```python
import torch

def _softmax(x, axis=-1):
    return torch.softmax(x, dim=axis)

def _gelu(x):
    return torch.nn.functional.gelu(x, approximate='tanh')

def _silu(x):
    return torch.nn.functional.silu(x)

def _sigmoid(x):
    return torch.sigmoid(x)

def _layernorm(x, axis=-1, eps=1e-05):
    m = x.mean(dim=axis, keepdim=True)
    v = x.var(dim=axis, keepdim=True, unbiased=False)
    return (x - m) / torch.sqrt(v + eps)

def _scatter_add(tgt, idx, src, axis=0):
    return tgt.clone().index_add_(axis, idx, src)

def _segment_sum(src, seg, n):
    out = torch.zeros((n,) + src.shape[1:], dtype=src.dtype)
    return out.index_add_(0, seg, src)

def _pad(x, pw):
    flat = tuple((v for pair in reversed(pw) for v in pair))
    return torch.nn.functional.pad(x, flat)
kernel_name = 'adaLN_cond__spectral_gfnet__glu_gated_reglu__prompt'

def setup_inputs():

    _w = lambda a: (lambda t: t.to(torch.bfloat16) if t.is_floating_point() else t)(torch.as_tensor(a))

    def _A_setup():
        B, S, D = (1, 2048, 576)
        Df = D // 2 + 1
        return {'x': _w((lambda *s: torch.randn(*s, dtype=torch.bfloat16) * 0.05)(B, S, D)), 'w_r': _w((lambda *s: torch.randn(*s, dtype=torch.bfloat16) * 3.2)(S, Df) * 0.02), 'w_i': _w((lambda *s: torch.randn(*s, dtype=torch.bfloat16) * 3.2)(S, Df) * 0.02)}
    _A_in = _A_setup()

    def _B_setup():
        B, S, D, F = (1, 2048, 576, 4608)
        return {'x': _w((lambda *s: torch.randn(*s, dtype=torch.bfloat16) * 0.05)(B, S, D)), 'W_gate': _w((lambda *s: torch.randn(*s, dtype=torch.bfloat16) * 0.4)(D, F) * (2.0 / D) ** 0.5), 'W_up': _w((lambda *s: torch.randn(*s, dtype=torch.bfloat16) * 0.4)(D, F) * (2.0 / D) ** 0.5), 'W_down': _w((lambda *s: torch.randn(*s, dtype=torch.bfloat16) * 0.4)(F, D) * (1.0 / F) ** 0.5)}
    _B_in = _B_setup()
    return {'A_x': _A_in['x'], 'A_w_r': _A_in['w_r'], 'A_w_i': _A_in['w_i'], 'B_x': _B_in['x'], 'B_W_gate': _B_in['W_gate'], 'B_W_up': _B_in['W_up'], 'B_W_down': _B_in['W_down'], 'c': _w((lambda *s: torch.randn(*s, dtype=torch.bfloat16) * 0.1)(1, 576) * 8.0), 'w_mod': _w((lambda *s: torch.randn(*s, dtype=torch.bfloat16) * 0.1)(576, 6 * 576) * 576 ** (-0.5) * 8.0)}

def reference(A_x, A_w_r, A_w_i, B_x, B_W_gate, B_W_up, B_W_down, c, w_mod):

    def _A_ref(x, w_r, w_i):
        B, S, D = x.shape
        X = (lambda x, axes=(-2, -1): torch.fft.rfft2(x.float(), dim=axes))(x, axes=(-2, -1))
        W = w_r + 1j * w_i
        X = X * W
        y = (lambda x, s, axes=(-2, -1): torch.fft.irfft2(x, s=s, dim=axes).to(torch.bfloat16))(X, (S, D), axes=(-2, -1))
        return y

    def _B_ref(x, W_gate, W_up, W_down):
        gate = torch.einsum('bsd,df->bsf', x, W_gate)
        up = torch.einsum('bsd,df->bsf', x, W_up)
        gate = gate * (lambda x, dt: x.to(dt))(gate > 0, gate.dtype)
        h = gate * up
        return torch.einsum('bsf,fd->bsd', h, W_down)
    x = A_x
    mod = (_silu(c) @ w_mod).reshape(c.shape[0], 6, 1, -1)
    sa, ca, ga, sb, cb, gb = (mod[:, 0].clone(), mod[:, 1].clone(), mod[:, 2].clone(), mod[:, 3].clone(), mod[:, 4].clone(), mod[:, 5].clone())
    h = _layernorm(x, axis=-1) * (1 + ca) + sa
    x = x + ga * _A_ref(h, A_w_r, A_w_i)
    h = _layernorm(x, axis=-1) * (1 + cb) + sb
    x = x + gb * _B_ref(h, B_W_gate, B_W_up, B_W_down)
    return x
```

```asm
; @launch grid=(256,1,1) block=(256,1,1) lds=162560
.amdgcn_target "amdgcn-amd-amdhsa--gfx950"
.text
.globl adaLN_cond__spectral_gfnet__glu_gated_reglu__prompt_kernel
.p2align 8
.type adaLN_cond__spectral_gfnet__glu_gated_reglu__prompt_kernel,@function
adaLN_cond__spectral_gfnet__glu_gated_reglu__prompt_kernel:
  s_cmp_ge_u32 s2, 256
  s_cbranch_scc1 KB_END
  s_load_dwordx4 s[52:55], s[0:1], 8
  s_load_dwordx4 s[56:59], s[0:1], 56
  s_load_dwordx2 s[64:65], s[0:1], 80
  s_load_dwordx2 s[68:69], s[0:1], 48
  s_load_dwordx2 s[4:5], s[0:1], 0
  s_load_dwordx2 s[40:41], s[0:1], 88
  v_lshrrev_b32 v1, 6, v0
  v_and_b32 v2, 63, v0
  v_and_b32 v3, 31, v0
  v_lshrrev_b32 v4, 5, v0
  v_readfirstlane_b32 s21, v1
  s_and_b32 s22, s2, 31
  s_lshr_b32 s23, s2, 5
  s_lshl_b32 s24, s23, 7
  s_add_u32 s24, s24, s22
  s_mul_i32 s24, s24, 1152
  v_lshlrev_b32 v8, 4, v3
  v_lshlrev_b32 v9, 2, v3
  v_add_u32 v9, 1024, v9
  v_bfe_u32 v12, v0, 5, 1
  v_lshl_add_u32 v12, v12, 5, v1
  v_mul_u32_u24 v12, 36864, v12
  v_add_u32 v6, v12, v8
  v_add_u32 v7, v12, v9
  v_mul_u32_u24 v12, 1152, v4
  v_add_u32 v42, v12, v8
  v_add_u32 v43, v12, v9
  v_and_b32 v10, 15, v2
  v_lshrrev_b32 v11, 4, v2
  v_cvt_f32_u32 v94, v10
  v_cvt_f32_u32 v95, v11
  s_movk_i32 s25, 13824
  s_movk_i32 s33, 27648
  v_lshlrev_b32 v184, 4, v0
  v_lshl_add_u32 v185, v1, 3, v2
  v_lshlrev_b32 v187, 3, v185
  v_add_u32 v187, 29696, v187
  v_lshlrev_b32 v185, 4, v185
  v_add_u32 v185, 4096, v185
  v_cmp_gt_u32 vcc, 8, v2
  v_mov_b32 v5, 1073741824
  s_nop 0
  v_cndmask_b32 v185, v5, v185, vcc
  v_mov_b32 v5, 29952
  v_cndmask_b32 v187, v5, v187, vcc
  v_lshlrev_b32 v186, 3, v0
  v_add_u32 v186, 27648, v186
  v_cmp_le_u32 vcc, 144, v0
  s_nop 1
  v_cndmask_b32 v188, 0, 1.0, vcc
  v_mul_f32 v114, 0x3d638e39, v94
  v_mul_f32 v124, 0x41000000, v95
  v_mul_f32 v124, v124, v114
  v_fma_f32 v125, v114, 1.0, v124
  v_fma_f32 v126, v114, 2.0, v124
  v_add_f32 v127, v126, v114
  v_fma_f32 v128, v114, 4.0, v124
  v_add_f32 v129, v128, v114
  v_add_f32 v130, v129, v114
  v_add_f32 v131, v130, v114
  v_mul_f32 v115, 0x3ae38e39, v94
  v_mul_f32 v60, 4.0, v95
  v_mul_f32 v60, v60, v115
  v_mul_f32 v114, 0x41800000, v115
  v_add_f32 v64, v60, v114
  v_fma_f32 v61, v115, 1.0, v60
  v_fma_f32 v62, v115, 2.0, v60
  v_add_f32 v63, v62, v115
  v_fma_f32 v65, v115, 1.0, v64
  v_fma_f32 v66, v115, 2.0, v64
  v_add_f32 v67, v66, v115
  s_cmp_ge_u32 s2, 54
  s_cselect_b32 s36, 36, 18
  s_cselect_b32 s37, 54, 0
  s_cselect_b32 s38, 18, 0
  s_sub_u32 s37, s2, s37
  s_lshl_b32 s39, s36, 1
  s_cmp_ge_u32 s37, s36
  s_cselect_b32 s34, 1, 0
  s_cmp_ge_u32 s37, s39
  s_cselect_b32 s34, 2, s34
  s_mul_i32 s35, s34, s36
  s_sub_u32 s35, s37, s35
  s_add_u32 s35, s35, s38
  v_lshrrev_b32 v227, 3, v0
  v_and_b32 v228, 7, v0
  v_mul_u32_u24 v226, 6912, v227
  v_lshl_add_u32 v226, v228, 4, v226
  v_lshlrev_b32 v227, 1, v227
  s_lshl_b32 s36, s35, 7
  s_mul_i32 s37, s34, 1327104
  s_add_u32 s36, s36, s37
  s_mul_i32 s37, s34, 384
  s_waitcnt lgkmcnt(0)
  s_cmp_ge_u32 s2, 162
  s_cbranch_scc1 KS_N0
  s_mov_b32 s60, s58
  s_mov_b32 s61, s59
  s_mov_b32 s62, 3981312
  s_mov_b32 s63, 0x20000
  s_mov_b32 s58, 1152
  s_mov_b32 s59, 0x20000
  buffer_load_ushort v220, v227, s[56:59], s37 offen offset:0
  buffer_load_ushort v221, v227, s[56:59], s37 offen offset:64
  buffer_load_ushort v222, v227, s[56:59], s37 offen offset:128
  buffer_load_ushort v223, v227, s[56:59], s37 offen offset:192
  buffer_load_ushort v224, v227, s[56:59], s37 offen offset:256
  buffer_load_ushort v225, v227, s[56:59], s37 offen offset:320
  buffer_load_dwordx4 v[196:199], v226, s[60:63], s36 offen
  s_add_u32 s36, s36, 221184
  buffer_load_dwordx4 v[200:203], v226, s[60:63], s36 offen
  s_add_u32 s36, s36, 221184
  buffer_load_dwordx4 v[204:207], v226, s[60:63], s36 offen
  s_add_u32 s36, s36, 221184
  buffer_load_dwordx4 v[208:211], v226, s[60:63], s36 offen
  s_add_u32 s36, s36, 221184
  buffer_load_dwordx4 v[212:215], v226, s[60:63], s36 offen
  s_add_u32 s36, s36, 221184
  buffer_load_dwordx4 v[216:219], v226, s[60:63], s36 offen
KS_N0:
  s_mov_b32 s48, s40
  s_mov_b32 s49, s41
  s_mov_b32 s50, 268435456
  s_mov_b32 s51, 0x20000
  s_mov_b32 s8, s4
  s_mov_b32 s9, s5
  s_mov_b32 s10, 2359296
  s_mov_b32 s11, 0x20000
  s_add_u32 s12, s40, 8192
  s_addc_u32 s13, s41, 0
  s_mov_b32 s14, 41472
  s_mov_b32 s15, 0x20000
  buffer_load_dwordx4 v[12:15], v6, s[8:11], s24 offen
  buffer_load_dwordx4 v[16:19], v6, s[8:11], s24 offen offset:512
  buffer_load_dword v20, v7, s[8:11], s24 offen
  s_lshl_b32 s36, s2, 13
  s_add_u32 s36, s36, 15728640
  s_cmp_ge_u32 s2, 54
  s_cselect_b32 s36, 1073741824, s36
  s_add_u32 s37, s36, 4096
  v_lshlrev_b32 v226, 4, v0
  v_mov_b32 v236, 0
  v_mov_b32 v237, 0
  v_mov_b32 v238, 0
  v_mov_b32 v239, 0
  buffer_store_dwordx4 v[236:239], v226, s[48:51], s36 offen sc1
  buffer_store_dwordx4 v[236:239], v226, s[48:51], s37 offen sc1
  s_mul_i32 s36, s34, 13824
  s_lshl_b32 s37, s35, 8
  s_add_u32 s36, s36, s37
  s_add_u32 s36, s36, 8192
  s_add_u32 s16, s40, 3145728
  s_addc_u32 s17, s41, 0
  s_mov_b32 s18, 2375680
  s_mov_b32 s19, 0x20000
  s_cmp_ge_u32 s2, 162
  s_cbranch_scc1 KS_N1
  s_waitcnt vmcnt(11)
  v_lshlrev_b32 v220, 16, v220
  v_lshlrev_b32 v221, 16, v221
  v_lshlrev_b32 v222, 16, v222
  v_lshlrev_b32 v223, 16, v223
  v_lshlrev_b32 v224, 16, v224
  v_lshlrev_b32 v225, 16, v225
  v_mul_f32 v226, 0xbfb8aa3b, v220
  v_mul_f32 v227, 0xbfb8aa3b, v221
  v_mul_f32 v228, 0xbfb8aa3b, v222
  v_mul_f32 v229, 0xbfb8aa3b, v223
  v_mul_f32 v230, 0xbfb8aa3b, v224
  v_mul_f32 v231, 0xbfb8aa3b, v225
  v_exp_f32 v226, v226
  v_exp_f32 v227, v227
  v_exp_f32 v228, v228
  v_exp_f32 v229, v229
  v_exp_f32 v230, v230
  v_exp_f32 v231, v231
  v_add_f32 v226, 1.0, v226
  v_add_f32 v227, 1.0, v227
  v_add_f32 v228, 1.0, v228
  v_add_f32 v229, 1.0, v229
  v_add_f32 v230, 1.0, v230
  v_add_f32 v231, 1.0, v231
  v_rcp_f32 v226, v226
  v_rcp_f32 v227, v227
  v_rcp_f32 v228, v228
  v_rcp_f32 v229, v229
  v_rcp_f32 v230, v230
  v_rcp_f32 v231, v231
  v_mul_f32 v226, v220, v226
  v_mul_f32 v227, v221, v227
  v_mul_f32 v228, v222, v228
  v_mul_f32 v229, v223, v229
  v_mul_f32 v230, v224, v230
  v_mul_f32 v231, v225, v231
  v_cvt_pk_bf16_f32 v226, v226, v226
  v_cvt_pk_bf16_f32 v227, v227, v227
  v_cvt_pk_bf16_f32 v228, v228, v228
  v_cvt_pk_bf16_f32 v229, v229, v229
  v_cvt_pk_bf16_f32 v230, v230, v230
  v_cvt_pk_bf16_f32 v231, v231, v231
  v_and_b32 v242, 0xffff0000, v226
  v_and_b32 v244, 0xffff0000, v227
  v_and_b32 v246, 0xffff0000, v228
  v_and_b32 v248, 0xffff0000, v229
  v_and_b32 v250, 0xffff0000, v230
  v_and_b32 v252, 0xffff0000, v231
  v_bfe_u32 v220, v2, 5, 1
  v_bfe_u32 v221, v2, 4, 1
  v_lshl_or_b32 v220, v221, 1, v220
  v_bfe_u32 v221, v2, 3, 1
  v_lshl_or_b32 v220, v221, 2, v220
  v_cmp_eq_u32 s[34:35], 1, v221
  v_and_b32 v221, 7, v2
  v_lshl_or_b32 v220, v221, 3, v220
  v_lshlrev_b32 v220, 2, v220
  v_lshl_add_u32 v220, v1, 8, v220
  v_add_u32 v220, 61440, v220
  v_lshlrev_b32 v221, 2, v2
  s_waitcnt vmcnt(10)
  v_lshlrev_b32 v226, 16, v196
  v_and_b32 v227, 0xffff0000, v196
  v_lshlrev_b32 v228, 16, v197
  v_and_b32 v229, 0xffff0000, v197
  v_lshlrev_b32 v230, 16, v198
  v_and_b32 v231, 0xffff0000, v198
  v_lshlrev_b32 v232, 16, v199
  v_and_b32 v233, 0xffff0000, v199
  v_pk_mul_f32 v[234:235], v[226:227], v[242:243] op_sel_hi:[1,0]
  v_pk_mul_f32 v[236:237], v[228:229], v[242:243] op_sel_hi:[1,0]
  v_pk_mul_f32 v[238:239], v[230:231], v[242:243] op_sel_hi:[1,0]
  v_pk_mul_f32 v[240:241], v[232:233], v[242:243] op_sel_hi:[1,0]
  s_waitcnt vmcnt(9)
  v_lshlrev_b32 v226, 16, v200
  v_and_b32 v227, 0xffff0000, v200
  v_lshlrev_b32 v228, 16, v201
  v_and_b32 v229, 0xffff0000, v201
  v_lshlrev_b32 v230, 16, v202
  v_and_b32 v231, 0xffff0000, v202
  v_lshlrev_b32 v232, 16, v203
  v_and_b32 v233, 0xffff0000, v203
  v_pk_fma_f32 v[234:235], v[226:227], v[244:245], v[234:235] op_sel_hi:[1,0,1]
  v_pk_fma_f32 v[236:237], v[228:229], v[244:245], v[236:237] op_sel_hi:[1,0,1]
  v_pk_fma_f32 v[238:239], v[230:231], v[244:245], v[238:239] op_sel_hi:[1,0,1]
  v_pk_fma_f32 v[240:241], v[232:233], v[244:245], v[240:241] op_sel_hi:[1,0,1]
  s_waitcnt vmcnt(8)
  v_lshlrev_b32 v226, 16, v204
  v_and_b32 v227, 0xffff0000, v204
  v_lshlrev_b32 v228, 16, v205
  v_and_b32 v229, 0xffff0000, v205
  v_lshlrev_b32 v230, 16, v206
  v_and_b32 v231, 0xffff0000, v206
  v_lshlrev_b32 v232, 16, v207
  v_and_b32 v233, 0xffff0000, v207
  v_pk_fma_f32 v[234:235], v[226:227], v[246:247], v[234:235] op_sel_hi:[1,0,1]
  v_pk_fma_f32 v[236:237], v[228:229], v[246:247], v[236:237] op_sel_hi:[1,0,1]
  v_pk_fma_f32 v[238:239], v[230:231], v[246:247], v[238:239] op_sel_hi:[1,0,1]
  v_pk_fma_f32 v[240:241], v[232:233], v[246:247], v[240:241] op_sel_hi:[1,0,1]
  s_waitcnt vmcnt(7)
  v_lshlrev_b32 v226, 16, v208
  v_and_b32 v227, 0xffff0000, v208
  v_lshlrev_b32 v228, 16, v209
  v_and_b32 v229, 0xffff0000, v209
  v_lshlrev_b32 v230, 16, v210
  v_and_b32 v231, 0xffff0000, v210
  v_lshlrev_b32 v232, 16, v211
  v_and_b32 v233, 0xffff0000, v211
  v_pk_fma_f32 v[234:235], v[226:227], v[248:249], v[234:235] op_sel_hi:[1,0,1]
  v_pk_fma_f32 v[236:237], v[228:229], v[248:249], v[236:237] op_sel_hi:[1,0,1]
  v_pk_fma_f32 v[238:239], v[230:231], v[248:249], v[238:239] op_sel_hi:[1,0,1]
  v_pk_fma_f32 v[240:241], v[232:233], v[248:249], v[240:241] op_sel_hi:[1,0,1]
  s_waitcnt vmcnt(6)
  v_lshlrev_b32 v226, 16, v212
  v_and_b32 v227, 0xffff0000, v212
  v_lshlrev_b32 v228, 16, v213
  v_and_b32 v229, 0xffff0000, v213
  v_lshlrev_b32 v230, 16, v214
  v_and_b32 v231, 0xffff0000, v214
  v_lshlrev_b32 v232, 16, v215
  v_and_b32 v233, 0xffff0000, v215
  v_pk_fma_f32 v[234:235], v[226:227], v[250:251], v[234:235] op_sel_hi:[1,0,1]
  v_pk_fma_f32 v[236:237], v[228:229], v[250:251], v[236:237] op_sel_hi:[1,0,1]
  v_pk_fma_f32 v[238:239], v[230:231], v[250:251], v[238:239] op_sel_hi:[1,0,1]
  v_pk_fma_f32 v[240:241], v[232:233], v[250:251], v[240:241] op_sel_hi:[1,0,1]
  s_waitcnt vmcnt(5)
  v_lshlrev_b32 v226, 16, v216
  v_and_b32 v227, 0xffff0000, v216
  v_lshlrev_b32 v228, 16, v217
  v_and_b32 v229, 0xffff0000, v217
  v_lshlrev_b32 v230, 16, v218
  v_and_b32 v231, 0xffff0000, v218
  v_lshlrev_b32 v232, 16, v219
  v_and_b32 v233, 0xffff0000, v219
  v_pk_fma_f32 v[234:235], v[226:227], v[252:253], v[234:235] op_sel_hi:[1,0,1]
  v_pk_fma_f32 v[236:237], v[228:229], v[252:253], v[236:237] op_sel_hi:[1,0,1]
  v_pk_fma_f32 v[238:239], v[230:231], v[252:253], v[238:239] op_sel_hi:[1,0,1]
  v_pk_fma_f32 v[240:241], v[232:233], v[252:253], v[240:241] op_sel_hi:[1,0,1]
  v_permlane32_swap_b32 v234, v235
  v_permlane32_swap_b32 v236, v237
  v_permlane32_swap_b32 v238, v239
  v_permlane32_swap_b32 v240, v241
  v_add_f32 v234, v234, v235
  v_add_f32 v236, v236, v237
  v_add_f32 v238, v238, v239
  v_add_f32 v240, v240, v241
  v_permlane16_swap_b32 v234, v236
  s_nop 0
  v_permlane16_swap_b32 v238, v240
  v_add_f32 v234, v234, v236
  v_add_f32 v238, v238, v240
  s_nop 0
  v_add_f32_dpp v234, v234, v234 row_ror:8 row_mask:0xf bank_mask:0xf
  v_add_f32_dpp v238, v238, v238 row_ror:8 row_mask:0xf bank_mask:0xf
  v_cndmask_b32 v234, v234, v238, s[34:35]
  ds_write_b32 v220, v234
  v_add_u32 v220, 61440, v221
  v_cmp_gt_u32 vcc, 64, v0
  v_mov_b32 v236, 1073741824
  s_nop 0
  v_cndmask_b32 v221, v236, v221, vcc
  s_waitcnt lgkmcnt(0)
  s_barrier
  ds_read_b32 v226, v220 offset:0
  ds_read_b32 v227, v220 offset:256
  ds_read_b32 v228, v220 offset:512
  ds_read_b32 v229, v220 offset:768
  s_waitcnt lgkmcnt(0)
  v_pk_add_f32 v[226:227], v[226:227], v[228:229]
  v_add_f32 v226, v226, v227
  buffer_store_dword v226, v221, s[48:51], s36 offen sc1
  s_waitcnt vmcnt(3)
  s_branch KS_N2
KS_N1:
  s_waitcnt vmcnt(2)
KS_N2:
  s_cmp_lt_u32 s2, 56
  s_cbranch_scc1 KC1_S
  s_getpc_b64 s[72:73]
KC1_PC:
  s_lshr_b32 s74, s2, 3
  s_sub_u32 s74, s74, 7
  s_lshl_b32 s74, s74, 2
  s_add_u32 s74, s74, s21
  s_mul_i32 s74, s74, 6
  v_min_u32 v254, 5, v2
  v_add_u32 v254, s74, v254
  v_lshlrev_b32 v254, 7, v254
  v_min_u32 v254, KB_END-KS_HX, v254
  v_add_u32 v254, KS_HX-KC1_PC, v254
  v_mov_b32 v255, s73
  v_add_co_u32 v254, vcc, s72, v254
  s_nop 1
  v_addc_co_u32 v255, vcc, 0, v255, vcc
  global_load_dword v254, v[254:255], off
KC1_S:
  s_cmp_lt_u32 s2, 128
  s_cbranch_scc1 KM_WL
  s_bfe_u32 s56, s2, 0x10003
  s_and_b32 s57, s2, 7
  s_lshl_b32 s57, s57, 1
  s_or_b32 s56, s56, s57
  s_bfe_u32 s57, s2, 0x30004
  s_lshl_b32 s58, s21, 6
  s_lshl_b32 s59, s57, 8
  s_add_u32 s58, s58, s59
  s_lshl_b32 s59, s56, 2
  s_add_u32 s58, s58, s59
  s_mul_i32 s58, s58, 578
  s_mul_i32 s59, s21, 3072
  s_add_u32 m0, s59, 32768
  v_lshlrev_b32 v194, 4, v2
  s_mov_b32 s60, s54
  s_mov_b32 s61, s55
  s_mov_b32 s62, 1183744
  s_mov_b32 s63, 0x20000
  s_mov_b32 s54, 1183744
  s_mov_b32 s55, 0x20000
  buffer_load_dwordx4 v194, s[52:55], s58 offen offset:0 lds
  buffer_load_dwordx4 v194, s[52:55], s58 offen offset:1024 lds
  buffer_load_dwordx4 v194, s[52:55], s58 offen offset:2048 lds
  s_add_u32 m0, s59, 45056
  s_nop 0
  buffer_load_dwordx4 v194, s[60:63], s58 offen offset:0 lds
  buffer_load_dwordx4 v194, s[60:63], s58 offen offset:1024 lds
  buffer_load_dwordx4 v194, s[60:63], s58 offen offset:2048 lds
KM_WL:
  v_lshlrev_b32 v96, 16, v12
  v_and_b32 v97, 0xffff0000, v12
  v_lshlrev_b32 v98, 16, v13
  v_and_b32 v99, 0xffff0000, v13
  v_lshlrev_b32 v100, 16, v14
  v_and_b32 v101, 0xffff0000, v14
  v_lshlrev_b32 v102, 16, v15
  v_and_b32 v103, 0xffff0000, v15
  v_lshlrev_b32 v104, 16, v16
  v_and_b32 v105, 0xffff0000, v16
  v_lshlrev_b32 v106, 16, v17
  v_and_b32 v107, 0xffff0000, v17
  v_lshlrev_b32 v108, 16, v18
  v_and_b32 v109, 0xffff0000, v18
  v_lshlrev_b32 v110, 16, v19
  v_and_b32 v111, 0xffff0000, v19
  v_lshlrev_b32 v112, 16, v20
  v_and_b32 v113, 0xffff0000, v20
  v_pk_add_f32 v[150:151], v[96:97], v[98:99]
  v_pk_add_f32 v[150:151], v[150:151], v[100:101]
  v_pk_add_f32 v[150:151], v[150:151], v[102:103]
  v_pk_add_f32 v[150:151], v[150:151], v[104:105]
  v_pk_add_f32 v[150:151], v[150:151], v[106:107]
  v_pk_add_f32 v[150:151], v[150:151], v[108:109]
  v_pk_add_f32 v[150:151], v[150:151], v[110:111]
  v_pk_add_f32 v[150:151], v[150:151], v[112:113]
  v_add_f32 v150, v150, v151
  s_nop 1
  v_add_f32_dpp v150, v150, v150 row_ror:8 row_mask:0xf bank_mask:0xf
  s_nop 1
  v_add_f32_dpp v150, v150, v150 row_ror:4 row_mask:0xf bank_mask:0xf
  s_nop 1
  v_add_f32_dpp v150, v150, v150 row_ror:2 row_mask:0xf bank_mask:0xf
  s_nop 1
  v_add_f32_dpp v150, v150, v150 row_ror:1 row_mask:0xf bank_mask:0xf
  v_mov_b32 v151, v150
  s_nop 1
  v_permlane16_swap_b32 v150, v151
  v_add_f32 v150, v150, v151
  v_mul_f32 v150, 0xbae38e39, v150
  v_cvt_pk_bf16_f32 v153, v150, v150
  v_pk_add_f32 v[96:97], v[96:97], v[150:151] op_sel_hi:[1,0]
  v_pk_add_f32 v[98:99], v[98:99], v[150:151] op_sel_hi:[1,0]
  v_pk_add_f32 v[100:101], v[100:101], v[150:151] op_sel_hi:[1,0]
  v_pk_add_f32 v[102:103], v[102:103], v[150:151] op_sel_hi:[1,0]
  v_pk_add_f32 v[104:105], v[104:105], v[150:151] op_sel_hi:[1,0]
  v_pk_add_f32 v[106:107], v[106:107], v[150:151] op_sel_hi:[1,0]
  v_pk_add_f32 v[108:109], v[108:109], v[150:151] op_sel_hi:[1,0]
  v_pk_add_f32 v[110:111], v[110:111], v[150:151] op_sel_hi:[1,0]
  v_pk_add_f32 v[112:113], v[112:113], v[150:151] op_sel_hi:[1,0]
  v_and_b32 v153, 0xffff0000, v153
  v_sub_f32 v153, v153, v150
  v_pk_mul_f32 v[150:151], v[96:97], v[96:97]
  v_pk_fma_f32 v[150:151], v[98:99], v[98:99], v[150:151]
  v_pk_fma_f32 v[150:151], v[100:101], v[100:101], v[150:151]
  v_pk_fma_f32 v[150:151], v[102:103], v[102:103], v[150:151]
  v_pk_fma_f32 v[150:151], v[104:105], v[104:105], v[150:151]
  v_pk_fma_f32 v[150:151], v[106:107], v[106:107], v[150:151]
  v_pk_fma_f32 v[150:151], v[108:109], v[108:109], v[150:151]
  v_pk_fma_f32 v[150:151], v[110:111], v[110:111], v[150:151]
  v_pk_fma_f32 v[150:151], v[112:113], v[112:113], v[150:151]
  v_add_f32 v150, v150, v151
  s_nop 1
  v_add_f32_dpp v150, v150, v150 row_ror:8 row_mask:0xf bank_mask:0xf
  s_nop 1
  v_add_f32_dpp v150, v150, v150 row_ror:4 row_mask:0xf bank_mask:0xf
  s_nop 1
  v_add_f32_dpp v150, v150, v150 row_ror:2 row_mask:0xf bank_mask:0xf
  s_nop 1
  v_add_f32_dpp v150, v150, v150 row_ror:1 row_mask:0xf bank_mask:0xf
  v_mov_b32 v151, v150
  s_nop 1
  v_permlane16_swap_b32 v150, v151
  v_add_f32 v150, v150, v151
  v_mul_f32 v152, 0x3ae38e39, v150
  v_cvt_pk_bf16_f32 v152, v152, v152
  v_and_b32 v152, 0xffff0000, v152
  v_add_f32 v152, 0x3727c5ac, v152
  v_cvt_pk_bf16_f32 v152, v152, v152
  v_and_b32 v152, 0xffff0000, v152
  v_sqrt_f32 v152, v152
  s_nop 0
  v_cvt_pk_bf16_f32 v152, v152, v152
  v_and_b32 v152, 0xffff0000, v152
  v_rcp_f32 v152, v152
  s_nop 0
  v_mul_f32 v153, v153, v152
  v_pk_fma_f32 v[96:97], v[96:97], v[152:153], v[152:153] op_sel:[0,0,1] op_sel_hi:[1,0,1]
  v_pk_fma_f32 v[98:99], v[98:99], v[152:153], v[152:153] op_sel:[0,0,1] op_sel_hi:[1,0,1]
  v_pk_fma_f32 v[100:101], v[100:101], v[152:153], v[152:153] op_sel:[0,0,1] op_sel_hi:[1,0,1]
  v_pk_fma_f32 v[102:103], v[102:103], v[152:153], v[152:153] op_sel:[0,0,1] op_sel_hi:[1,0,1]
  v_pk_fma_f32 v[104:105], v[104:105], v[152:153], v[152:153] op_sel:[0,0,1] op_sel_hi:[1,0,1]
  v_pk_fma_f32 v[106:107], v[106:107], v[152:153], v[152:153] op_sel:[0,0,1] op_sel_hi:[1,0,1]
  v_pk_fma_f32 v[108:109], v[108:109], v[152:153], v[152:153] op_sel:[0,0,1] op_sel_hi:[1,0,1]
  v_pk_fma_f32 v[110:111], v[110:111], v[152:153], v[152:153] op_sel:[0,0,1] op_sel_hi:[1,0,1]
  v_pk_fma_f32 v[112:113], v[112:113], v[152:153], v[152:153] op_sel:[0,0,1] op_sel_hi:[1,0,1]
  s_mov_b32 s66, 256
  s_mov_b32 s67, 0x20000
  v_cmp_eq_u32 vcc, 0, v0
  v_mov_b32 v250, 1073741824
  s_nop 0
  v_cndmask_b32 v250, v250, 0, vcc
  v_mov_b32 v251, 1
  s_cmp_ge_u32 s2, 54
  s_cbranch_scc1 KS_HP
  s_waitcnt vmcnt(0)
  s_barrier
  s_cmp_lg_u32 s21, 0
  s_cbranch_scc1 KS_HP
  buffer_atomic_add v251, v250, s[64:67], 0 offen sc0 sc1
  s_waitcnt vmcnt(0)
  v_readfirstlane_b32 s34, v251
  s_nop 0
  s_cmp_lg_u32 s34, 53
  s_cbranch_scc1 KS_HP
  buffer_store_dword v251, v250, s[64:67], 0 offen offset:128 sc1
KS_HP:
  v_cos_f32 v116, v124
  v_cos_f32 v117, v125
  v_cos_f32 v118, v126
  v_cos_f32 v119, v127
  v_cos_f32 v120, v128
  v_cos_f32 v121, v129
  v_cos_f32 v122, v130
  v_cos_f32 v123, v131
  v_sin_f32 v124, v124
  v_sin_f32 v125, v125
  v_sin_f32 v126, v126
  v_sin_f32 v127, v127
  v_sin_f32 v128, v128
  v_sin_f32 v129, v129
  v_sin_f32 v130, v130
  v_sin_f32 v131, v131
  v_cmp_gt_u32 vcc, 3, v11
  v_cmp_gt_u32 s[30:31], 2, v11
  v_cos_f32 v52, v60
  v_cos_f32 v53, v61
  v_cos_f32 v54, v62
  v_cos_f32 v55, v63
  v_cos_f32 v56, v64
  v_cos_f32 v57, v65
  v_cos_f32 v58, v66
  v_cos_f32 v59, v67
  v_sin_f32 v60, v60
  v_sin_f32 v61, v61
  v_sin_f32 v62, v62
  v_sin_f32 v63, v63
  v_sin_f32 v64, v64
  v_sin_f32 v65, v65
  v_sin_f32 v66, v66
  v_sin_f32 v67, v67
  v_cvt_pk_bf16_f32 v44, v116, v117
  v_cvt_pk_bf16_f32 v48, -v124, -v125
  v_cvt_pk_bf16_f32 v45, v118, v119
  v_cvt_pk_bf16_f32 v49, -v126, -v127
  v_cvt_pk_bf16_f32 v46, v120, v121
  v_cvt_pk_bf16_f32 v50, -v128, -v129
  v_cvt_pk_bf16_f32 v47, v122, v123
  v_cvt_pk_bf16_f32 v51, -v130, -v131
  v_cndmask_b32 v44, 0, v44, vcc
  v_cndmask_b32 v48, 0, v48, vcc
  v_cndmask_b32 v45, 0, v45, s[30:31]
  v_cndmask_b32 v49, 0, v49, s[30:31]
  v_cndmask_b32 v46, 0, v46, s[30:31]
  v_cndmask_b32 v50, 0, v50, s[30:31]
  v_cndmask_b32 v47, 0, v47, s[30:31]
  v_cndmask_b32 v51, 0, v51, s[30:31]
  v_mul_f32 v114, 0x3d000000, v94
  v_mul_f32 v119, 4.0, v95
  v_mul_f32 v119, v119, v114
  v_fma_f32 v120, v114, 1.0, v119
  v_fma_f32 v121, v114, 2.0, v119
  v_add_f32 v122, v121, v114
  v_and_b32 v123, 1, v10
  v_mul_u32_u24 v123, 0x8000, v123
  v_cos_f32 v115, v119
  v_cos_f32 v116, v120
  v_cos_f32 v117, v121
  v_cos_f32 v118, v122
  v_sin_f32 v119, v119
  v_sin_f32 v120, v120
  v_sin_f32 v121, v121
  v_sin_f32 v122, v122
  v_lshl_or_b32 v123, v123, 16, v123
  v_cvt_pk_bf16_f32 v68, v115, v116
  v_cvt_pk_bf16_f32 v69, v117, v118
  v_cvt_pk_bf16_f32 v72, v119, v120
  v_cvt_pk_bf16_f32 v73, v121, v122
  v_xor_b32 v70, v68, v123
  v_xor_b32 v71, v69, v123
  v_xor_b32 v74, v72, v123
  v_xor_b32 v75, v73, v123
  v_xor_b32 v76, 0x80008000, v72
  v_xor_b32 v77, 0x80008000, v73
  v_xor_b32 v78, 0x80008000, v74
  v_xor_b32 v79, 0x80008000, v75
  v_xor_b32 v80, 0x80000000, v68
  v_xor_b32 v81, 0x80000000, v69
  v_xor_b32 v82, 0x80000000, v70
  v_xor_b32 v83, 0x80000000, v71
  v_xor_b32 v84, 0x80000000, v72
  v_xor_b32 v85, 0x80000000, v73
  v_xor_b32 v86, 0x80000000, v74
  v_xor_b32 v87, 0x80000000, v75
  v_xor_b32 v88, 0x00008000, v68
  v_xor_b32 v89, 0x00008000, v69
  v_xor_b32 v90, 0x00008000, v70
  v_xor_b32 v91, 0x00008000, v71
  v_lshrrev_b32 v5, 2, v10
  v_lshl_add_u32 v5, v11, 3, v5
  v_and_b32 v94, 3, v10
  v_lshlrev_b32 v94, 3, v94
  s_mul_i32 s26, s21, 2304
  v_add_u32 v94, s26, v94
  v_min_u32 v92, 17, v5
  v_lshl_add_u32 v92, v92, 6, v94
  v_add_u32 v5, 4, v5
  v_min_u32 v93, 17, v5
  v_lshl_add_u32 v93, v93, 6, v94
  s_lshl_b32 s26, s21, 3
  s_add_u32 s26, s26, 9216
  v_mul_u32_u24 v5, 72, v11
  v_add_u32 v5, v5, v10
  v_mul_u32_u24 v5, 40, v5
  v_add_u32 v94, s26, v5
  s_add_u32 s27, s26, 9360
  v_sub_u32 v95, s27, v5
  s_add_u32 s27, s26, 11520
  v_mov_b32 v5, s27
  v_cmp_eq_u32 vcc, 1, v2
  s_nop 1
  v_cndmask_b32 v41, v94, v5, vcc
  s_add_u32 s27, s26, 40
  v_mov_b32 v5, s27
  v_cmp_eq_u32 vcc, 0, v2
  v_add_u32 v4, 2160, v95
  s_nop 0
  v_cndmask_b32 v4, v4, v5, vcc
  v_lshrrev_b32 v5, 4, v0
  v_lshlrev_b32 v5, 2, v5
  v_and_b32 v6, 3, v0
  v_add_u32 v5, v5, v6
  v_mul_u32_u24 v6, 80, v5
  v_bfe_u32 v5, v0, 2, 2
  v_lshl_add_u32 v6, v5, 3, v6
  v_add_u32 v6, 9216, v6
  v_lshrrev_b32 v7, 2, v0
  v_lshlrev_b32 v7, 14, v7
  v_and_b32 v5, 3, v2
  v_lshl_add_u32 v7, v5, 4, v7
  s_lshl_b32 s28, s22, 9
  s_lshl_b32 s29, s23, 6
  s_add_u32 s28, s28, s29
  s_add_u32 s29, s28, 1048576
  s_add_u32 s30, s28, 2097152
  s_cmp_lt_u32 s2, 128
  s_cbranch_scc1 KM_WS
  s_waitcnt vmcnt(0)
  s_barrier
  s_add_u32 s60, s40, 65536
  s_addc_u32 s61, s41, 0
  s_mov_b32 s62, 2367488
  s_mov_b32 s63, 0x20000
  v_and_b32 v196, 3, v0
  v_lshrrev_b32 v197, 2, v0
  v_mul_u32_u24 v198, 578, v196
  v_lshl_add_u32 v198, v197, 1, v198
  v_add_u32 v198, 32768, v198
  v_lshlrev_b32 v199, 13, v197
  v_lshl_add_u32 v199, v196, 4, v199
  s_lshl_b32 s58, s57, 10
  s_lshl_b32 s59, s56, 6
  s_add_u32 s58, s58, s59
  ds_read_u16 v200, v198 offset:0
  ds_read_u16 v224, v198 offset:12288
  ds_read_u16 v201, v198 offset:3072
  ds_read_u16 v225, v198 offset:15360
  ds_read_u16 v202, v198 offset:6144
  ds_read_u16 v226, v198 offset:18432
  ds_read_u16 v203, v198 offset:9216
  ds_read_u16 v227, v198 offset:21504
  ds_read_u16 v204, v198 offset:128
  ds_read_u16 v228, v198 offset:12416
  ds_read_u16 v205, v198 offset:3200
  ds_read_u16 v229, v198 offset:15488
  ds_read_u16 v206, v198 offset:6272
  ds_read_u16 v230, v198 offset:18560
  ds_read_u16 v207, v198 offset:9344
  ds_read_u16 v231, v198 offset:21632
  s_waitcnt lgkmcnt(8)
  v_lshl_or_b32 v200, v224, 16, v200
  v_lshl_or_b32 v201, v225, 16, v201
  v_lshl_or_b32 v202, v226, 16, v202
  v_lshl_or_b32 v203, v227, 16, v203
  buffer_store_dwordx4 v[200:203], v199, s[60:63], s58 offen sc1
  s_add_u32 s58, s58, 524288
  ds_read_u16 v208, v198 offset:256
  ds_read_u16 v232, v198 offset:12544
  ds_read_u16 v209, v198 offset:3328
  ds_read_u16 v233, v198 offset:15616
  ds_read_u16 v210, v198 offset:6400
  ds_read_u16 v234, v198 offset:18688
  ds_read_u16 v211, v198 offset:9472
  ds_read_u16 v235, v198 offset:21760
  s_waitcnt lgkmcnt(8)
  v_lshl_or_b32 v204, v228, 16, v204
  v_lshl_or_b32 v205, v229, 16, v205
  v_lshl_or_b32 v206, v230, 16, v206
  v_lshl_or_b32 v207, v231, 16, v207
  buffer_store_dwordx4 v[204:207], v199, s[60:63], s58 offen sc1
  s_add_u32 s58, s58, 524288
  ds_read_u16 v212, v198 offset:384
  ds_read_u16 v236, v198 offset:12672
  ds_read_u16 v213, v198 offset:3456
  ds_read_u16 v237, v198 offset:15744
  ds_read_u16 v214, v198 offset:6528
  ds_read_u16 v238, v198 offset:18816
  ds_read_u16 v215, v198 offset:9600
  ds_read_u16 v239, v198 offset:21888
  s_waitcnt lgkmcnt(8)
  v_lshl_or_b32 v208, v232, 16, v208
  v_lshl_or_b32 v209, v233, 16, v209
  v_lshl_or_b32 v210, v234, 16, v210
  v_lshl_or_b32 v211, v235, 16, v211
  buffer_store_dwordx4 v[208:211], v199, s[60:63], s58 offen sc1
  s_add_u32 s58, s58, 524288
  ds_read_u16 v216, v198 offset:512
  ds_read_u16 v240, v198 offset:12800
  ds_read_u16 v217, v198 offset:3584
  ds_read_u16 v241, v198 offset:15872
  ds_read_u16 v218, v198 offset:6656
  ds_read_u16 v242, v198 offset:18944
  ds_read_u16 v219, v198 offset:9728
  ds_read_u16 v243, v198 offset:22016
  s_waitcnt lgkmcnt(8)
  v_lshl_or_b32 v212, v236, 16, v212
  v_lshl_or_b32 v213, v237, 16, v213
  v_lshl_or_b32 v214, v238, 16, v214
  v_lshl_or_b32 v215, v239, 16, v215
  buffer_store_dwordx4 v[212:215], v199, s[60:63], s58 offen sc1
  s_add_u32 s58, s58, 524288
  s_waitcnt lgkmcnt(0)
  v_lshl_or_b32 v216, v240, 16, v216
  v_lshl_or_b32 v217, v241, 16, v217
  v_lshl_or_b32 v218, v242, 16, v218
  v_lshl_or_b32 v219, v243, 16, v219
  buffer_store_dwordx4 v[216:219], v199, s[60:63], s58 offen sc1
KM_WS:
  s_mul_i32 s70, s2, 4
  s_add_u32 s70, s70, s21
  s_mul_i32 s70, s70, 3456
  s_add_u32 s70, s70, 0
  v_lshlrev_b32 v248, 7, v2
  v_add_u32 v248, s70, v248
  v_cmp_gt_u32 vcc, 27, v2
  v_mov_b32 v249, 1073741824
  s_nop 0
  v_cndmask_b32 v248, v249, v248, vcc
  s_mov_b32 s70, 5308416
  s_mov_b32 s71, 0x20000
  s_cmp_lg_u32 s21, 0
  s_cbranch_scc1 KS_HX
  s_mov_b32 s35, 200000
KS_HL:
  buffer_load_dword v251, v250, s[64:67], 0 offen offset:128 sc1
  s_sub_u32 s35, s35, 1
  s_cmp_eq_u32 s35, 0
  s_cbranch_scc1 KS_HX
  s_waitcnt vmcnt(0)
  v_readfirstlane_b32 s34, v251
  s_nop 0
  s_cmp_lg_u32 s34, 0
  s_cbranch_scc1 KS_HX
  s_sleep 4
  s_branch KS_HL
KS_HX:
  s_barrier
  buffer_load_dwordx4 v[160:163], v184, s[12:15], 0 offen sc1
  buffer_load_dwordx4 v[172:175], v185, s[12:15], 0 offen sc1
  buffer_load_dwordx4 v[164:167], v184, s[12:15], s25 offen sc1
  buffer_load_dwordx4 v[176:179], v185, s[12:15], s25 offen sc1
  buffer_load_dwordx4 v[168:171], v184, s[12:15], s33 offen sc1
  buffer_load_dwordx4 v[180:183], v185, s[12:15], s33 offen sc1
  s_waitcnt vmcnt(0)
  buffer_load_dword v249, v248, s[68:71], 0 offen
  v_pk_add_f32 v[160:161], v[160:161], v[164:165]
  v_pk_add_f32 v[160:161], v[160:161], v[168:169]
  v_pk_add_f32 v[162:163], v[162:163], v[166:167]
  v_pk_add_f32 v[162:163], v[162:163], v[170:171]
  v_cvt_pk_bf16_f32 v22, v160, v161
  v_cvt_pk_bf16_f32 v23, v162, v163
  v_lshlrev_b32 v160, 16, v22
  v_and_b32 v161, 0xffff0000, v22
  v_lshlrev_b32 v162, 16, v23
  v_and_b32 v163, 0xffff0000, v23
  v_add_f32 v160, v188, v160
  v_add_f32 v161, v188, v161
  v_add_f32 v162, v188, v162
  v_add_f32 v163, v188, v163
  v_cvt_pk_bf16_f32 v22, v160, v161
  v_cvt_pk_bf16_f32 v23, v162, v163
  v_pk_add_f32 v[172:173], v[172:173], v[176:177]
  v_pk_add_f32 v[172:173], v[172:173], v[180:181]
  v_pk_add_f32 v[174:175], v[174:175], v[178:179]
  v_pk_add_f32 v[174:175], v[174:175], v[182:183]
  v_cvt_pk_bf16_f32 v24, v172, v173
  v_cvt_pk_bf16_f32 v25, v174, v175
  v_lshlrev_b32 v172, 16, v24
  v_and_b32 v173, 0xffff0000, v24
  v_lshlrev_b32 v174, 16, v25
  v_and_b32 v175, 0xffff0000, v25
  v_add_f32 v172, 1.0, v172
  v_add_f32 v173, 1.0, v173
  v_add_f32 v174, 1.0, v174
  v_add_f32 v175, 1.0, v175
  v_cvt_pk_bf16_f32 v24, v172, v173
  v_cvt_pk_bf16_f32 v25, v174, v175
  ds_write_b64 v186, v[22:23]
  ds_write_b64 v187, v[24:25]
  v_add_u32 v8, 27648, v8
  v_add_u32 v9, 27648, v9
  s_waitcnt lgkmcnt(0)
  s_barrier
  ds_read_b128 v[22:25], v8 offset:0
  ds_read_b128 v[26:29], v8 offset:512
  ds_read_b32 v30, v9 offset:0
  ds_read_b128 v[32:35], v8 offset:1152
  ds_read_b128 v[36:39], v8 offset:1664
  ds_read_b32 v40, v9 offset:1152
  s_waitcnt lgkmcnt(3)
  v_lshlrev_b32 v114, 16, v22
  v_and_b32 v115, 0xffff0000, v22
  v_lshlrev_b32 v116, 16, v23
  v_and_b32 v117, 0xffff0000, v23
  v_lshlrev_b32 v118, 16, v24
  v_and_b32 v119, 0xffff0000, v24
  v_lshlrev_b32 v120, 16, v25
  v_and_b32 v121, 0xffff0000, v25
  v_lshlrev_b32 v122, 16, v26
  v_and_b32 v123, 0xffff0000, v26
  v_lshlrev_b32 v124, 16, v27
  v_and_b32 v125, 0xffff0000, v27
  v_lshlrev_b32 v126, 16, v28
  v_and_b32 v127, 0xffff0000, v28
  v_lshlrev_b32 v128, 16, v29
  v_and_b32 v129, 0xffff0000, v29
  v_lshlrev_b32 v130, 16, v30
  v_and_b32 v131, 0xffff0000, v30
  s_waitcnt lgkmcnt(0)
  v_lshlrev_b32 v132, 16, v32
  v_and_b32 v133, 0xffff0000, v32
  v_lshlrev_b32 v134, 16, v33
  v_and_b32 v135, 0xffff0000, v33
  v_lshlrev_b32 v136, 16, v34
  v_and_b32 v137, 0xffff0000, v34
  v_lshlrev_b32 v138, 16, v35
  v_and_b32 v139, 0xffff0000, v35
  v_lshlrev_b32 v140, 16, v36
  v_and_b32 v141, 0xffff0000, v36
  v_lshlrev_b32 v142, 16, v37
  v_and_b32 v143, 0xffff0000, v37
  v_lshlrev_b32 v144, 16, v38
  v_and_b32 v145, 0xffff0000, v38
  v_lshlrev_b32 v146, 16, v39
  v_and_b32 v147, 0xffff0000, v39
  v_lshlrev_b32 v148, 16, v40
  v_and_b32 v149, 0xffff0000, v40
  v_pk_fma_f32 v[96:97], v[96:97], v[132:133], v[114:115]
  v_pk_fma_f32 v[98:99], v[98:99], v[134:135], v[116:117]
  v_pk_fma_f32 v[100:101], v[100:101], v[136:137], v[118:119]
  v_pk_fma_f32 v[102:103], v[102:103], v[138:139], v[120:121]
  v_pk_fma_f32 v[104:105], v[104:105], v[140:141], v[122:123]
  v_pk_fma_f32 v[106:107], v[106:107], v[142:143], v[124:125]
  v_pk_fma_f32 v[108:109], v[108:109], v[144:145], v[126:127]
  v_pk_fma_f32 v[110:111], v[110:111], v[146:147], v[128:129]
  v_pk_fma_f32 v[112:113], v[112:113], v[148:149], v[130:131]
  v_cvt_pk_bf16_f32 v12, v96, v97
  v_cvt_pk_bf16_f32 v13, v98, v99
  v_cvt_pk_bf16_f32 v14, v100, v101
  v_cvt_pk_bf16_f32 v15, v102, v103
  v_cvt_pk_bf16_f32 v16, v104, v105
  v_cvt_pk_bf16_f32 v17, v106, v107
  v_cvt_pk_bf16_f32 v18, v108, v109
  v_cvt_pk_bf16_f32 v19, v110, v111
  v_cvt_pk_bf16_f32 v20, v112, v113
  ds_write_b128 v42, v[12:15]
  ds_write_b128 v42, v[16:19] offset:512
  ds_write_b32 v43, v20
  ds_read_b64_tr_b16 v[96:97], v92 offset:0
  ds_read_b64_tr_b16 v[98:99], v93 offset:0
  ds_read_b64_tr_b16 v[100:101], v92 offset:32
  ds_read_b64_tr_b16 v[102:103], v93 offset:32
  ds_read_b64_tr_b16 v[104:105], v92 offset:1152
  ds_read_b64_tr_b16 v[106:107], v93 offset:1152
  ds_read_b64_tr_b16 v[108:109], v92 offset:1184
  ds_read_b64_tr_b16 v[110:111], v93 offset:1184
  s_waitcnt lgkmcnt(4)
  v_mfma_f32_16x16x32_bf16 v[112:115], v[96:99], v[44:47], 0
  v_mfma_f32_16x16x32_bf16 v[116:119], v[96:99], v[48:51], 0
  v_mfma_f32_16x16x32_bf16 v[120:123], v[100:103], v[44:47], 0
  v_mfma_f32_16x16x32_bf16 v[124:127], v[100:103], v[48:51], 0
  s_waitcnt lgkmcnt(0)
  v_mfma_f32_16x16x32_bf16 v[128:131], v[104:107], v[44:47], 0
  v_mfma_f32_16x16x32_bf16 v[132:135], v[104:107], v[48:51], 0
  v_mfma_f32_16x16x32_bf16 v[136:139], v[108:111], v[44:47], 0
  v_mfma_f32_16x16x32_bf16 v[140:143], v[108:111], v[48:51], 0
  s_nop 0
  v_pk_mul_f32 v[8:9], v[116:117], v[60:61]
  v_pk_mul_f32 v[116:117], v[116:117], v[52:53]
  v_pk_fma_f32 v[116:117], v[112:113], v[60:61], v[116:117] neg_lo:[1,0,0] neg_hi:[1,0,0]
  v_pk_fma_f32 v[112:113], v[112:113], v[52:53], v[8:9]
  v_pk_mul_f32 v[8:9], v[118:119], v[62:63]
  v_pk_mul_f32 v[118:119], v[118:119], v[54:55]
  v_pk_fma_f32 v[118:119], v[114:115], v[62:63], v[118:119] neg_lo:[1,0,0] neg_hi:[1,0,0]
  v_pk_fma_f32 v[114:115], v[114:115], v[54:55], v[8:9]
  v_cvt_pk_bf16_f32 v144, v112, v113
  v_cvt_pk_bf16_f32 v145, v114, v115
  v_cvt_pk_bf16_f32 v148, v116, v117
  v_cvt_pk_bf16_f32 v149, v118, v119
  v_pk_mul_f32 v[8:9], v[124:125], v[64:65]
  v_pk_mul_f32 v[124:125], v[124:125], v[56:57]
  v_pk_fma_f32 v[124:125], v[120:121], v[64:65], v[124:125] neg_lo:[1,0,0] neg_hi:[1,0,0]
  v_pk_fma_f32 v[120:121], v[120:121], v[56:57], v[8:9]
  v_pk_mul_f32 v[8:9], v[126:127], v[66:67]
  v_pk_mul_f32 v[126:127], v[126:127], v[58:59]
  v_pk_fma_f32 v[126:127], v[122:123], v[66:67], v[126:127] neg_lo:[1,0,0] neg_hi:[1,0,0]
  v_pk_fma_f32 v[122:123], v[122:123], v[58:59], v[8:9]
  v_cvt_pk_bf16_f32 v146, v120, v121
  v_cvt_pk_bf16_f32 v147, v122, v123
  v_cvt_pk_bf16_f32 v150, v124, v125
  v_cvt_pk_bf16_f32 v151, v126, v127
  v_mfma_f32_16x16x32_bf16 v[160:163], v[68:71], v[144:147], 0
  v_mul_f32 v8, v132, v60
  v_mul_f32 v132, v132, v52
  v_mfma_f32_16x16x32_bf16 v[160:163], v[72:75], v[148:151], v[160:163]
  v_fma_f32 v132, -v128, v60, v132
  v_fma_f32 v128, v128, v52, v8
  v_mfma_f32_16x16x32_bf16 v[164:167], v[68:71], v[148:151], 0
  v_mul_f32 v9, v133, v61
  v_mul_f32 v133, v133, v53
  v_mfma_f32_16x16x32_bf16 v[164:167], v[76:79], v[144:147], v[164:167]
  v_fma_f32 v133, -v129, v61, v133
  v_fma_f32 v129, v129, v53, v9
  v_mfma_f32_16x16x32_bf16 v[168:171], v[80:83], v[144:147], 0
  v_mul_f32 v8, v134, v62
  v_mul_f32 v134, v134, v54
  v_mfma_f32_16x16x32_bf16 v[168:171], v[84:87], v[148:151], v[168:171]
  v_fma_f32 v134, -v130, v62, v134
  v_fma_f32 v130, v130, v54, v8
  v_mfma_f32_16x16x32_bf16 v[172:175], v[88:91], v[148:151], 0
  v_mul_f32 v9, v135, v63
  v_mul_f32 v135, v135, v55
  v_mfma_f32_16x16x32_bf16 v[172:175], v[84:87], v[144:147], v[172:175]
  v_fma_f32 v135, -v131, v63, v135
  v_fma_f32 v131, v131, v55, v9
  v_cvt_pk_bf16_f32 v152, v128, v129
  v_cvt_pk_bf16_f32 v153, v130, v131
  v_cvt_pk_bf16_f32 v156, v132, v133
  v_cvt_pk_bf16_f32 v157, v134, v135
  v_pk_mul_f32 v[8:9], v[140:141], v[64:65]
  v_pk_mul_f32 v[140:141], v[140:141], v[56:57]
  v_pk_fma_f32 v[140:141], v[136:137], v[64:65], v[140:141] neg_lo:[1,0,0] neg_hi:[1,0,0]
  v_pk_fma_f32 v[136:137], v[136:137], v[56:57], v[8:9]
  v_pk_mul_f32 v[8:9], v[142:143], v[66:67]
  v_pk_mul_f32 v[142:143], v[142:143], v[58:59]
  v_pk_fma_f32 v[142:143], v[138:139], v[66:67], v[142:143] neg_lo:[1,0,0] neg_hi:[1,0,0]
  v_pk_fma_f32 v[138:139], v[138:139], v[58:59], v[8:9]
  v_cvt_pk_bf16_f32 v154, v136, v137
  v_cvt_pk_bf16_f32 v155, v138, v139
  v_cvt_pk_bf16_f32 v158, v140, v141
  v_cvt_pk_bf16_f32 v159, v142, v143
  v_mfma_f32_16x16x32_bf16 v[176:179], v[68:71], v[152:155], 0
  s_nop 0
  v_mfma_f32_16x16x32_bf16 v[176:179], v[72:75], v[156:159], v[176:179]
  v_mfma_f32_16x16x32_bf16 v[180:183], v[68:71], v[156:159], 0
  v_mfma_f32_16x16x32_bf16 v[180:183], v[76:79], v[152:155], v[180:183]
  v_mfma_f32_16x16x32_bf16 v[184:187], v[80:83], v[152:155], 0
  v_mfma_f32_16x16x32_bf16 v[184:187], v[84:87], v[156:159], v[184:187]
  v_mfma_f32_16x16x32_bf16 v[188:191], v[88:91], v[156:159], 0
  v_mfma_f32_16x16x32_bf16 v[188:191], v[84:87], v[152:155], v[188:191]
  s_mov_b32 exec_lo, 0x03ff03ff
  s_mov_b32 exec_hi, 0x03ff03ff
  v_pk_add_f32 v[112:113], v[160:161], v[176:177]
  v_pk_add_f32 v[176:177], v[160:161], v[176:177] neg_lo:[0,1] neg_hi:[0,1]
  v_pk_add_f32 v[114:115], v[162:163], v[178:179]
  v_pk_add_f32 v[178:179], v[162:163], v[178:179] neg_lo:[0,1] neg_hi:[0,1]
  v_pk_add_f32 v[116:117], v[164:165], v[180:181]
  v_pk_add_f32 v[180:181], v[164:165], v[180:181] neg_lo:[0,1] neg_hi:[0,1]
  v_pk_add_f32 v[118:119], v[166:167], v[182:183]
  v_pk_add_f32 v[182:183], v[166:167], v[182:183] neg_lo:[0,1] neg_hi:[0,1]
  v_cvt_pk_bf16_f32 v12, v112, v116
  v_cvt_pk_bf16_f32 v13, v176, v180
  ds_write_b64 v41, v[12:13] offset:0
  v_cvt_pk_bf16_f32 v14, v113, v117
  v_cvt_pk_bf16_f32 v15, v177, v181
  ds_write_b64 v94, v[14:15] offset:720
  v_cvt_pk_bf16_f32 v16, v114, v118
  v_cvt_pk_bf16_f32 v17, v178, v182
  ds_write_b64 v94, v[16:17] offset:1440
  v_cvt_pk_bf16_f32 v18, v115, v119
  v_cvt_pk_bf16_f32 v19, v179, v183
  ds_write_b64 v94, v[18:19] offset:2160
  v_pk_add_f32 v[112:113], v[168:169], v[184:185]
  v_pk_add_f32 v[184:185], v[168:169], v[184:185] neg_lo:[0,1] neg_hi:[0,1]
  v_pk_add_f32 v[114:115], v[170:171], v[186:187]
  v_pk_add_f32 v[186:187], v[170:171], v[186:187] neg_lo:[0,1] neg_hi:[0,1]
  v_pk_add_f32 v[116:117], v[172:173], v[188:189]
  v_pk_add_f32 v[188:189], v[172:173], v[188:189] neg_lo:[0,1] neg_hi:[0,1]
  v_pk_add_f32 v[118:119], v[174:175], v[190:191]
  v_pk_add_f32 v[190:191], v[174:175], v[190:191] neg_lo:[0,1] neg_hi:[0,1]
  v_cvt_pk_bf16_f32 v20, v112, v116
  v_cvt_pk_bf16_f32 v21, v184, v188
  ds_write_b64 v4, v[20:21] offset:0
  v_cvt_pk_bf16_f32 v22, v113, v117
  v_cvt_pk_bf16_f32 v23, v185, v189
  ds_write_b64 v95, v[22:23] offset:1440
  v_cvt_pk_bf16_f32 v24, v114, v118
  v_cvt_pk_bf16_f32 v25, v186, v190
  ds_write_b64 v95, v[24:25] offset:720
  v_cvt_pk_bf16_f32 v26, v115, v119
  v_cvt_pk_bf16_f32 v27, v187, v191
  ds_write_b64 v95, v[26:27] offset:0
  s_mov_b64 exec, -1
  s_waitcnt lgkmcnt(0)
  s_barrier
  ds_read_b64_tr_b16 v[16:17], v6 offset:0
  ds_read_b64_tr_b16 v[18:19], v6 offset:40
  ds_read_b64_tr_b16 v[20:21], v6 offset:5120
  ds_read_b64_tr_b16 v[22:23], v6 offset:5160
  ds_read_b64_tr_b16 v[24:25], v6 offset:10240
  ds_read_b64_tr_b16 v[26:27], v6 offset:10280
  s_waitcnt lgkmcnt(4)
  buffer_store_dwordx4 v[16:19], v7, s[16:19], s28 offen sc1
  s_waitcnt lgkmcnt(2)
  buffer_store_dwordx4 v[20:23], v7, s[16:19], s29 offen sc1
  s_waitcnt lgkmcnt(0)
  buffer_store_dwordx4 v[24:27], v7, s[16:19], s30 offen sc1
  v_cmp_gt_u32 vcc, 16, v0
  v_lshlrev_b32 v12, 11, v0
  v_mov_b32 v13, 1073741824
  v_cndmask_b32 v12, v13, v12, vcc
  v_mov_b32 v13, 1
  s_and_b32 s24, s2, 15
  s_lshl_b32 s24, s24, 7
  s_add_u32 s24, s24, 16007168
  s_waitcnt vmcnt(0)
  s_barrier
  buffer_atomic_add v13, v12, s[48:51], s24 offen sc1
  s_branch KM_A
.p2align 12
KM_A:
  s_mov_b32 s39, 16007168
  s_cmp_ge_u32 s2, 145
  s_cbranch_scc1 KM_J0
KM_P2:
  s_load_dwordx2 s[40:41], s[0:1], 88
  v_lshrrev_b32 v1, 6, v0
  v_and_b32 v2, 63, v0
  v_and_b32 v10, 15, v0
  v_bfe_u32 v11, v0, 4, 2
  v_readfirstlane_b32 s21, v1
  s_lshl_b32 s22, s2, 1
  s_add_u32 s23, s22, 1
  s_cmp_eq_u32 s2, 0
  s_cselect_b32 s23, 288, s23
  s_mov_b32 s26, 0x3cb504f3
  s_cselect_b32 s26, 0x3c800000, s26
  s_cmp_eq_u32 s2, 144
  s_cselect_b32 s22, 1, s22
  s_cselect_b32 s23, 1, s23
  s_cselect_b32 s31, 4, 8
  s_and_b32 s34, s21, 1
  s_lshr_b32 s35, s21, 1
  v_lshrrev_b32 v3, 5, v2
  v_and_b32 v4, 1, v1
  v_lshlrev_b32 v4, 3, v4
  v_lshl_or_b32 v4, v3, 2, v4
  v_and_b32 v5, 31, v2
  v_xor_b32 v4, v4, v5
  v_lshl_add_u32 v3, v1, 3, v3
  v_lshlrev_b32 v3, 9, v3
  v_lshl_add_u32 v3, v4, 4, v3
  v_xor_b32 v4, 32, v3
  v_xor_b32 v5, 16, v3
  v_xor_b32 v6, 48, v3
  s_lshl_b32 s25, s21, 12
  s_lshl_b32 s24, s2, 14
  s_lshl_b32 s28, s22, 13
  s_lshl_b32 s29, s23, 13
  s_add_u32 s30, s28, 4096
  s_add_u32 s27, s29, 4096
  s_lshl_b32 s36, s35, 4
  v_add_u32 v13, s36, v10
  v_lshl_add_u32 v12, v13, 1, s34
  v_lshlrev_b32 v7, 4, v12
  v_lshl_add_u32 v7, v11, 10, v7
  v_cvt_f32_u32 v8, v12
  v_cvt_f32_u32 v9, v11
  v_cvt_f32_u32 v14, v10
  v_cvt_f32_u32 v15, v13
  v_mul_f32 v160, 0x3c800000, v8
  v_mul_f32 v170, 4.0, v9
  v_mul_f32 v170, v170, v160
  v_fma_f32 v171, v160, 1.0, v170
  v_fma_f32 v172, v160, 2.0, v170
  v_add_f32 v173, v172, v160
  v_mul_f32 v160, 0x3e800000, v8
  v_add_f32 v174, v170, v160
  v_add_f32 v175, v171, v160
  v_add_f32 v176, v172, v160
  v_add_f32 v177, v173, v160
  v_mul_f32 v161, 0x3a000000, v8
  v_mul_f32 v128, 4.0, v9
  v_mul_f32 v128, v128, v161
  v_mul_f32 v160, 0x41800000, v161
  v_add_f32 v132, v128, v160
  v_fma_f32 v129, v161, 1.0, v128
  v_fma_f32 v130, v161, 2.0, v128
  v_add_f32 v131, v130, v161
  v_fma_f32 v133, v161, 1.0, v132
  v_fma_f32 v134, v161, 2.0, v132
  v_add_f32 v135, v134, v161
  v_mul_f32 v243, 0x3c800000, v15
  s_waitcnt lgkmcnt(0)
  s_add_u32 s8, s40, 3145728
  s_addc_u32 s9, s41, 0
  s_mov_b32 s10, 2375680
  s_mov_b32 s11, 0x20000
  s_add_u32 s12, s40, 65536
  s_addc_u32 s13, s41, 0
  s_mov_b32 s14, 2367488
  s_mov_b32 s15, 0x20000
  s_add_u32 s16, s40, 6291456
  s_addc_u32 s17, s41, 0
  s_mov_b32 s18, 2375680
  s_mov_b32 s19, 0x20000
  v_cos_f32 v162, v170
  v_cos_f32 v163, v171
  v_cos_f32 v164, v172
  v_cos_f32 v165, v173
  v_cos_f32 v166, v174
  v_cos_f32 v167, v175
  v_cos_f32 v168, v176
  v_cos_f32 v169, v177
  v_sin_f32 v170, v170
  v_sin_f32 v171, v171
  v_sin_f32 v172, v172
  v_sin_f32 v173, v173
  v_sin_f32 v174, v174
  v_sin_f32 v175, v175
  v_sin_f32 v176, v176
  v_sin_f32 v177, v177
  v_cos_f32 v242, v243
  v_sin_f32 v243, v243
  v_cvt_pk_bf16_f32 v96, v162, v163
  v_cvt_pk_bf16_f32 v104, v170, v171
  v_cvt_pk_bf16_f32 v97, v164, v165
  v_cvt_pk_bf16_f32 v105, v172, v173
  v_cvt_pk_bf16_f32 v98, v166, v167
  v_cvt_pk_bf16_f32 v106, v174, v175
  v_cvt_pk_bf16_f32 v99, v168, v169
  v_cvt_pk_bf16_f32 v107, v176, v177
  v_xor_b32 v100, 0x80008000, v104
  v_xor_b32 v101, 0x80008000, v105
  v_xor_b32 v102, 0x80008000, v106
  v_xor_b32 v103, 0x80008000, v107
  v_and_b32 v210, 10, v10
  v_bfe_u32 v211, v10, 2, 1
  v_or_b32 v210, v210, v211
  v_and_b32 v211, 1, v10
  v_lshl_or_b32 v210, v211, 2, v210
  v_lshlrev_b32 v211, 2, v11
  v_xor_b32 v210, v210, v211
  v_lshlrev_b32 v210, 4, v210
  v_lshl_add_u32 v210, v10, 9, v210
  v_add_u32 v244, 16384, v210
  s_lshl_b32 s36, s34, 5
  v_xor_b32 v244, s36, v244
  v_xor_b32 v245, 16, v244
  v_bfe_u32 v210, v10, 1, 1
  v_bfe_u32 v211, v10, 3, 1
  v_lshl_or_b32 v210, v211, 1, v210
  v_bfe_u32 v211, v10, 2, 1
  v_lshl_or_b32 v210, v211, 2, v210
  v_xor_b32 v210, v210, v11
  v_lshlrev_b32 v210, 3, v210
  v_lshl_add_u32 v248, v13, 6, v210
  s_lshl_b32 s36, s34, 11
  v_add_u32 v248, s36, v248
  v_xor_b32 v249, 32, v248
  v_lshrrev_b32 v210, 2, v10
  v_lshl_add_u32 v211, v11, 2, v210
  v_lshlrev_b32 v211, 6, v211
  v_lshrrev_b32 v210, 1, v210
  v_lshrrev_b32 v212, 1, v11
  v_lshl_or_b32 v210, v212, 1, v210
  v_and_b32 v212, 1, v11
  v_lshl_or_b32 v210, v212, 2, v210
  v_and_b32 v212, 3, v10
  v_xor_b32 v210, v210, v212
  s_lshl_b32 s36, s34, 2
  v_xor_b32 v210, s36, v210
  v_lshl_add_u32 v240, v210, 3, v211
  v_and_b32 v210, 7, v10
  v_xor_b32 v210, v210, v11
  v_lshlrev_b32 v210, 4, v210
  v_lshl_add_u32 v250, v10, 7, v210
  v_lshl_add_u32 v250, v1, 12, v250
  v_add_u32 v250, 32768, v250
  v_xor_b32 v251, 64, v250
  v_lshrrev_b32 v210, 3, v2
  v_lshlrev_b32 v210, 4, v210
  v_lshlrev_b32 v252, 4, v2
  v_xor_b32 v252, v252, v210
  v_lshl_add_u32 v252, v1, 12, v252
  v_add_u32 v252, 32768, v252
  v_mov_b32 v210, s22
  v_mov_b32 v211, s23
  v_bfe_u32 v212, v2, 2, 1
  v_cmp_eq_u32 vcc, 1, v212
  v_and_b32 v212, 3, v2
  s_nop 0
  v_cndmask_b32 v210, v210, v211, vcc
  v_bfe_u32 v211, v210, 2, 2
  v_xor_b32 v211, v211, v212
  v_lshlrev_b32 v211, 4, v211
  v_lshl_add_u32 v211, v210, 6, v211
  s_lshl_b32 s36, s35, 5
  s_add_u32 s36, s36, s34
  v_lshrrev_b32 v253, 3, v2
  v_lshl_add_u32 v253, v253, 1, s36
  v_mul_u32_u24 v253, 18560, v253
  v_add_u32 v253, v253, v211
  v_and_b32 v210, 7, v2
  v_cmp_gt_u32 vcc, s31, v210
  v_mov_b32 v210, 1073741824
  s_nop 0
  v_cndmask_b32 v253, v210, v253, vcc
  v_cos_f32 v120, v128
  v_cos_f32 v121, v129
  v_cos_f32 v122, v130
  v_cos_f32 v123, v131
  v_cos_f32 v124, v132
  v_cos_f32 v125, v133
  v_cos_f32 v126, v134
  v_cos_f32 v127, v135
  v_sin_f32 v128, v128
  v_sin_f32 v129, v129
  v_sin_f32 v130, v130
  v_sin_f32 v131, v131
  v_sin_f32 v132, v132
  v_sin_f32 v133, v133
  v_sin_f32 v134, v134
  v_sin_f32 v135, v135
  v_mul_f32 v192, 0x3d000000, v14
  v_mul_f32 v197, 4.0, v9
  v_mul_f32 v197, v197, v192
  v_fma_f32 v198, v192, 1.0, v197
  v_fma_f32 v199, v192, 2.0, v197
  v_add_f32 v200, v199, v192
  v_and_b32 v201, 1, v10
  v_mul_u32_u24 v201, 0x8000, v201
  v_cos_f32 v193, v197
  v_cos_f32 v194, v198
  v_cos_f32 v195, v199
  v_cos_f32 v196, v200
  v_sin_f32 v197, v197
  v_sin_f32 v198, v198
  v_sin_f32 v199, v199
  v_sin_f32 v200, v200
  v_lshl_or_b32 v201, v201, 16, v201
  v_cvt_pk_bf16_f32 v136, v193, v194
  v_cvt_pk_bf16_f32 v137, v195, v196
  v_cvt_pk_bf16_f32 v152, v197, v198
  v_cvt_pk_bf16_f32 v153, v199, v200
  v_xor_b32 v138, v136, v201
  v_xor_b32 v139, v137, v201
  v_xor_b32 v154, v152, v201
  v_xor_b32 v155, v153, v201
  v_pk_mul_f32 v[120:121], v[120:121], s[26:27] op_sel_hi:[1,0]
  v_pk_mul_f32 v[122:123], v[122:123], s[26:27] op_sel_hi:[1,0]
  v_pk_mul_f32 v[124:125], v[124:125], s[26:27] op_sel_hi:[1,0]
  v_pk_mul_f32 v[126:127], v[126:127], s[26:27] op_sel_hi:[1,0]
  v_pk_mul_f32 v[128:129], v[128:129], s[26:27] op_sel_hi:[1,0]
  v_pk_mul_f32 v[130:131], v[130:131], s[26:27] op_sel_hi:[1,0]
  v_pk_mul_f32 v[132:133], v[132:133], s[26:27] op_sel_hi:[1,0]
  v_pk_mul_f32 v[134:135], v[134:135], s[26:27] op_sel_hi:[1,0]
  v_xor_b32 v140, 0x80000000, v136
  v_xor_b32 v141, 0x80000000, v137
  v_xor_b32 v142, 0x80000000, v138
  v_xor_b32 v143, 0x80000000, v139
  v_xor_b32 v156, 0x80000000, v152
  v_xor_b32 v157, 0x80000000, v153
  v_xor_b32 v158, 0x80000000, v154
  v_xor_b32 v159, 0x80000000, v155
  v_xor_b32 v144, 0x80008000, v152
  v_xor_b32 v145, 0x80008000, v153
  v_xor_b32 v146, 0x80008000, v154
  v_xor_b32 v147, 0x80008000, v155
  v_xor_b32 v148, 0x80008000, v156
  v_xor_b32 v149, 0x80008000, v157
  v_xor_b32 v150, 0x80008000, v158
  v_xor_b32 v151, 0x80008000, v159
  s_lshl_b32 s36, s35, 31
  v_xor_b32 v108, s36, v136
  v_xor_b32 v109, s36, v137
  v_xor_b32 v110, s36, v138
  v_xor_b32 v111, s36, v139
  v_xor_b32 v112, s36, v144
  v_xor_b32 v113, s36, v145
  v_xor_b32 v114, s36, v146
  v_xor_b32 v115, s36, v147
  v_xor_b32 v116, s36, v152
  v_xor_b32 v117, s36, v153
  v_xor_b32 v118, s36, v154
  v_xor_b32 v119, s36, v155
  s_mov_b32 s36, 296960
  s_mov_b32 s37, 1187840
  s_mov_b32 s38, 1484800
  s_cmp_lg_u32 s21, 0
  s_cbranch_scc1 KM_WA_O
  v_and_b32 v200, 63, v0
  v_cmp_gt_u32 vcc, 16, v200
  v_lshlrev_b32 v200, 7, v200
  v_mov_b32 v201, 1073741824
  v_cndmask_b32 v200, v201, v200, vcc
  s_lshr_b32 s32, s2, 4
  s_lshl_b32 s32, s32, 11
  s_add_u32 s32, s32, s39
  s_mov_b32 s33, 200000
KM_WA_P:
  buffer_load_dword v201, v200, s[48:51], s32 offen sc1
  s_sub_u32 s33, s33, 1
  s_cmp_eq_u32 s33, 0
  s_cbranch_scc1 KM_WA_X
  s_waitcnt vmcnt(0)
  v_cmp_ne_u32 vcc, 16, v201
  s_nop 0
  s_and_b32 s34, vcc_lo, 0xffff
  s_cbranch_scc0 KM_WA_X
  s_sleep 4
  s_branch KM_WA_P
KM_WA_O:
  s_cmp_lg_u32 s21, 2
  s_cbranch_scc1 KM_WA_X
  s_mov_b64 exec, 0
  s_branch KA_I0
KA_BACK:
  s_mov_b64 exec, -1
KM_WA_X:
  s_barrier
  s_add_u32 m0, s25, 16384
  s_nop 0
  buffer_load_dwordx4 v3, s[8:11], s24 offen offset:0 sc1 lds
  buffer_load_dwordx4 v4, s[8:11], s24 offen offset:1024 sc1 lds
  buffer_load_dwordx4 v5, s[8:11], s24 offen offset:2048 sc1 lds
  buffer_load_dwordx4 v6, s[8:11], s24 offen offset:3072 sc1 lds
  buffer_load_dwordx4 v[80:83], v7, s[12:15], s28 offen sc1
  buffer_load_dwordx4 v[84:87], v7, s[12:15], s30 offen sc1
  buffer_load_dwordx4 v[88:91], v7, s[12:15], s29 offen sc1
  buffer_load_dwordx4 v[92:95], v7, s[12:15], s27 offen sc1
  s_waitcnt vmcnt(4)
  s_barrier
  ds_read_b128 v[16:19], v244 offset:0
  ds_read_b128 v[20:23], v244 offset:256
  ds_read_b128 v[24:27], v245 offset:0
  ds_read_b128 v[28:31], v245 offset:256
  ds_read_b128 v[32:35], v244 offset:8192
  ds_read_b128 v[36:39], v244 offset:8448
  ds_read_b128 v[40:43], v245 offset:8192
  ds_read_b128 v[44:47], v245 offset:8448
  s_waitcnt lgkmcnt(4)
  v_swap_b32 v18, v20
  v_swap_b32 v19, v21
  v_swap_b32 v26, v28
  v_swap_b32 v27, v29
  v_mfma_f32_16x16x32_bf16 v[160:163], v[16:19], v[96:99], 0
  s_nop 0
  v_mfma_f32_16x16x32_bf16 v[160:163], v[24:27], v[104:107], v[160:163]
  s_waitcnt lgkmcnt(0)
  v_swap_b32 v34, v36
  v_mfma_f32_16x16x32_bf16 v[164:167], v[16:19], v[100:103], 0
  v_swap_b32 v35, v37
  v_swap_b32 v42, v44
  v_mfma_f32_16x16x32_bf16 v[164:167], v[24:27], v[96:99], v[164:167]
  v_swap_b32 v43, v45
  v_mfma_f32_16x16x32_bf16 v[168:171], v[32:35], v[96:99], 0
  s_nop 0
  v_mfma_f32_16x16x32_bf16 v[168:171], v[40:43], v[104:107], v[168:171]
  v_mfma_f32_16x16x32_bf16 v[172:175], v[32:35], v[100:103], 0
  v_mfma_f32_16x16x32_bf16 v[172:175], v[40:43], v[96:99], v[172:175]
  v_mfma_f32_16x16x32_bf16 v[176:179], v[20:23], v[96:99], 0
  s_nop 0
  v_mul_f32 v8, v164, v128
  v_mul_f32 v164, v164, v120
  v_mfma_f32_16x16x32_bf16 v[176:179], v[28:31], v[104:107], v[176:179]
  v_fma_f32 v164, -v160, v128, v164
  v_fma_f32 v160, v160, v120, v8
  v_mfma_f32_16x16x32_bf16 v[180:183], v[20:23], v[100:103], 0
  v_mul_f32 v9, v165, v129
  v_mul_f32 v165, v165, v121
  v_mfma_f32_16x16x32_bf16 v[180:183], v[28:31], v[96:99], v[180:183]
  v_fma_f32 v165, -v161, v129, v165
  v_fma_f32 v161, v161, v121, v9
  v_mfma_f32_16x16x32_bf16 v[184:187], v[36:39], v[96:99], 0
  v_mul_f32 v8, v166, v130
  v_mul_f32 v166, v166, v122
  v_mfma_f32_16x16x32_bf16 v[184:187], v[44:47], v[104:107], v[184:187]
  v_fma_f32 v166, -v162, v130, v166
  v_fma_f32 v162, v162, v122, v8
  v_mfma_f32_16x16x32_bf16 v[188:191], v[36:39], v[100:103], 0
  v_mul_f32 v9, v167, v131
  v_mul_f32 v167, v167, v123
  v_mfma_f32_16x16x32_bf16 v[188:191], v[44:47], v[96:99], v[188:191]
  v_fma_f32 v167, -v163, v131, v167
  v_fma_f32 v163, v163, v123, v9
  v_cvt_pk_bf16_f32 v224, v160, v161
  v_cvt_pk_bf16_f32 v225, v162, v163
  v_cvt_pk_bf16_f32 v228, v164, v165
  v_cvt_pk_bf16_f32 v229, v166, v167
  v_pk_mul_f32 v[8:9], v[172:173], v[132:133]
  v_pk_mul_f32 v[172:173], v[172:173], v[124:125]
  v_pk_fma_f32 v[172:173], v[168:169], v[132:133], v[172:173] neg_lo:[1,0,0] neg_hi:[1,0,0]
  v_pk_fma_f32 v[168:169], v[168:169], v[124:125], v[8:9]
  v_pk_mul_f32 v[8:9], v[174:175], v[134:135]
  v_pk_mul_f32 v[174:175], v[174:175], v[126:127]
  v_pk_fma_f32 v[174:175], v[170:171], v[134:135], v[174:175] neg_lo:[1,0,0] neg_hi:[1,0,0]
  v_pk_fma_f32 v[170:171], v[170:171], v[126:127], v[8:9]
  v_cvt_pk_bf16_f32 v226, v168, v169
  v_cvt_pk_bf16_f32 v227, v170, v171
  v_cvt_pk_bf16_f32 v230, v172, v173
  v_cvt_pk_bf16_f32 v231, v174, v175
  v_mfma_f32_16x16x32_bf16 v[192:195], v[136:139], v[224:227], 0
  v_mul_f32 v8, v180, v128
  v_mul_f32 v180, v180, v120
  v_mfma_f32_16x16x32_bf16 v[192:195], v[152:155], v[228:231], v[192:195]
  v_fma_f32 v180, -v176, v128, v180
  v_fma_f32 v176, v176, v120, v8
  v_mfma_f32_16x16x32_bf16 v[196:199], v[136:139], v[228:231], 0
  v_mul_f32 v9, v181, v129
  v_mul_f32 v181, v181, v121
  v_mfma_f32_16x16x32_bf16 v[196:199], v[144:147], v[224:227], v[196:199]
  v_fma_f32 v181, -v177, v129, v181
  v_fma_f32 v177, v177, v121, v9
  v_mfma_f32_16x16x32_bf16 v[200:203], v[140:143], v[224:227], 0
  v_mul_f32 v8, v182, v130
  v_mul_f32 v182, v182, v122
  v_mfma_f32_16x16x32_bf16 v[200:203], v[156:159], v[228:231], v[200:203]
  v_fma_f32 v182, -v178, v130, v182
  v_fma_f32 v178, v178, v122, v8
  v_mfma_f32_16x16x32_bf16 v[204:207], v[140:143], v[228:231], 0
  v_mul_f32 v9, v183, v131
  v_mul_f32 v183, v183, v123
  v_mfma_f32_16x16x32_bf16 v[204:207], v[148:151], v[224:227], v[204:207]
  v_fma_f32 v183, -v179, v131, v183
  v_fma_f32 v179, v179, v123, v9
  v_cvt_pk_bf16_f32 v232, v176, v177
  v_cvt_pk_bf16_f32 v233, v178, v179
  v_cvt_pk_bf16_f32 v236, v180, v181
  v_cvt_pk_bf16_f32 v237, v182, v183
  v_pk_mul_f32 v[8:9], v[188:189], v[132:133]
  v_pk_mul_f32 v[188:189], v[188:189], v[124:125]
  v_pk_fma_f32 v[188:189], v[184:185], v[132:133], v[188:189] neg_lo:[1,0,0] neg_hi:[1,0,0]
  v_pk_fma_f32 v[184:185], v[184:185], v[124:125], v[8:9]
  v_pk_mul_f32 v[8:9], v[190:191], v[134:135]
  v_pk_mul_f32 v[190:191], v[190:191], v[126:127]
  v_pk_fma_f32 v[190:191], v[186:187], v[134:135], v[190:191] neg_lo:[1,0,0] neg_hi:[1,0,0]
  v_pk_fma_f32 v[186:187], v[186:187], v[126:127], v[8:9]
  v_cvt_pk_bf16_f32 v234, v184, v185
  v_cvt_pk_bf16_f32 v235, v186, v187
  v_cvt_pk_bf16_f32 v238, v188, v189
  v_cvt_pk_bf16_f32 v239, v190, v191
  s_waitcnt vmcnt(0)
  v_mfma_f32_16x16x32_bf16 v[208:211], v[136:139], v[232:235], 0
  v_lshlrev_b32 v48, 16, v80
  v_and_b32 v56, 0xffff0000, v80
  v_mfma_f32_16x16x32_bf16 v[208:211], v[152:155], v[236:239], v[208:211]
  v_lshlrev_b32 v49, 16, v81
  v_and_b32 v57, 0xffff0000, v81
  v_mfma_f32_16x16x32_bf16 v[212:215], v[136:139], v[236:239], 0
  v_lshlrev_b32 v50, 16, v82
  v_and_b32 v58, 0xffff0000, v82
  v_mfma_f32_16x16x32_bf16 v[212:215], v[144:147], v[232:235], v[212:215]
  v_lshlrev_b32 v51, 16, v83
  v_and_b32 v59, 0xffff0000, v83
  v_mfma_f32_16x16x32_bf16 v[216:219], v[140:143], v[232:235], 0
  v_lshlrev_b32 v52, 16, v84
  v_and_b32 v60, 0xffff0000, v84
  v_mfma_f32_16x16x32_bf16 v[216:219], v[156:159], v[236:239], v[216:219]
  v_lshlrev_b32 v53, 16, v85
  v_and_b32 v61, 0xffff0000, v85
  v_mfma_f32_16x16x32_bf16 v[220:223], v[140:143], v[236:239], 0
  v_lshlrev_b32 v54, 16, v86
  v_and_b32 v62, 0xffff0000, v86
  v_mfma_f32_16x16x32_bf16 v[220:223], v[148:151], v[232:235], v[220:223]
  v_lshlrev_b32 v55, 16, v87
  v_and_b32 v63, 0xffff0000, v87
  v_pk_mul_f32 v[8:9], v[196:197], v[56:57]
  v_pk_mul_f32 v[196:197], v[196:197], v[48:49]
  v_pk_fma_f32 v[196:197], v[192:193], v[56:57], v[196:197]
  v_pk_fma_f32 v[192:193], v[192:193], v[48:49], v[8:9] neg_lo:[0,0,1] neg_hi:[0,0,1]
  v_pk_mul_f32 v[8:9], v[198:199], v[58:59]
  v_pk_mul_f32 v[198:199], v[198:199], v[50:51]
  v_pk_fma_f32 v[198:199], v[194:195], v[58:59], v[198:199]
  v_pk_fma_f32 v[194:195], v[194:195], v[50:51], v[8:9] neg_lo:[0,0,1] neg_hi:[0,0,1]
  v_cvt_pk_bf16_f32 v224, v192, v193
  v_cvt_pk_bf16_f32 v225, v194, v195
  v_cvt_pk_bf16_f32 v228, v196, v197
  v_cvt_pk_bf16_f32 v229, v198, v199
  v_pk_mul_f32 v[8:9], v[204:205], v[60:61]
  v_pk_mul_f32 v[204:205], v[204:205], v[52:53]
  v_pk_fma_f32 v[204:205], v[200:201], v[60:61], v[204:205]
  v_pk_fma_f32 v[200:201], v[200:201], v[52:53], v[8:9] neg_lo:[0,0,1] neg_hi:[0,0,1]
  v_pk_mul_f32 v[8:9], v[206:207], v[62:63]
  v_pk_mul_f32 v[206:207], v[206:207], v[54:55]
  v_pk_fma_f32 v[206:207], v[202:203], v[62:63], v[206:207]
  v_pk_fma_f32 v[202:203], v[202:203], v[54:55], v[8:9] neg_lo:[0,0,1] neg_hi:[0,0,1]
  v_cvt_pk_bf16_f32 v226, v200, v201
  v_cvt_pk_bf16_f32 v227, v202, v203
  v_cvt_pk_bf16_f32 v230, v204, v205
  v_cvt_pk_bf16_f32 v231, v206, v207
  v_mfma_f32_16x16x32_bf16 v[160:163], v[136:139], v[224:227], 0
  v_lshlrev_b32 v64, 16, v88
  v_and_b32 v72, 0xffff0000, v88
  v_mfma_f32_16x16x32_bf16 v[160:163], v[144:147], v[228:231], v[160:163]
  v_lshlrev_b32 v65, 16, v89
  v_and_b32 v73, 0xffff0000, v89
  v_mfma_f32_16x16x32_bf16 v[164:167], v[136:139], v[228:231], 0
  v_lshlrev_b32 v66, 16, v90
  v_and_b32 v74, 0xffff0000, v90
  v_mfma_f32_16x16x32_bf16 v[164:167], v[152:155], v[224:227], v[164:167]
  v_lshlrev_b32 v67, 16, v91
  v_and_b32 v75, 0xffff0000, v91
  v_mfma_f32_16x16x32_bf16 v[168:171], v[140:143], v[224:227], 0
  v_lshlrev_b32 v68, 16, v92
  v_and_b32 v76, 0xffff0000, v92
  v_mfma_f32_16x16x32_bf16 v[168:171], v[148:151], v[228:231], v[168:171]
  v_lshlrev_b32 v69, 16, v93
  v_and_b32 v77, 0xffff0000, v93
  v_mfma_f32_16x16x32_bf16 v[172:175], v[140:143], v[228:231], 0
  v_lshlrev_b32 v70, 16, v94
  v_and_b32 v78, 0xffff0000, v94
  v_mfma_f32_16x16x32_bf16 v[172:175], v[156:159], v[224:227], v[172:175]
  v_lshlrev_b32 v71, 16, v95
  v_and_b32 v79, 0xffff0000, v95
  v_pk_mul_f32 v[8:9], v[212:213], v[72:73]
  v_pk_mul_f32 v[212:213], v[212:213], v[64:65]
  v_pk_fma_f32 v[212:213], v[208:209], v[72:73], v[212:213]
  v_pk_fma_f32 v[208:209], v[208:209], v[64:65], v[8:9] neg_lo:[0,0,1] neg_hi:[0,0,1]
  v_pk_mul_f32 v[8:9], v[214:215], v[74:75]
  v_pk_mul_f32 v[214:215], v[214:215], v[66:67]
  v_pk_fma_f32 v[214:215], v[210:211], v[74:75], v[214:215]
  v_pk_fma_f32 v[210:211], v[210:211], v[66:67], v[8:9] neg_lo:[0,0,1] neg_hi:[0,0,1]
  v_cvt_pk_bf16_f32 v232, v208, v209
  v_cvt_pk_bf16_f32 v233, v210, v211
  v_cvt_pk_bf16_f32 v236, v212, v213
  v_cvt_pk_bf16_f32 v237, v214, v215
  v_pk_mul_f32 v[8:9], v[220:221], v[76:77]
  v_pk_mul_f32 v[220:221], v[220:221], v[68:69]
  v_pk_fma_f32 v[220:221], v[216:217], v[76:77], v[220:221]
  v_pk_fma_f32 v[216:217], v[216:217], v[68:69], v[8:9] neg_lo:[0,0,1] neg_hi:[0,0,1]
  v_pk_mul_f32 v[8:9], v[222:223], v[78:79]
  v_pk_mul_f32 v[222:223], v[222:223], v[70:71]
  v_pk_fma_f32 v[222:223], v[218:219], v[78:79], v[222:223]
  v_pk_fma_f32 v[218:219], v[218:219], v[70:71], v[8:9] neg_lo:[0,0,1] neg_hi:[0,0,1]
  v_cvt_pk_bf16_f32 v234, v216, v217
  v_cvt_pk_bf16_f32 v235, v218, v219
  v_cvt_pk_bf16_f32 v238, v220, v221
  v_cvt_pk_bf16_f32 v239, v222, v223
  v_mfma_f32_16x16x32_bf16 v[176:179], v[136:139], v[232:235], 0
  v_mul_f32 v8, v164, v128
  v_mul_f32 v164, v164, v120
  v_mfma_f32_16x16x32_bf16 v[176:179], v[144:147], v[236:239], v[176:179]
  v_fma_f32 v164, v160, v128, v164
  v_fma_f32 v160, v160, v120, -v8
  v_mfma_f32_16x16x32_bf16 v[180:183], v[136:139], v[236:239], 0
  v_mul_f32 v9, v165, v129
  v_mul_f32 v165, v165, v121
  v_mfma_f32_16x16x32_bf16 v[180:183], v[152:155], v[232:235], v[180:183]
  v_fma_f32 v165, v161, v129, v165
  v_fma_f32 v161, v161, v121, -v9
  v_mfma_f32_16x16x32_bf16 v[184:187], v[140:143], v[232:235], 0
  v_mul_f32 v8, v166, v130
  v_mul_f32 v166, v166, v122
  v_mfma_f32_16x16x32_bf16 v[184:187], v[148:151], v[236:239], v[184:187]
  v_fma_f32 v166, v162, v130, v166
  v_fma_f32 v162, v162, v122, -v8
  v_mfma_f32_16x16x32_bf16 v[188:191], v[140:143], v[236:239], 0
  v_mul_f32 v9, v167, v131
  v_mul_f32 v167, v167, v123
  v_mfma_f32_16x16x32_bf16 v[188:191], v[156:159], v[232:235], v[188:191]
  v_fma_f32 v167, v163, v131, v167
  v_fma_f32 v163, v163, v123, -v9
  v_cvt_pk_bf16_f32 v160, v160, v161
  v_cvt_pk_bf16_f32 v161, v162, v163
  ds_write_b64 v248, v[160:161] offset:0
  v_cvt_pk_bf16_f32 v164, v164, v165
  v_cvt_pk_bf16_f32 v165, v166, v167
  ds_write_b64 v248, v[164:165] offset:4096
  v_pk_mul_f32 v[8:9], v[172:173], v[132:133]
  v_pk_mul_f32 v[172:173], v[172:173], v[124:125]
  v_pk_fma_f32 v[172:173], v[168:169], v[132:133], v[172:173]
  v_pk_fma_f32 v[168:169], v[168:169], v[124:125], v[8:9] neg_lo:[0,0,1] neg_hi:[0,0,1]
  v_pk_mul_f32 v[8:9], v[174:175], v[134:135]
  v_pk_mul_f32 v[174:175], v[174:175], v[126:127]
  v_pk_fma_f32 v[174:175], v[170:171], v[134:135], v[174:175]
  v_pk_fma_f32 v[170:171], v[170:171], v[126:127], v[8:9] neg_lo:[0,0,1] neg_hi:[0,0,1]
  v_cvt_pk_bf16_f32 v168, v168, v169
  v_cvt_pk_bf16_f32 v169, v170, v171
  ds_write_b64 v249, v[168:169] offset:0
  v_cvt_pk_bf16_f32 v172, v172, v173
  v_cvt_pk_bf16_f32 v173, v174, v175
  ds_write_b64 v249, v[172:173] offset:4096
  v_pk_mul_f32 v[8:9], v[180:181], v[128:129]
  v_pk_mul_f32 v[180:181], v[180:181], v[120:121]
  v_pk_fma_f32 v[180:181], v[176:177], v[128:129], v[180:181]
  v_pk_fma_f32 v[176:177], v[176:177], v[120:121], v[8:9] neg_lo:[0,0,1] neg_hi:[0,0,1]
  v_pk_mul_f32 v[8:9], v[182:183], v[130:131]
  v_pk_mul_f32 v[182:183], v[182:183], v[122:123]
  v_pk_fma_f32 v[182:183], v[178:179], v[130:131], v[182:183]
  v_pk_fma_f32 v[178:179], v[178:179], v[122:123], v[8:9] neg_lo:[0,0,1] neg_hi:[0,0,1]
  v_cvt_pk_bf16_f32 v176, v176, v177
  v_cvt_pk_bf16_f32 v177, v178, v179
  ds_write_b64 v248, v[176:177] offset:8192
  v_cvt_pk_bf16_f32 v180, v180, v181
  v_cvt_pk_bf16_f32 v181, v182, v183
  ds_write_b64 v248, v[180:181] offset:12288
  v_pk_mul_f32 v[8:9], v[188:189], v[132:133]
  v_pk_mul_f32 v[188:189], v[188:189], v[124:125]
  v_pk_fma_f32 v[188:189], v[184:185], v[132:133], v[188:189]
  v_pk_fma_f32 v[184:185], v[184:185], v[124:125], v[8:9] neg_lo:[0,0,1] neg_hi:[0,0,1]
  v_pk_mul_f32 v[8:9], v[190:191], v[134:135]
  v_pk_mul_f32 v[190:191], v[190:191], v[126:127]
  v_pk_fma_f32 v[190:191], v[186:187], v[134:135], v[190:191]
  v_pk_fma_f32 v[186:187], v[186:187], v[126:127], v[8:9] neg_lo:[0,0,1] neg_hi:[0,0,1]
  v_cvt_pk_bf16_f32 v184, v184, v185
  v_cvt_pk_bf16_f32 v185, v186, v187
  ds_write_b64 v249, v[184:185] offset:8192
  v_cvt_pk_bf16_f32 v188, v188, v189
  v_cvt_pk_bf16_f32 v189, v190, v191
  ds_write_b64 v249, v[188:189] offset:12288
  s_waitcnt lgkmcnt(0)
  s_barrier
  ds_read_b64_tr_b16 v[16:17], v240 offset:0
  ds_read_b64_tr_b16 v[18:19], v240 offset:1024
  ds_read_b64_tr_b16 v[20:21], v240 offset:4096
  ds_read_b64_tr_b16 v[22:23], v240 offset:5120
  ds_read_b64_tr_b16 v[24:25], v240 offset:2048
  ds_read_b64_tr_b16 v[26:27], v240 offset:3072
  ds_read_b64_tr_b16 v[28:29], v240 offset:6144
  ds_read_b64_tr_b16 v[30:31], v240 offset:7168
  ds_read_b64_tr_b16 v[32:33], v240 offset:8192
  ds_read_b64_tr_b16 v[34:35], v240 offset:9216
  ds_read_b64_tr_b16 v[36:37], v240 offset:12288
  ds_read_b64_tr_b16 v[38:39], v240 offset:13312
  ds_read_b64_tr_b16 v[40:41], v240 offset:10240
  ds_read_b64_tr_b16 v[42:43], v240 offset:11264
  ds_read_b64_tr_b16 v[44:45], v240 offset:14336
  ds_read_b64_tr_b16 v[46:47], v240 offset:15360
  s_waitcnt lgkmcnt(12)
  v_mfma_f32_16x16x32_bf16 v[192:195], v[16:19], v[108:111], 0
  v_mfma_f32_16x16x32_bf16 v[192:195], v[20:23], v[112:115], v[192:195]
  v_mfma_f32_16x16x32_bf16 v[196:199], v[20:23], v[108:111], 0
  v_mfma_f32_16x16x32_bf16 v[196:199], v[16:19], v[116:119], v[196:199]
  s_waitcnt lgkmcnt(8)
  v_mfma_f32_16x16x32_bf16 v[200:203], v[24:27], v[108:111], 0
  v_mfma_f32_16x16x32_bf16 v[200:203], v[28:31], v[112:115], v[200:203]
  v_mfma_f32_16x16x32_bf16 v[204:207], v[28:31], v[108:111], 0
  v_mfma_f32_16x16x32_bf16 v[204:207], v[24:27], v[116:119], v[204:207]
  s_waitcnt lgkmcnt(4)
  v_mfma_f32_16x16x32_bf16 v[208:211], v[32:35], v[108:111], 0
  v_mfma_f32_16x16x32_bf16 v[208:211], v[36:39], v[112:115], v[208:211]
  v_mfma_f32_16x16x32_bf16 v[212:215], v[36:39], v[108:111], 0
  v_mfma_f32_16x16x32_bf16 v[212:215], v[32:35], v[116:119], v[212:215]
  s_nop 2
  v_mul_f32 v8, v204, v243
  v_mul_f32 v204, v204, v242
  s_waitcnt lgkmcnt(0)
  v_mfma_f32_16x16x32_bf16 v[216:219], v[40:43], v[108:111], 0
  v_fma_f32 v204, v200, v243, v204
  v_fma_f32 v200, v200, v242, -v8
  v_mfma_f32_16x16x32_bf16 v[216:219], v[44:47], v[112:115], v[216:219]
  v_mul_f32 v9, v205, v243
  v_mul_f32 v205, v205, v242
  v_mfma_f32_16x16x32_bf16 v[220:223], v[44:47], v[108:111], 0
  v_fma_f32 v205, v201, v243, v205
  v_fma_f32 v201, v201, v242, -v9
  v_mfma_f32_16x16x32_bf16 v[220:223], v[40:43], v[116:119], v[220:223]
  v_mul_f32 v8, v206, v243
  v_mul_f32 v206, v206, v242
  v_fma_f32 v206, v202, v243, v206
  v_fma_f32 v202, v202, v242, -v8
  v_mul_f32 v9, v207, v243
  v_mul_f32 v207, v207, v242
  v_fma_f32 v207, v203, v243, v207
  v_fma_f32 v203, v203, v242, -v9
  v_pk_add_f32 v[160:161], v[192:193], v[200:201] neg_lo:[0,1] neg_hi:[0,1]
KA_I0:
  s_cbranch_execz KA_I1
  v_pk_add_f32 v[192:193], v[192:193], v[200:201]
  v_pk_add_f32 v[162:163], v[194:195], v[202:203] neg_lo:[0,1] neg_hi:[0,1]
  v_pk_add_f32 v[194:195], v[194:195], v[202:203]
  v_pk_add_f32 v[164:165], v[196:197], v[204:205] neg_lo:[0,1] neg_hi:[0,1]
  v_pk_add_f32 v[196:197], v[196:197], v[204:205]
  v_pk_add_f32 v[166:167], v[198:199], v[206:207] neg_lo:[0,1] neg_hi:[0,1]
  v_pk_add_f32 v[198:199], v[198:199], v[206:207]
  v_cvt_pk_bf16_f32 v224, v192, v193
  v_cvt_pk_bf16_f32 v225, v194, v195
  v_cvt_pk_bf16_f32 v226, v196, v197
  v_cvt_pk_bf16_f32 v227, v198, v199
  ds_write_b128 v250, v[224:227] offset:0
  v_cvt_pk_bf16_f32 v232, v160, v161
  v_cvt_pk_bf16_f32 v233, v162, v163
  v_cvt_pk_bf16_f32 v234, v164, v165
  v_cvt_pk_bf16_f32 v235, v166, v167
  ds_write_b128 v250, v[232:235] offset:2048
  v_pk_mul_f32 v[8:9], v[220:221], v[242:243] op_sel:[0,1] op_sel_hi:[1,1]
  v_pk_mul_f32 v[220:221], v[220:221], v[242:243] op_sel:[0,0] op_sel_hi:[1,0]
  v_pk_fma_f32 v[220:221], v[216:217], v[242:243], v[220:221] op_sel:[0,1,0] op_sel_hi:[1,1,1]
  v_pk_fma_f32 v[216:217], v[216:217], v[242:243], v[8:9] op_sel:[0,0,0] op_sel_hi:[1,0,1] neg_lo:[0,0,1] neg_hi:[0,0,1]
  v_pk_mul_f32 v[8:9], v[222:223], v[242:243] op_sel:[0,1] op_sel_hi:[1,1]
  v_pk_mul_f32 v[222:223], v[222:223], v[242:243] op_sel:[0,0] op_sel_hi:[1,0]
  v_pk_fma_f32 v[222:223], v[218:219], v[242:243], v[222:223] op_sel:[0,1,0] op_sel_hi:[1,1,1]
  v_pk_fma_f32 v[218:219], v[218:219], v[242:243], v[8:9] op_sel:[0,0,0] op_sel_hi:[1,0,1] neg_lo:[0,0,1] neg_hi:[0,0,1]
  v_pk_add_f32 v[176:177], v[208:209], v[216:217] neg_lo:[0,1] neg_hi:[0,1]
  v_pk_add_f32 v[208:209], v[208:209], v[216:217]
  v_pk_add_f32 v[178:179], v[210:211], v[218:219] neg_lo:[0,1] neg_hi:[0,1]
  v_pk_add_f32 v[210:211], v[210:211], v[218:219]
  v_pk_add_f32 v[180:181], v[212:213], v[220:221] neg_lo:[0,1] neg_hi:[0,1]
  v_pk_add_f32 v[212:213], v[212:213], v[220:221]
  v_pk_add_f32 v[182:183], v[214:215], v[222:223] neg_lo:[0,1] neg_hi:[0,1]
  v_pk_add_f32 v[214:215], v[214:215], v[222:223]
  v_cvt_pk_bf16_f32 v228, v208, v209
  v_cvt_pk_bf16_f32 v229, v210, v211
  v_cvt_pk_bf16_f32 v230, v212, v213
  v_cvt_pk_bf16_f32 v231, v214, v215
  ds_write_b128 v251, v[228:231] offset:0
  v_cvt_pk_bf16_f32 v236, v176, v177
  v_cvt_pk_bf16_f32 v237, v178, v179
  v_cvt_pk_bf16_f32 v238, v180, v181
  v_cvt_pk_bf16_f32 v239, v182, v183
  ds_write_b128 v251, v[236:239] offset:2048
  ds_read_b128 v[16:19], v252 offset:0
  ds_read_b128 v[20:23], v252 offset:1024
  ds_read_b128 v[24:27], v252 offset:2048
  ds_read_b128 v[28:31], v252 offset:3072
  s_waitcnt lgkmcnt(3)
  buffer_store_dwordx4 v[16:19], v253, s[16:19], 0 offen sc1
  s_waitcnt lgkmcnt(2)
  buffer_store_dwordx4 v[20:23], v253, s[16:19], s36 offen sc1
  s_waitcnt lgkmcnt(1)
  buffer_store_dwordx4 v[24:27], v253, s[16:19], s37 offen sc1
  s_waitcnt lgkmcnt(0)
  buffer_store_dwordx4 v[28:31], v253, s[16:19], s38 offen sc1
  s_waitcnt vmcnt(0)
  s_branch KM_SB
KM_J0:
KM_J0B:
  s_cmp_ge_u32 s2, 177
  s_cbranch_scc1 KM_SB0
  s_load_dwordx4 s[4:7], s[0:1], 32
  s_load_dwordx2 s[40:41], s[0:1], 88
  s_sub_u32 s3, s2, 145
  s_and_b32 s20, s3, 7
  s_bfe_u32 s22, s3, 0x10003
  s_lshr_b32 s23, s3, 4
  s_mul_i32 s24, s23, 2654208
  s_mul_i32 s25, s20, 1152
  s_add_u32 s24, s24, s25
  s_add_u32 s24, s24, 512
  s_mul_i32 s25, s20, 147456
  s_mul_i32 s26, s23, 36864
  s_add_u32 s25, s25, s26
  s_lshl_b32 s26, s22, 6
  s_add_u32 s25, s25, s26
  v_lshrrev_b32 v1, 3, v0
  v_and_b32 v2, 7, v0
  v_mul_u32_u24 v3, 9216, v1
  v_lshl_add_u32 v3, v2, 4, v3
  v_bfe_u32 v4, v0, 2, 1
  v_mul_u32_u24 v4, 73728, v4
  v_lshl_add_u32 v4, v1, 7, v4
  v_and_b32 v2, 3, v0
  v_lshl_add_u32 v4, v2, 4, v4
  s_waitcnt lgkmcnt(0)
  s_cmp_eq_u32 s22, 1
  s_cselect_b32 s8, s6, s4
  s_cselect_b32 s9, s7, s5
  s_mov_b32 s10, 5308416
  s_mov_b32 s11, 0x20000
  buffer_load_dwordx4 v[8:11], v3, s[8:11], s24 offen
  s_add_u32 s24, s24, 294912
  buffer_load_dwordx4 v[12:15], v3, s[8:11], s24 offen
  s_add_u32 s24, s24, 294912
  buffer_load_dwordx4 v[16:19], v3, s[8:11], s24 offen
  s_add_u32 s24, s24, 294912
  buffer_load_dwordx4 v[20:23], v3, s[8:11], s24 offen
  s_add_u32 s24, s24, 294912
  buffer_load_dwordx4 v[24:27], v3, s[8:11], s24 offen
  s_add_u32 s24, s24, 294912
  buffer_load_dwordx4 v[28:31], v3, s[8:11], s24 offen
  s_add_u32 s24, s24, 294912
  buffer_load_dwordx4 v[32:35], v3, s[8:11], s24 offen
  s_add_u32 s24, s24, 294912
  buffer_load_dwordx4 v[36:39], v3, s[8:11], s24 offen
  s_add_u32 s24, s24, 294912
  buffer_load_dwordx4 v[40:43], v3, s[8:11], s24 offen
  s_add_u32 s12, s40, 50331648
  s_addc_u32 s13, s41, 0
  s_mov_b32 s14, 1179648
  s_mov_b32 s15, 0x20000
  s_waitcnt vmcnt(8)
  buffer_store_dwordx4 v[8:11], v4, s[12:15], s25 offen sc1
  s_add_u32 s25, s25, 4096
  s_waitcnt vmcnt(8)
  buffer_store_dwordx4 v[12:15], v4, s[12:15], s25 offen sc1
  s_add_u32 s25, s25, 4096
  s_waitcnt vmcnt(8)
  buffer_store_dwordx4 v[16:19], v4, s[12:15], s25 offen sc1
  s_add_u32 s25, s25, 4096
  s_waitcnt vmcnt(8)
  buffer_store_dwordx4 v[20:23], v4, s[12:15], s25 offen sc1
  s_add_u32 s25, s25, 4096
  s_waitcnt vmcnt(8)
  buffer_store_dwordx4 v[24:27], v4, s[12:15], s25 offen sc1
  s_add_u32 s25, s25, 4096
  s_waitcnt vmcnt(8)
  buffer_store_dwordx4 v[28:31], v4, s[12:15], s25 offen sc1
  s_add_u32 s25, s25, 4096
  s_waitcnt vmcnt(8)
  buffer_store_dwordx4 v[32:35], v4, s[12:15], s25 offen sc1
  s_add_u32 s25, s25, 4096
  s_waitcnt vmcnt(8)
  buffer_store_dwordx4 v[36:39], v4, s[12:15], s25 offen sc1
  s_add_u32 s25, s25, 4096
  s_waitcnt vmcnt(8)
  buffer_store_dwordx4 v[40:43], v4, s[12:15], s25 offen sc1
KM_SB0:
  s_waitcnt vmcnt(0)
KM_SB:
  v_cmp_gt_u32 vcc, 16, v0
  v_lshlrev_b32 v12, 11, v0
  v_mov_b32 v13, 1073741824
  v_cndmask_b32 v12, v13, v12, vcc
  v_mov_b32 v13, 1
  s_and_b32 s24, s2, 15
  s_lshl_b32 s24, s24, 7
  s_add_u32 s24, s24, 16039936
  s_barrier
  buffer_atomic_add v13, v12, s[48:51], s24 offen sc1
  s_cmp_lt_u32 s2, 145
  s_cbranch_scc1 KM_P3
  s_cmp_lt_u32 s2, 177
  s_cbranch_scc1 KM_J3
KM_J3:
  v_lshrrev_b32 v1, 6, v0
  s_nop 0
  v_readfirstlane_b32 s21, v1
  s_nop 0
  s_cmp_lg_u32 s21, 0
  s_cbranch_scc1 KM_WA2_O
  v_and_b32 v250, 63, v0
  v_cmp_gt_u32 vcc, 16, v250
  v_lshlrev_b32 v250, 7, v250
  v_mov_b32 v251, 1073741824
  v_cndmask_b32 v250, v251, v250, vcc
  s_lshr_b32 s32, s2, 4
  s_lshl_b32 s32, s32, 11
  s_add_u32 s32, s32, 16007168
  s_mov_b32 s33, 200000
KM_WA2_P:
  buffer_load_dword v251, v250, s[48:51], s32 offen sc1
  s_sub_u32 s33, s33, 1
  s_cmp_eq_u32 s33, 0
  s_cbranch_scc1 KM_WA2_X
  s_waitcnt vmcnt(0)
  v_cmp_ne_u32 vcc, 16, v251
  s_nop 0
  s_and_b32 s34, vcc_lo, 0xffff
  s_cbranch_scc0 KM_WA2_X
  s_sleep 4
  s_branch KM_WA2_P
KM_WA2_O:
KM_WA2_X:
  s_barrier
  v_lshlrev_b32 v242, 4, v0
  v_cmp_gt_u32 vcc, 64, v0
  v_mov_b32 v243, 1073741824
  s_nop 0
  v_cndmask_b32 v243, v243, v242, vcc
  v_lshlrev_b32 v244, 3, v0
  v_add_u32 v244, 156800, v244
  v_mov_b32 v245, 157824
  v_cndmask_b32 v245, v245, v244, vcc
  s_mov_b32 s24, 12800
  buffer_load_dwordx4 v[200:203], v242, s[48:51], s24 offen sc1
  s_mov_b32 s24, 26624
  buffer_load_dwordx4 v[204:207], v242, s[48:51], s24 offen sc1
  s_mov_b32 s24, 40448
  buffer_load_dwordx4 v[208:211], v242, s[48:51], s24 offen sc1
  s_mov_b32 s24, 16896
  buffer_load_dwordx4 v[212:215], v242, s[48:51], s24 offen sc1
  s_mov_b32 s24, 30720
  buffer_load_dwordx4 v[216:219], v242, s[48:51], s24 offen sc1
  s_mov_b32 s24, 44544
  buffer_load_dwordx4 v[220:223], v242, s[48:51], s24 offen sc1
  s_mov_b32 s24, 20992
  buffer_load_dwordx4 v[224:227], v243, s[48:51], s24 offen sc1
  s_mov_b32 s24, 34816
  buffer_load_dwordx4 v[228:231], v243, s[48:51], s24 offen sc1
  s_mov_b32 s24, 48640
  buffer_load_dwordx4 v[232:235], v243, s[48:51], s24 offen sc1
  v_subrev_u32 v246, 32, v0
  v_cmp_gt_u32 vcc, 144, v246
  s_nop 1
  v_cndmask_b32 v246, 0, 1.0, vcc
  s_waitcnt vmcnt(6)
  v_pk_add_f32 v[200:201], v[200:201], v[204:205]
  v_pk_add_f32 v[200:201], v[200:201], v[208:209]
  v_pk_add_f32 v[202:203], v[202:203], v[206:207]
  v_pk_add_f32 v[202:203], v[202:203], v[210:211]
  v_cvt_pk_bf16_f32 v236, v200, v201
  v_cvt_pk_bf16_f32 v237, v202, v203
  v_lshlrev_b32 v200, 16, v236
  v_and_b32 v201, 0xffff0000, v236
  v_lshlrev_b32 v202, 16, v237
  v_and_b32 v203, 0xffff0000, v237
  v_add_f32 v200, 0, v200
  v_add_f32 v201, 0, v201
  v_add_f32 v202, 0, v202
  v_add_f32 v203, 0, v203
  v_cvt_pk_bf16_f32 v236, v200, v201
  v_cvt_pk_bf16_f32 v237, v202, v203
  ds_write_b64 v244, v[236:237] offset:0
  s_waitcnt vmcnt(3)
  v_pk_add_f32 v[212:213], v[212:213], v[216:217]
  v_pk_add_f32 v[212:213], v[212:213], v[220:221]
  v_pk_add_f32 v[214:215], v[214:215], v[218:219]
  v_pk_add_f32 v[214:215], v[214:215], v[222:223]
  v_cvt_pk_bf16_f32 v238, v212, v213
  v_cvt_pk_bf16_f32 v239, v214, v215
  v_lshlrev_b32 v212, 16, v238
  v_and_b32 v213, 0xffff0000, v238
  v_lshlrev_b32 v214, 16, v239
  v_and_b32 v215, 0xffff0000, v239
  v_add_f32 v212, v246, v212
  v_add_f32 v213, v246, v213
  v_add_f32 v214, v246, v214
  v_add_f32 v215, v246, v215
  v_cvt_pk_bf16_f32 v238, v212, v213
  v_cvt_pk_bf16_f32 v239, v214, v215
  ds_write_b64 v244, v[238:239] offset:2048
  s_waitcnt vmcnt(0)
  v_pk_add_f32 v[224:225], v[224:225], v[228:229]
  v_pk_add_f32 v[224:225], v[224:225], v[232:233]
  v_pk_add_f32 v[226:227], v[226:227], v[230:231]
  v_pk_add_f32 v[226:227], v[226:227], v[234:235]
  v_cvt_pk_bf16_f32 v240, v224, v225
  v_cvt_pk_bf16_f32 v241, v226, v227
  v_lshlrev_b32 v224, 16, v240
  v_and_b32 v225, 0xffff0000, v240
  v_lshlrev_b32 v226, 16, v241
  v_and_b32 v227, 0xffff0000, v241
  v_add_f32 v224, 0, v224
  v_add_f32 v225, 0, v225
  v_add_f32 v226, 0, v226
  v_add_f32 v227, 0, v227
  v_cvt_pk_bf16_f32 v240, v224, v225
  v_cvt_pk_bf16_f32 v241, v226, v227
  ds_write_b64 v245, v[240:241] offset:4096
  s_cmp_lt_u32 s2, 177
  s_cbranch_scc1 KM_P3B
KM_J2B:
  s_cmp_ge_u32 s2, 256
  s_cbranch_scc1 KM_P3B
  s_load_dwordx4 s[8:11], s[0:1], 32
  s_sub_u32 s3, s2, 177
  s_mul_i32 s3, s3, 234
  s_add_u32 s3, s3, 0
  v_add_u32 v1, s3, v0
  v_lshrrev_b32 v20, 5, v1
  v_mul_u32_u24 v20, 9216, v20
  v_bfe_u32 v2, v1, 2, 3
  v_mul_u32_u24 v2, 1152, v2
  v_add_u32 v20, v20, v2
  v_bfe_u32 v2, v1, 1, 1
  v_mul_u32_u24 v2, 640, v2
  v_add_u32 v20, v20, v2
  v_and_b32 v2, 1, v1
  v_lshl_add_u32 v20, v2, 7, v20
  s_add_u32 s3, s3, 256
  v_cmp_gt_u32 vcc, 234, v0
  v_mov_b32 v2, 1073741824
  s_nop 0
  v_cndmask_b32 v20, v2, v20, vcc
  s_waitcnt lgkmcnt(0)
  s_mov_b32 s12, s10
  s_mov_b32 s13, s11
  s_mov_b32 s10, 5308416
  s_mov_b32 s11, 0x20000
  s_mov_b32 s14, 5308416
  s_mov_b32 s15, 0x20000
  buffer_load_dword v254, v20, s[8:11], 0 offen
  buffer_load_dword v254, v20, s[12:15], 0 offen
KM_J2:
  s_cmp_ge_u32 s2, 256
  s_cbranch_scc1 KM_P3B
  s_load_dwordx2 s[8:9], s[0:1], 48
  s_sub_u32 s3, s2, 177
  v_lshlrev_b32 v1, 7, v0
  s_waitcnt lgkmcnt(0)
  s_mov_b32 s10, 5308416
  s_mov_b32 s11, 0x20000
  s_mul_i32 s4, s3, 23296
  s_add_u32 s4, s4, 3473408
  v_cmp_gt_u32 vcc, 182, v0
  v_mov_b32 v40, 1073741824
  s_nop 0
  v_cndmask_b32 v40, v40, v1, vcc
  buffer_load_dword v254, v40, s[8:11], s4 offen
  s_branch KM_P3B
KM_P3:
  v_lshlrev_b32 v242, 4, v0
  v_cmp_gt_u32 vcc, 64, v0
  v_mov_b32 v243, 1073741824
  s_nop 0
  v_cndmask_b32 v243, v243, v242, vcc
  v_lshlrev_b32 v244, 3, v0
  v_add_u32 v244, 156800, v244
  v_mov_b32 v245, 157824
  v_cndmask_b32 v245, v245, v244, vcc
  s_mov_b32 s24, 12800
  buffer_load_dwordx4 v[200:203], v242, s[48:51], s24 offen sc1
  s_mov_b32 s24, 26624
  buffer_load_dwordx4 v[204:207], v242, s[48:51], s24 offen sc1
  s_mov_b32 s24, 40448
  buffer_load_dwordx4 v[208:211], v242, s[48:51], s24 offen sc1
  s_mov_b32 s24, 16896
  buffer_load_dwordx4 v[212:215], v242, s[48:51], s24 offen sc1
  s_mov_b32 s24, 30720
  buffer_load_dwordx4 v[216:219], v242, s[48:51], s24 offen sc1
  s_mov_b32 s24, 44544
  buffer_load_dwordx4 v[220:223], v242, s[48:51], s24 offen sc1
  s_mov_b32 s24, 20992
  buffer_load_dwordx4 v[224:227], v243, s[48:51], s24 offen sc1
  s_mov_b32 s24, 34816
  buffer_load_dwordx4 v[228:231], v243, s[48:51], s24 offen sc1
  s_mov_b32 s24, 48640
  buffer_load_dwordx4 v[232:235], v243, s[48:51], s24 offen sc1
  v_subrev_u32 v246, 32, v0
  v_cmp_gt_u32 vcc, 144, v246
  s_nop 1
  v_cndmask_b32 v246, 0, 1.0, vcc
KM_P3B:
  s_load_dwordx2 s[40:41], s[0:1], 88
  s_load_dwordx2 s[64:65], s[0:1], 0
  s_load_dwordx4 s[4:7], s[0:1], 32
  s_load_dwordx2 s[44:45], s[0:1], 48
  s_load_dwordx2 s[68:69], s[0:1], 72
  v_lshrrev_b32 v1, 6, v0
  v_and_b32 v2, 63, v0
  v_and_b32 v3, 31, v0
  v_lshrrev_b32 v4, 5, v0
  v_readfirstlane_b32 s21, v1
  s_and_b32 s38, s2, 7
  s_lshr_b32 s39, s2, 3
  s_and_b32 s42, s38, 7
  s_lshl_b32 s42, s42, 1
  s_and_b32 s43, s39, 1
  s_add_u32 s42, s42, s43
  s_lshr_b32 s43, s38, 3
  s_lshl_b32 s43, s43, 4
  s_lshr_b32 s39, s39, 1
  s_add_u32 s43, s43, s39
  s_lshl_b32 s55, s43, 3
  s_lshr_b32 s56, s42, 1
  s_add_u32 s55, s55, s56
  s_and_b32 s56, s42, 1
  s_lshl_b32 s22, s21, 10
  s_mul_i32 s59, s55, 18560
  s_add_u32 s59, s59, 6291456
  s_mul_i32 s60, s21, 5120
  s_add_u32 s59, s59, s60
  s_add_u32 s60, s60, 110592
  s_mov_b32 m0, s60
  s_lshl_b32 s61, s55, 1
  s_add_u32 s61, s61, s56
  s_mul_i32 s61, s61, 9216
  v_lshlrev_b32 v8, 4, v3
  v_lshlrev_b32 v9, 2, v3
  v_add_u32 v9, 1024, v9
  v_mul_u32_u24 v5, 1152, v4
  v_add_u32 v6, v5, v8
  v_add_u32 v7, v5, v9
  v_lshlrev_b32 v184, 4, v2
  v_and_b32 v10, 15, v2
  v_lshrrev_b32 v11, 4, v2
  s_mul_i32 s39, s42, 576
  s_lshl_b32 s33, s56, 6
  s_add_u32 s24, s39, s33
  s_mul_i32 s25, s42, 73728
  s_add_u32 s25, s25, 50331648
  s_mov_b32 s23, s24
  v_lshrrev_b32 v12, 3, v2
  v_bfe_u32 v13, v2, 4, 1
  v_and_b32 v5, 1, v1
  v_lshl_or_b32 v13, v5, 1, v13
  v_bfe_u32 v5, v2, 1, 2
  v_xor_b32 v13, v13, v5
  v_lshlrev_b32 v13, 5, v13
  v_and_b32 v5, 1, v2
  v_lshl_add_u32 v13, v5, 4, v13
  v_lshl_add_u32 v5, v1, 3, v12
  v_lshl_add_u32 v181, v5, 7, v13
  v_mul_u32_u24 v5, 9216, v5
  v_add_u32 v180, v5, v13
  v_lshrrev_b32 v5, 5, v2
  v_lshlrev_b32 v5, 4, v5
  v_lshl_add_u32 v5, v1, 2, v5
  v_and_b32 v12, 3, v12
  v_add_u32 v5, v5, v12
  v_mul_u32_u24 v5, 1152, v5
  v_add_u32 v182, v5, v13
  s_and_b32 s57, s21, 1
  s_lshr_b32 s58, s21, 1
  s_lshl_b32 s37, s56, 1
  s_add_u32 s37, s37, s58
  v_cvt_f32_u32 v62, v10
  v_cvt_f32_u32 v63, v11
  v_mul_f32 v96, 0x3d000000, v62
  v_mul_f32 v101, 4.0, v63
  v_mul_f32 v101, v101, v96
  v_fma_f32 v102, v96, 1.0, v101
  v_fma_f32 v103, v96, 2.0, v101
  v_add_f32 v104, v103, v96
  v_and_b32 v105, 1, v10
  v_mul_u32_u24 v105, 0x8000, v105
  v_cos_f32 v97, v101
  v_cos_f32 v98, v102
  v_cos_f32 v99, v103
  v_cos_f32 v100, v104
  v_sin_f32 v101, v101
  v_sin_f32 v102, v102
  v_sin_f32 v103, v103
  v_sin_f32 v104, v104
  v_lshl_or_b32 v105, v105, 16, v105
  v_cvt_pk_bf16_f32 v64, v97, v98
  v_cvt_pk_bf16_f32 v65, v99, v100
  v_cvt_pk_bf16_f32 v68, v101, v102
  v_cvt_pk_bf16_f32 v69, v103, v104
  v_xor_b32 v66, v64, v105
  v_xor_b32 v67, v65, v105
  v_xor_b32 v70, v68, v105
  v_xor_b32 v71, v69, v105
  s_lshl_b32 s36, s57, 31
  v_xor_b32 v64, s36, v64
  v_xor_b32 v65, s36, v65
  v_xor_b32 v66, s36, v66
  v_xor_b32 v67, s36, v67
  v_xor_b32 v68, s36, v68
  v_xor_b32 v69, s36, v69
  v_xor_b32 v70, s36, v70
  v_xor_b32 v71, s36, v71
  v_xor_b32 v72, 0x80008000, v68
  v_mov_b32 v76, v64
  v_xor_b32 v73, 0x80008000, v69
  v_mov_b32 v77, v65
  v_mov_b32 v74, v70
  v_xor_b32 v78, 0x80008000, v66
  v_mov_b32 v75, v71
  v_xor_b32 v79, 0x80008000, v67
  s_lshl_b32 s36, s57, 4
  v_add_u32 v14, s36, v10
  v_cvt_f32_u32 v14, v14
  v_mul_f32 v14, 0x3ae38e39, v14
  v_mul_f32 v83, v63, v14
  v_fma_f32 v84, v14, 4.0, v83
  v_fma_f32 v85, v14, 4.0, v84
  v_mul_f32 v14, 0x3d638e39, v62
  v_mul_f32 v102, v63, v14
  v_fma_f32 v103, v14, 4.0, v102
  v_fma_f32 v104, v14, 4.0, v103
  v_add_f32 v14, 0x3f638e39, v14
  v_mul_f32 v105, v63, v14
  v_fma_f32 v106, v14, 4.0, v105
  v_fma_f32 v107, v14, 4.0, v106
  v_cos_f32 v80, v83
  v_cos_f32 v81, v84
  v_cos_f32 v82, v85
  v_sin_f32 v83, v83
  v_sin_f32 v84, v84
  v_sin_f32 v85, v85
  v_cos_f32 v96, v102
  v_cos_f32 v97, v103
  v_cos_f32 v98, v104
  v_cos_f32 v99, v105
  v_cos_f32 v100, v106
  v_cos_f32 v101, v107
  v_sin_f32 v102, v102
  v_sin_f32 v103, v103
  v_sin_f32 v104, v104
  v_sin_f32 v105, v105
  v_sin_f32 v106, v106
  v_sin_f32 v107, v107
  v_cmp_gt_u32 vcc, 2, v11
  v_mul_f32 v80, 0x3b638e39, v80
  v_mul_f32 v81, 0x3b638e39, v81
  v_mul_f32 v82, 0x3b638e39, v82
  v_mul_f32 v83, 0x3b638e39, v83
  v_mul_f32 v84, 0x3b638e39, v84
  v_mul_f32 v85, 0x3b638e39, v85
  v_cvt_pk_bf16_f32 v88, v96, -v102
  v_cvt_pk_bf16_f32 v89, v97, -v103
  v_cvt_pk_bf16_f32 v90, v98, -v104
  v_cndmask_b32 v90, 0, v90, vcc
  v_mov_b32 v91, 0
  v_cvt_pk_bf16_f32 v92, v99, -v105
  v_cvt_pk_bf16_f32 v93, v100, -v106
  v_cvt_pk_bf16_f32 v94, v101, -v107
  v_cndmask_b32 v94, 0, v94, vcc
  v_mov_b32 v95, 0
  s_waitcnt lgkmcnt(0)
  s_mov_b32 s48, s40
  s_mov_b32 s49, s41
  s_mov_b32 s50, 268435456
  s_mov_b32 s51, 0x20000
  s_mov_b32 s74, s59
  s_mov_b32 s75, s60
  s_mov_b32 s66, 2359296
  s_mov_b32 s67, 0x20000
  buffer_load_dwordx4 v[16:19], v6, s[64:67], s61 offen
  buffer_load_dwordx4 v[20:23], v6, s[64:67], s61 offen offset:512
  buffer_load_dword v24, v7, s[64:67], s61 offen
  s_mov_b32 s8, s4
  s_mov_b32 s9, s5
  s_mov_b32 s10, 5308416
  s_mov_b32 s11, 0x20000
  s_mov_b32 s12, s6
  s_mov_b32 s13, s7
  s_mov_b32 s14, 5308416
  s_mov_b32 s15, 0x20000
  v_mov_b32 v56, 0
  v_mov_b32 v57, 0
  v_mov_b32 v58, 0
  v_mov_b32 v59, 0
  v_mov_b32 v5, 131072
  ds_write_b128 v5, v[56:59]
  ds_write_b32 v5, v56 offset:16
  v_lshrrev_b32 v5, 2, v10
  v_lshl_add_u32 v5, v11, 2, v5
  v_and_b32 v13, 3, v10
  v_mov_b32 v99, 20480
  v_mul_u32_u24 v96, 18, v5
  v_add_u32 v96, v96, v13
  v_add_u32 v97, 0, v96
  v_bfe_u32 v98, v97, 2, 2
  v_xor_b32 v98, s37, v98
  v_lshlrev_b32 v98, 4, v98
  v_lshl_add_u32 v56, v97, 6, v98
  v_sub_u32 v97, 288, v96
  v_bfe_u32 v98, v97, 2, 2
  v_xor_b32 v98, s37, v98
  v_lshlrev_b32 v98, 4, v98
  v_lshl_add_u32 v57, v97, 6, v98
  v_cmp_eq_u32 vcc, 0, v13
  v_cmp_le_u32 s[62:63], 1, v5
  s_nop 0
  s_and_b64 vcc, vcc, s[62:63]
  v_cndmask_b32 v57, v57, v99, vcc
  v_add_u32 v97, 4, v96
  v_bfe_u32 v98, v97, 2, 2
  v_xor_b32 v98, s37, v98
  v_lshlrev_b32 v98, 4, v98
  v_lshl_add_u32 v58, v97, 6, v98
  v_sub_u32 v97, 284, v96
  v_bfe_u32 v98, v97, 2, 2
  v_xor_b32 v98, s37, v98
  v_lshlrev_b32 v98, 4, v98
  v_lshl_add_u32 v59, v97, 6, v98
  v_add_u32 v97, 8, v96
  v_bfe_u32 v98, v97, 2, 2
  v_xor_b32 v98, s37, v98
  v_lshlrev_b32 v98, 4, v98
  v_lshl_add_u32 v60, v97, 6, v98
  v_cmp_le_u32 vcc, 2, v13
  s_nop 1
  v_cndmask_b32 v60, v60, v99, vcc
  v_sub_u32 v97, 280, v96
  v_bfe_u32 v98, v97, 2, 2
  v_xor_b32 v98, s37, v98
  v_lshlrev_b32 v98, 4, v98
  v_lshl_add_u32 v61, v97, 6, v98
  v_cmp_le_u32 vcc, 1, v13
  s_nop 1
  v_cndmask_b32 v61, v61, v99, vcc
  v_add_u32 v56, 110592, v56
  v_add_u32 v57, 110592, v57
  v_add_u32 v58, 110592, v58
  v_add_u32 v59, 110592, v59
  v_add_u32 v60, 110592, v60
  v_add_u32 v61, 110592, v61
  v_lshrrev_b32 v5, 1, v11
  s_lshl_b32 s60, s57, 1
  v_add_u32 v5, s60, v5
  v_bfe_u32 v62, v10, 1, 2
  v_xor_b32 v5, v5, v62
  v_lshlrev_b32 v5, 4, v5
  v_lshl_add_u32 v62, v10, 6, v5
  v_and_b32 v5, 1, v11
  v_lshl_add_u32 v62, v5, 3, v62
  s_mul_i32 s60, s58, 4672
  s_add_u32 s60, s60, 131328
  v_add_u32 v62, s60, v62
  v_bfe_u32 v5, v3, 3, 2
  v_and_b32 v63, 3, v3
  v_xor_b32 v5, v5, v63
  v_lshlrev_b32 v5, 4, v5
  v_lshrrev_b32 v63, 2, v3
  v_lshl_add_u32 v63, v63, 6, v5
  v_mul_u32_u24 v5, 1168, v4
  v_add_u32 v5, 131328, v5
  v_add_u32 v63, v63, v5
  v_add_u32 v15, v9, v5
  v_add_u32 v55, v8, v5
  v_mov_b32 v147, 0
  v_mov_b32 v151, 0
  v_mov_b32 v155, 0
  v_mov_b32 v159, 0
  s_cmp_ge_u32 s2, 145
  s_cbranch_scc1 KM_P3C
  s_waitcnt vmcnt(9)
  v_pk_add_f32 v[200:201], v[200:201], v[204:205]
  v_pk_add_f32 v[200:201], v[200:201], v[208:209]
  v_pk_add_f32 v[202:203], v[202:203], v[206:207]
  v_pk_add_f32 v[202:203], v[202:203], v[210:211]
  v_cvt_pk_bf16_f32 v236, v200, v201
  v_cvt_pk_bf16_f32 v237, v202, v203
  v_lshlrev_b32 v200, 16, v236
  v_and_b32 v201, 0xffff0000, v236
  v_lshlrev_b32 v202, 16, v237
  v_and_b32 v203, 0xffff0000, v237
  v_add_f32 v200, 0, v200
  v_add_f32 v201, 0, v201
  v_add_f32 v202, 0, v202
  v_add_f32 v203, 0, v203
  v_cvt_pk_bf16_f32 v236, v200, v201
  v_cvt_pk_bf16_f32 v237, v202, v203
  ds_write_b64 v244, v[236:237] offset:0
  s_waitcnt vmcnt(6)
  v_pk_add_f32 v[212:213], v[212:213], v[216:217]
  v_pk_add_f32 v[212:213], v[212:213], v[220:221]
  v_pk_add_f32 v[214:215], v[214:215], v[218:219]
  v_pk_add_f32 v[214:215], v[214:215], v[222:223]
  v_cvt_pk_bf16_f32 v238, v212, v213
  v_cvt_pk_bf16_f32 v239, v214, v215
  v_lshlrev_b32 v212, 16, v238
  v_and_b32 v213, 0xffff0000, v238
  v_lshlrev_b32 v214, 16, v239
  v_and_b32 v215, 0xffff0000, v239
  v_add_f32 v212, v246, v212
  v_add_f32 v213, v246, v213
  v_add_f32 v214, v246, v214
  v_add_f32 v215, v246, v215
  v_cvt_pk_bf16_f32 v238, v212, v213
  v_cvt_pk_bf16_f32 v239, v214, v215
  ds_write_b64 v244, v[238:239] offset:2048
  s_waitcnt vmcnt(3)
  v_pk_add_f32 v[224:225], v[224:225], v[228:229]
  v_pk_add_f32 v[224:225], v[224:225], v[232:233]
  v_pk_add_f32 v[226:227], v[226:227], v[230:231]
  v_pk_add_f32 v[226:227], v[226:227], v[234:235]
  v_cvt_pk_bf16_f32 v240, v224, v225
  v_cvt_pk_bf16_f32 v241, v226, v227
  v_lshlrev_b32 v224, 16, v240
  v_and_b32 v225, 0xffff0000, v240
  v_lshlrev_b32 v226, 16, v241
  v_and_b32 v227, 0xffff0000, v241
  v_add_f32 v224, 0, v224
KA_I1:
  s_cbranch_execz KA_I2
  v_add_f32 v225, 0, v225
  v_add_f32 v226, 0, v226
  v_add_f32 v227, 0, v227
  v_cvt_pk_bf16_f32 v240, v224, v225
  v_cvt_pk_bf16_f32 v241, v226, v227
  ds_write_b64 v245, v[240:241] offset:4096
KM_P3C:
  s_add_u32 m0, s22, 0
  s_nop 0
  buffer_load_dwordx4 v180, s[8:11], s23 offen lds
  s_add_u32 s23, s23, 294912
  s_add_u32 m0, s22, 4096
  s_nop 0
  buffer_load_dwordx4 v180, s[8:11], s23 offen lds
  s_add_u32 s23, s23, 294912
  s_add_u32 m0, s22, 8192
  s_nop 0
  buffer_load_dwordx4 v180, s[8:11], s23 offen lds
  s_add_u32 s23, s23, 294912
  s_add_u32 m0, s22, 12288
  s_nop 0
  buffer_load_dwordx4 v180, s[8:11], s23 offen lds
  s_add_u32 s23, s23, 294912
  s_add_u32 m0, s22, 16384
  s_nop 0
  buffer_load_dwordx4 v180, s[8:11], s23 offen lds
  s_add_u32 s23, s23, 294912
  s_add_u32 m0, s22, 20480
  s_nop 0
  buffer_load_dwordx4 v180, s[8:11], s23 offen lds
  s_add_u32 s23, s23, 294912
  s_add_u32 m0, s22, 24576
  s_nop 0
  buffer_load_dwordx4 v180, s[8:11], s23 offen lds
  s_add_u32 s23, s23, 294912
  s_add_u32 m0, s22, 28672
  s_nop 0
  buffer_load_dwordx4 v180, s[8:11], s23 offen lds
  s_add_u32 s23, s23, 294912
  s_add_u32 m0, s22, 32768
  s_nop 0
  buffer_load_dwordx4 v180, s[8:11], s23 offen lds
  v_add_u32 v12, 156800, v8
  v_add_u32 v13, 156800, v9
  s_getpc_b64 s[30:31]
KC2_PC:
  s_lshr_b32 s32, s2, 3
  s_sub_u32 s32, s32, 0
  s_lshl_b32 s32, s32, 2
  s_add_u32 s32, s32, s21
  s_mul_i32 s32, s32, 4
  v_min_u32 v252, 3, v2
  v_add_u32 v252, s32, v252
  v_lshlrev_b32 v252, 7, v252
  v_min_u32 v252, KB_END-KB_GO, v252
  v_add_u32 v252, KB_GO-KC2_PC, v252
  v_mov_b32 v253, s31
  v_add_co_u32 v252, vcc, s30, v252
  s_nop 1
  v_addc_co_u32 v253, vcc, 0, v253, vcc
  global_load_dword v252, v[252:253], off
  s_sub_u32 s30, s2, 0
  s_lshl_b32 s30, s30, 2
  s_add_u32 s30, s30, s21
  s_mul_i32 s31, s30, 18
  v_add_u32 v5, s31, v2
  v_lshrrev_b32 v250, 5, v5
  v_mul_u32_u24 v250, 9216, v250
  v_bfe_u32 v251, v5, 2, 3
  v_mul_u32_u24 v251, 1152, v251
  v_add_u32 v250, v250, v251
  v_bfe_u32 v251, v5, 1, 1
  v_mul_u32_u24 v251, 640, v251
  v_add_u32 v250, v250, v251
  v_and_b32 v251, 1, v5
  v_lshl_add_u32 v250, v251, 7, v250
  v_add_u32 v250, 256, v250
  v_cmp_gt_u32 vcc, 18, v2
  v_mov_b32 v5, 1073741824
  s_nop 0
  v_cndmask_b32 v250, v5, v250, vcc
  s_mul_i32 s30, s30, 128
  s_add_u32 s30, s30, 5308416
  v_lshlrev_b32 v251, 7, v2
  v_add_u32 v251, s30, v251
  v_cmp_gt_u32 vcc, 1, v2
  s_nop 1
  v_cndmask_b32 v251, v5, v251, vcc
  s_mov_b32 s46, 5308416
  s_mov_b32 s47, 0x20000
  s_mov_b32 s73, 16039936
  s_cmp_lg_u32 s21, 0
  s_cbranch_scc1 KM_WB_O
  v_and_b32 v248, 63, v0
  v_cmp_gt_u32 vcc, 16, v248
  v_lshlrev_b32 v248, 7, v248
  v_mov_b32 v249, 1073741824
  v_cndmask_b32 v248, v249, v248, vcc
  s_lshr_b32 s30, s2, 4
  s_lshl_b32 s30, s30, 11
  s_add_u32 s30, s30, s73
  s_mov_b32 s31, 200000
KM_WB_P:
  buffer_load_dword v249, v248, s[48:51], s30 offen sc1
  s_sub_u32 s31, s31, 1
  s_cmp_eq_u32 s31, 0
  s_cbranch_scc1 KM_WB_X
  s_waitcnt vmcnt(0)
  v_cmp_ne_u32 vcc, 16, v249
  s_nop 0
  s_and_b32 s32, vcc_lo, 0xffff
  s_cbranch_scc0 KM_WB_X
  s_sleep 8
  s_branch KM_WB_P
KM_WB_O:
KM_WB_X:
  s_barrier
  s_mov_b32 m0, s75
  s_nop 0
  buffer_load_dwordx4 v184, s[48:51], s74 offen offset:0 sc1 lds
  buffer_load_dwordx4 v184, s[48:51], s74 offen offset:1024 sc1 lds
  buffer_load_dwordx4 v184, s[48:51], s74 offen offset:2048 sc1 lds
  buffer_load_dwordx4 v184, s[48:51], s74 offen offset:3072 sc1 lds
  s_add_u32 m0, s75, 4096
  s_add_u32 s74, s74, 4096
  buffer_load_dwordx4 v184, s[48:51], s74 offen sc1 lds
  s_waitcnt vmcnt(0) lgkmcnt(0)
  s_barrier
  ds_read_b64_tr_b16 v[96:97], v56 offset:0
  ds_read_b64_tr_b16 v[98:99], v57 offset:0
  ds_read_b64_tr_b16 v[100:101], v56 offset:8
  ds_read_b64_tr_b16 v[102:103], v57 offset:8
  ds_read_b64_tr_b16 v[104:105], v58 offset:0
  ds_read_b64_tr_b16 v[106:107], v59 offset:0
  ds_read_b64_tr_b16 v[108:109], v58 offset:8
  ds_read_b64_tr_b16 v[110:111], v59 offset:8
  ds_read_b64_tr_b16 v[112:113], v60 offset:0
  ds_read_b64_tr_b16 v[114:115], v61 offset:0
  ds_read_b64_tr_b16 v[116:117], v60 offset:8
  ds_read_b64_tr_b16 v[118:119], v61 offset:8
  ds_read_b128 v[26:29], v12 offset:0
  ds_read_b128 v[30:33], v12 offset:512
  ds_read_b32 v34, v13 offset:0
  buffer_load_dword v252, v250, s[8:11], 0 offen
  buffer_load_dword v252, v250, s[12:15], 0 offen
  buffer_load_dword v252, v251, s[44:47], 0 offen
  s_waitcnt vmcnt(17)
  s_waitcnt lgkmcnt(11)
  v_mfma_f32_16x16x32_bf16 v[120:123], v[96:99], v[64:67], 0
  v_lshlrev_b32 v198, 16, v16
  v_and_b32 v199, 0xffff0000, v16
  v_mfma_f32_16x16x32_bf16 v[120:123], v[100:103], v[72:75], v[120:123]
  v_lshlrev_b32 v200, 16, v17
  v_and_b32 v201, 0xffff0000, v17
  v_mfma_f32_16x16x32_bf16 v[124:127], v[96:99], v[68:71], 0
  v_lshlrev_b32 v202, 16, v18
  v_and_b32 v203, 0xffff0000, v18
  v_mfma_f32_16x16x32_bf16 v[124:127], v[100:103], v[76:79], v[124:127]
  v_lshlrev_b32 v204, 16, v19
  v_and_b32 v205, 0xffff0000, v19
  s_waitcnt lgkmcnt(7)
  v_mfma_f32_16x16x32_bf16 v[128:131], v[104:107], v[64:67], 0
  v_lshlrev_b32 v206, 16, v20
  v_and_b32 v207, 0xffff0000, v20
  v_mfma_f32_16x16x32_bf16 v[128:131], v[108:111], v[72:75], v[128:131]
  v_lshlrev_b32 v208, 16, v21
  v_and_b32 v209, 0xffff0000, v21
  v_mfma_f32_16x16x32_bf16 v[132:135], v[104:107], v[68:71], 0
  v_lshlrev_b32 v210, 16, v22
  v_and_b32 v211, 0xffff0000, v22
  v_mfma_f32_16x16x32_bf16 v[132:135], v[108:111], v[76:79], v[132:135]
  v_lshlrev_b32 v212, 16, v23
  v_and_b32 v213, 0xffff0000, v23
  s_waitcnt lgkmcnt(3)
  v_mfma_f32_16x16x32_bf16 v[136:139], v[112:115], v[64:67], 0
  v_lshlrev_b32 v214, 16, v24
  v_and_b32 v215, 0xffff0000, v24
  v_mfma_f32_16x16x32_bf16 v[136:139], v[116:119], v[72:75], v[136:139]
  v_mul_f32 v86, v124, v83
  v_mul_f32 v124, v124, v80
  v_mfma_f32_16x16x32_bf16 v[140:143], v[112:115], v[68:71], 0
  v_fma_f32 v124, v120, v83, v124
  v_fma_f32 v120, v120, v80, -v86
  v_mfma_f32_16x16x32_bf16 v[140:143], v[116:119], v[76:79], v[140:143]
  v_mul_f32 v87, v125, v83
  v_mul_f32 v125, v125, v80
  v_fma_f32 v125, v121, v83, v125
  v_fma_f32 v121, v121, v80, -v87
  v_pk_mul_f32 v[86:87], v[126:127], v[82:83] op_sel:[0,1] op_sel_hi:[1,1]
  v_pk_mul_f32 v[126:127], v[126:127], v[80:81] op_sel:[0,0] op_sel_hi:[1,0]
  v_pk_fma_f32 v[126:127], v[122:123], v[82:83], v[126:127] op_sel:[0,1,0] op_sel_hi:[1,1,1]
  v_pk_fma_f32 v[122:123], v[122:123], v[80:81], v[86:87] op_sel:[0,0,0] op_sel_hi:[1,0,1] neg_lo:[0,0,1] neg_hi:[0,0,1]
  v_cvt_pk_bf16_f32 v144, v120, v124
  v_cvt_pk_bf16_f32 v148, v121, v125
  v_cvt_pk_bf16_f32 v152, v122, v126
  v_cvt_pk_bf16_f32 v156, v123, v127
  v_pk_mul_f32 v[86:87], v[132:133], v[84:85] op_sel:[0,0] op_sel_hi:[1,0]
  v_pk_mul_f32 v[132:133], v[132:133], v[80:81] op_sel:[0,1] op_sel_hi:[1,1]
  v_pk_fma_f32 v[132:133], v[128:129], v[84:85], v[132:133] op_sel:[0,0,0] op_sel_hi:[1,0,1]
  v_pk_fma_f32 v[128:129], v[128:129], v[80:81], v[86:87] op_sel:[0,1,0] op_sel_hi:[1,1,1] neg_lo:[0,0,1] neg_hi:[0,0,1]
  v_pk_mul_f32 v[86:87], v[134:135], v[84:85] op_sel:[0,0] op_sel_hi:[1,0]
  v_pk_mul_f32 v[134:135], v[134:135], v[80:81] op_sel:[0,1] op_sel_hi:[1,1]
  v_pk_fma_f32 v[134:135], v[130:131], v[84:85], v[134:135] op_sel:[0,0,0] op_sel_hi:[1,0,1]
  v_pk_fma_f32 v[130:131], v[130:131], v[80:81], v[86:87] op_sel:[0,1,0] op_sel_hi:[1,1,1] neg_lo:[0,0,1] neg_hi:[0,0,1]
  v_cvt_pk_bf16_f32 v145, v128, v132
  v_cvt_pk_bf16_f32 v149, v129, v133
  v_cvt_pk_bf16_f32 v153, v130, v134
  v_cvt_pk_bf16_f32 v157, v131, v135
  v_pk_mul_f32 v[86:87], v[140:141], v[84:85] op_sel:[0,1] op_sel_hi:[1,1]
  v_pk_mul_f32 v[140:141], v[140:141], v[82:83] op_sel:[0,0] op_sel_hi:[1,0]
  v_pk_fma_f32 v[140:141], v[136:137], v[84:85], v[140:141] op_sel:[0,1,0] op_sel_hi:[1,1,1]
  v_pk_fma_f32 v[136:137], v[136:137], v[82:83], v[86:87] op_sel:[0,0,0] op_sel_hi:[1,0,1] neg_lo:[0,0,1] neg_hi:[0,0,1]
  v_pk_mul_f32 v[86:87], v[142:143], v[84:85] op_sel:[0,1] op_sel_hi:[1,1]
  v_pk_mul_f32 v[142:143], v[142:143], v[82:83] op_sel:[0,0] op_sel_hi:[1,0]
  v_pk_fma_f32 v[142:143], v[138:139], v[84:85], v[142:143] op_sel:[0,1,0] op_sel_hi:[1,1,1]
  v_pk_fma_f32 v[138:139], v[138:139], v[82:83], v[86:87] op_sel:[0,0,0] op_sel_hi:[1,0,1] neg_lo:[0,0,1] neg_hi:[0,0,1]
  v_cvt_pk_bf16_f32 v146, v136, v140
  v_cvt_pk_bf16_f32 v150, v137, v141
  v_cvt_pk_bf16_f32 v154, v138, v142
  v_cvt_pk_bf16_f32 v158, v139, v143
  v_mfma_f32_16x16x32_bf16 v[96:99], v[144:147], v[88:91], 0
  v_mfma_f32_16x16x32_bf16 v[100:103], v[144:147], v[92:95], 0
  v_mfma_f32_16x16x32_bf16 v[104:107], v[148:151], v[88:91], 0
  v_mfma_f32_16x16x32_bf16 v[108:111], v[148:151], v[92:95], 0
  v_mfma_f32_16x16x32_bf16 v[112:115], v[152:155], v[88:91], 0
  v_mfma_f32_16x16x32_bf16 v[116:119], v[152:155], v[92:95], 0
  v_mfma_f32_16x16x32_bf16 v[120:123], v[156:159], v[88:91], 0
  v_mfma_f32_16x16x32_bf16 v[124:127], v[156:159], v[92:95], 0
  ds_read_b128 v[36:39], v12 offset:1152
  ds_read_b128 v[40:43], v12 offset:1664
  ds_read_b32 v44, v13 offset:1152
  ds_read_b128 v[46:49], v12 offset:2304
  ds_read_b128 v[50:53], v12 offset:2816
  ds_read_b32 v54, v13 offset:2304
  v_cvt_pk_bf16_f32 v96, v96, v97
  v_cvt_pk_bf16_f32 v97, v98, v99
  v_cvt_pk_bf16_f32 v100, v100, v101
  v_cvt_pk_bf16_f32 v101, v102, v103
  ds_write_b64 v62, v[96:97] offset:0
  v_cvt_pk_bf16_f32 v104, v104, v105
  v_cvt_pk_bf16_f32 v105, v106, v107
  v_cvt_pk_bf16_f32 v108, v108, v109
  v_cvt_pk_bf16_f32 v109, v110, v111
  ds_write_b64 v62, v[104:105] offset:1168
  v_cvt_pk_bf16_f32 v112, v112, v113
  v_cvt_pk_bf16_f32 v113, v114, v115
  v_cvt_pk_bf16_f32 v116, v116, v117
  v_cvt_pk_bf16_f32 v117, v118, v119
  ds_write_b64 v62, v[112:113] offset:2336
  v_cvt_pk_bf16_f32 v120, v120, v121
  v_cvt_pk_bf16_f32 v121, v122, v123
  v_cvt_pk_bf16_f32 v124, v124, v125
  v_cvt_pk_bf16_f32 v125, v126, v127
  ds_write_b64 v62, v[120:121] offset:3504
  s_mov_b32 exec_lo, 0x00030003
  s_mov_b32 exec_hi, 0x00030003
  ds_write_b64 v62, v[100:101] offset:1024
  ds_write_b64 v62, v[108:109] offset:2192
  ds_write_b64 v62, v[116:117] offset:3360
  ds_write_b64 v62, v[124:125] offset:4528
  s_mov_b64 exec, -1
  s_waitcnt lgkmcnt(14)
  v_lshlrev_b32 v146, 16, v26
  v_and_b32 v147, 0xffff0000, v26
  v_lshlrev_b32 v148, 16, v27
  v_and_b32 v149, 0xffff0000, v27
  v_lshlrev_b32 v150, 16, v28
  v_and_b32 v151, 0xffff0000, v28
  v_lshlrev_b32 v152, 16, v29
  v_and_b32 v153, 0xffff0000, v29
  v_lshlrev_b32 v154, 16, v30
  v_and_b32 v155, 0xffff0000, v30
  v_lshlrev_b32 v156, 16, v31
  v_and_b32 v157, 0xffff0000, v31
  v_lshlrev_b32 v158, 16, v32
  v_and_b32 v159, 0xffff0000, v32
  v_lshlrev_b32 v160, 16, v33
  v_and_b32 v161, 0xffff0000, v33
  v_lshlrev_b32 v162, 16, v34
  v_and_b32 v163, 0xffff0000, v34
  s_waitcnt lgkmcnt(0)
  s_barrier
  ds_read_b128 v[220:223], v63
  ds_read_b128 v[224:227], v63 offset:512
  ds_read_b32 v228, v15
  v_and_b32 v5, 7, v0
  v_lshrrev_b32 v230, 3, v0
  v_mul_u32_u24 v229, 1168, v5
  v_lshl_add_u32 v229, v230, 4, v229
  v_add_u32 v229, 131328, v229
  v_lshlrev_b32 v230, 8, v230
  v_lshl_add_u32 v230, v5, 4, v230
  v_mov_b32 v231, 1073741824
  v_cmp_gt_u32 vcc, 64, v0
  s_nop 1
  v_cndmask_b32 v231, v231, v230, vcc
  s_mul_i32 s59, s55, 18432
  s_lshl_b32 s60, s56, 7
  s_add_u32 s59, s59, s60
  s_add_u32 s59, s59, 12582912
  s_add_u32 s60, s59, 8192
  s_add_u32 s62, s59, 16384
  s_mov_b32 s75, s61
  s_waitcnt lgkmcnt(0)
  v_lshlrev_b32 v96, 16, v220
  v_and_b32 v97, 0xffff0000, v220
  v_lshlrev_b32 v98, 16, v221
  v_and_b32 v99, 0xffff0000, v221
  v_lshlrev_b32 v100, 16, v222
  v_and_b32 v101, 0xffff0000, v222
  v_lshlrev_b32 v102, 16, v223
  v_and_b32 v103, 0xffff0000, v223
  v_lshlrev_b32 v104, 16, v224
  v_and_b32 v105, 0xffff0000, v224
  v_lshlrev_b32 v106, 16, v225
  v_and_b32 v107, 0xffff0000, v225
  v_lshlrev_b32 v108, 16, v226
  v_and_b32 v109, 0xffff0000, v226
  v_lshlrev_b32 v110, 16, v227
  v_and_b32 v111, 0xffff0000, v227
  v_lshlrev_b32 v112, 16, v228
  v_and_b32 v113, 0xffff0000, v228
  v_pk_fma_f32 v[198:199], v[146:147], v[96:97], v[198:199]
  v_pk_fma_f32 v[200:201], v[148:149], v[98:99], v[200:201]
  v_pk_fma_f32 v[202:203], v[150:151], v[100:101], v[202:203]
  v_pk_fma_f32 v[204:205], v[152:153], v[102:103], v[204:205]
  v_pk_fma_f32 v[206:207], v[154:155], v[104:105], v[206:207]
  v_pk_fma_f32 v[208:209], v[156:157], v[106:107], v[208:209]
  v_pk_fma_f32 v[210:211], v[158:159], v[108:109], v[210:211]
  v_pk_fma_f32 v[212:213], v[160:161], v[110:111], v[212:213]
  v_pk_fma_f32 v[214:215], v[162:163], v[112:113], v[214:215]
  v_cvt_pk_bf16_f32 v16, v198, v199
  v_cvt_pk_bf16_f32 v17, v200, v201
  v_cvt_pk_bf16_f32 v18, v202, v203
  v_cvt_pk_bf16_f32 v19, v204, v205
  v_cvt_pk_bf16_f32 v20, v206, v207
  v_cvt_pk_bf16_f32 v21, v208, v209
  v_cvt_pk_bf16_f32 v22, v210, v211
  v_cvt_pk_bf16_f32 v23, v212, v213
  v_cvt_pk_bf16_f32 v24, v214, v215
  v_lshlrev_b32 v198, 16, v16
  v_and_b32 v199, 0xffff0000, v16
  v_lshlrev_b32 v200, 16, v17
  v_and_b32 v201, 0xffff0000, v17
  v_lshlrev_b32 v202, 16, v18
  v_and_b32 v203, 0xffff0000, v18
  v_lshlrev_b32 v204, 16, v19
  v_and_b32 v205, 0xffff0000, v19
  v_lshlrev_b32 v206, 16, v20
  v_and_b32 v207, 0xffff0000, v20
  v_lshlrev_b32 v208, 16, v21
  v_and_b32 v209, 0xffff0000, v21
  v_lshlrev_b32 v210, 16, v22
  v_and_b32 v211, 0xffff0000, v22
  v_lshlrev_b32 v212, 16, v23
  v_and_b32 v213, 0xffff0000, v23
  v_lshlrev_b32 v214, 16, v24
  v_and_b32 v215, 0xffff0000, v24
  v_pk_add_f32 v[164:165], v[198:199], v[200:201]
  v_pk_add_f32 v[164:165], v[164:165], v[202:203]
  v_pk_add_f32 v[164:165], v[164:165], v[204:205]
  v_pk_add_f32 v[164:165], v[164:165], v[206:207]
  v_pk_add_f32 v[164:165], v[164:165], v[208:209]
  v_pk_add_f32 v[164:165], v[164:165], v[210:211]
  v_pk_add_f32 v[164:165], v[164:165], v[212:213]
  v_pk_add_f32 v[164:165], v[164:165], v[214:215]
  v_add_f32 v164, v164, v165
  v_lshlrev_b32 v96, 16, v36
  v_and_b32 v97, 0xffff0000, v36
  v_add_f32_dpp v164, v164, v164 row_ror:8 row_mask:0xf bank_mask:0xf
  v_lshlrev_b32 v98, 16, v37
  v_and_b32 v99, 0xffff0000, v37
  v_add_f32_dpp v164, v164, v164 row_ror:4 row_mask:0xf bank_mask:0xf
  v_lshlrev_b32 v100, 16, v38
  v_and_b32 v101, 0xffff0000, v38
  v_add_f32_dpp v164, v164, v164 row_ror:2 row_mask:0xf bank_mask:0xf
  v_lshlrev_b32 v102, 16, v39
  v_and_b32 v103, 0xffff0000, v39
  v_add_f32_dpp v164, v164, v164 row_ror:1 row_mask:0xf bank_mask:0xf
  v_mov_b32 v165, v164
  v_lshlrev_b32 v104, 16, v40
  v_and_b32 v105, 0xffff0000, v40
  v_permlane16_swap_b32 v164, v165
  v_add_f32 v164, v164, v165
  v_mul_f32 v164, 0xbae38e39, v164
  v_cvt_pk_bf16_f32 v167, v164, v164
  v_pk_add_f32 v[198:199], v[198:199], v[164:165] op_sel_hi:[1,0]
  v_pk_add_f32 v[200:201], v[200:201], v[164:165] op_sel_hi:[1,0]
  v_pk_add_f32 v[202:203], v[202:203], v[164:165] op_sel_hi:[1,0]
  v_pk_add_f32 v[204:205], v[204:205], v[164:165] op_sel_hi:[1,0]
  v_pk_add_f32 v[206:207], v[206:207], v[164:165] op_sel_hi:[1,0]
  v_pk_add_f32 v[208:209], v[208:209], v[164:165] op_sel_hi:[1,0]
  v_pk_add_f32 v[210:211], v[210:211], v[164:165] op_sel_hi:[1,0]
  v_pk_add_f32 v[212:213], v[212:213], v[164:165] op_sel_hi:[1,0]
  v_pk_add_f32 v[214:215], v[214:215], v[164:165] op_sel_hi:[1,0]
  v_and_b32 v167, 0xffff0000, v167
  v_sub_f32 v167, v167, v164
  v_pk_mul_f32 v[164:165], v[198:199], v[198:199]
  v_pk_fma_f32 v[164:165], v[200:201], v[200:201], v[164:165]
  v_pk_fma_f32 v[164:165], v[202:203], v[202:203], v[164:165]
  v_pk_fma_f32 v[164:165], v[204:205], v[204:205], v[164:165]
  v_pk_fma_f32 v[164:165], v[206:207], v[206:207], v[164:165]
  v_pk_fma_f32 v[164:165], v[208:209], v[208:209], v[164:165]
  v_pk_fma_f32 v[164:165], v[210:211], v[210:211], v[164:165]
  v_pk_fma_f32 v[164:165], v[212:213], v[212:213], v[164:165]
  v_pk_fma_f32 v[164:165], v[214:215], v[214:215], v[164:165]
  v_add_f32 v164, v164, v165
  v_lshlrev_b32 v106, 16, v41
  v_and_b32 v107, 0xffff0000, v41
  v_add_f32_dpp v164, v164, v164 row_ror:8 row_mask:0xf bank_mask:0xf
  v_lshlrev_b32 v108, 16, v42
  v_and_b32 v109, 0xffff0000, v42
  v_add_f32_dpp v164, v164, v164 row_ror:4 row_mask:0xf bank_mask:0xf
  v_lshlrev_b32 v110, 16, v43
  v_and_b32 v111, 0xffff0000, v43
  v_add_f32_dpp v164, v164, v164 row_ror:2 row_mask:0xf bank_mask:0xf
  v_lshlrev_b32 v112, 16, v44
  v_and_b32 v113, 0xffff0000, v44
  v_add_f32_dpp v164, v164, v164 row_ror:1 row_mask:0xf bank_mask:0xf
  v_mov_b32 v165, v164
  v_lshlrev_b32 v146, 16, v46
  v_and_b32 v147, 0xffff0000, v46
  v_permlane16_swap_b32 v164, v165
  v_add_f32 v164, v164, v165
  v_mul_f32 v166, 0x3ae38e39, v164
  v_cvt_pk_bf16_f32 v166, v166, v166
  v_and_b32 v166, 0xffff0000, v166
  v_add_f32 v166, 0x3727c5ac, v166
  v_cvt_pk_bf16_f32 v166, v166, v166
  v_and_b32 v166, 0xffff0000, v166
  v_sqrt_f32 v166, v166
  v_lshlrev_b32 v148, 16, v47
  v_cvt_pk_bf16_f32 v166, v166, v166
  v_and_b32 v166, 0xffff0000, v166
  v_rcp_f32 v166, v166
  v_and_b32 v149, 0xffff0000, v47
  v_mul_f32 v167, v167, v166
  v_lshlrev_b32 v150, 16, v48
  v_and_b32 v151, 0xffff0000, v48
  v_lshlrev_b32 v152, 16, v49
  v_and_b32 v153, 0xffff0000, v49
  v_lshlrev_b32 v154, 16, v50
  v_and_b32 v155, 0xffff0000, v50
  v_lshlrev_b32 v156, 16, v51
  v_and_b32 v157, 0xffff0000, v51
  v_lshlrev_b32 v158, 16, v52
  v_and_b32 v159, 0xffff0000, v52
  v_lshlrev_b32 v160, 16, v53
  v_and_b32 v161, 0xffff0000, v53
  v_lshlrev_b32 v162, 16, v54
  v_and_b32 v163, 0xffff0000, v54
  v_pk_fma_f32 v[198:199], v[198:199], v[166:167], v[166:167] op_sel:[0,0,1] op_sel_hi:[1,0,1]
  v_pk_fma_f32 v[200:201], v[200:201], v[166:167], v[166:167] op_sel:[0,0,1] op_sel_hi:[1,0,1]
  v_pk_fma_f32 v[202:203], v[202:203], v[166:167], v[166:167] op_sel:[0,0,1] op_sel_hi:[1,0,1]
  v_pk_fma_f32 v[204:205], v[204:205], v[166:167], v[166:167] op_sel:[0,0,1] op_sel_hi:[1,0,1]
  v_pk_fma_f32 v[206:207], v[206:207], v[166:167], v[166:167] op_sel:[0,0,1] op_sel_hi:[1,0,1]
  v_pk_fma_f32 v[208:209], v[208:209], v[166:167], v[166:167] op_sel:[0,0,1] op_sel_hi:[1,0,1]
  v_pk_fma_f32 v[210:211], v[210:211], v[166:167], v[166:167] op_sel:[0,0,1] op_sel_hi:[1,0,1]
  v_pk_fma_f32 v[212:213], v[212:213], v[166:167], v[166:167] op_sel:[0,0,1] op_sel_hi:[1,0,1]
  v_pk_fma_f32 v[214:215], v[214:215], v[166:167], v[166:167] op_sel:[0,0,1] op_sel_hi:[1,0,1]
  v_pk_fma_f32 v[198:199], v[198:199], v[146:147], v[96:97]
  v_pk_fma_f32 v[200:201], v[200:201], v[148:149], v[98:99]
  v_pk_fma_f32 v[202:203], v[202:203], v[150:151], v[100:101]
  v_pk_fma_f32 v[204:205], v[204:205], v[152:153], v[102:103]
  v_pk_fma_f32 v[206:207], v[206:207], v[154:155], v[104:105]
  v_pk_fma_f32 v[208:209], v[208:209], v[156:157], v[106:107]
  v_pk_fma_f32 v[210:211], v[210:211], v[158:159], v[108:109]
  v_pk_fma_f32 v[212:213], v[212:213], v[160:161], v[110:111]
  v_pk_fma_f32 v[214:215], v[214:215], v[162:163], v[112:113]
  v_cvt_pk_bf16_f32 v64, v198, v199
  v_cvt_pk_bf16_f32 v65, v200, v201
  v_cvt_pk_bf16_f32 v66, v202, v203
  v_cvt_pk_bf16_f32 v67, v204, v205
  v_cvt_pk_bf16_f32 v68, v206, v207
  v_cvt_pk_bf16_f32 v69, v208, v209
  v_cvt_pk_bf16_f32 v70, v210, v211
  v_cvt_pk_bf16_f32 v71, v212, v213
  v_cvt_pk_bf16_f32 v72, v214, v215
  ds_write_b128 v55, v[64:67]
  ds_write_b128 v55, v[68:71] offset:512
  ds_write_b32 v15, v72
  s_waitcnt lgkmcnt(0)
  s_barrier
  ds_read_b128 v[64:67], v229 offset:0
  ds_read_b128 v[68:71], v229 offset:512
  ds_read_b128 v[72:75], v229 offset:1024
  s_waitcnt lgkmcnt(2)
  buffer_store_dwordx4 v[64:67], v230, s[48:51], s59 offen sc1
  s_waitcnt lgkmcnt(1)
  buffer_store_dwordx4 v[68:71], v230, s[48:51], s60 offen sc1
  s_waitcnt lgkmcnt(0)
  buffer_store_dwordx4 v[72:75], v231, s[48:51], s62 offen sc1
  v_add_u32 v12, 16128, v55
  v_add_u32 v13, 16128, v15
  ds_write_b128 v12, v[16:19]
  ds_write_b128 v12, v[20:23] offset:512
  ds_write_b32 v13, v24
  v_accvgpr_write_b32 a246, v12
  v_accvgpr_write_b32 a247, v13
  v_accvgpr_write_b32 a248, v6
  v_accvgpr_write_b32 a249, v7
  s_add_u32 s23, s24, 0
  s_add_u32 m0, s22, 36864
  s_nop 0
  buffer_load_dwordx4 v180, s[12:15], s23 offen lds
  s_add_u32 s23, s23, 294912
  s_add_u32 m0, s22, 40960
  s_nop 0
  buffer_load_dwordx4 v180, s[12:15], s23 offen lds
  s_add_u32 s23, s23, 294912
  s_add_u32 m0, s22, 45056
  s_nop 0
  buffer_load_dwordx4 v180, s[12:15], s23 offen lds
  s_add_u32 s23, s23, 294912
  s_add_u32 m0, s22, 49152
  s_nop 0
  buffer_load_dwordx4 v180, s[12:15], s23 offen lds
  s_add_u32 s23, s23, 294912
  s_add_u32 m0, s22, 53248
  s_nop 0
  buffer_load_dwordx4 v180, s[12:15], s23 offen lds
  s_add_u32 s23, s23, 294912
  s_add_u32 m0, s22, 57344
  s_nop 0
  buffer_load_dwordx4 v180, s[12:15], s23 offen lds
  s_add_u32 s23, s23, 294912
  s_add_u32 m0, s22, 61440
  s_nop 0
  buffer_load_dwordx4 v180, s[12:15], s23 offen lds
  s_add_u32 s23, s23, 294912
  s_add_u32 m0, s22, 65536
  s_nop 0
  buffer_load_dwordx4 v180, s[12:15], s23 offen lds
  s_add_u32 s23, s23, 294912
  s_add_u32 m0, s22, 69632
  s_nop 0
  buffer_load_dwordx4 v180, s[12:15], s23 offen lds
  s_mov_b32 s46, 5308416
  s_mov_b32 s47, 0x20000
  s_mul_i32 s52, s24, 576
  s_mul_i32 s33, s56, 640
  s_add_u32 s26, s52, s33
  s_mul_i32 s27, s56, 4294635520
  s_add_u32 s27, s27, 36864
  s_xor_b32 s59, s42, 1
  s_xor_b32 s60, s56, 1
  s_mul_i32 s59, s59, 288
  s_lshl_b32 s62, s60, 5
  s_add_u32 s59, s59, s62
  s_mul_i32 s59, s59, 1152
  s_add_u32 s29, s59, s33
  s_mul_i32 s30, s60, 4294635520
  s_add_u32 s30, s30, 36864
  s_lshl_b32 s59, s43, 4
  s_add_u32 s59, s59, s42
  s_xor_b32 s60, s59, 1
  s_mul_i32 s28, s59, 81920
  s_add_u32 s28, s28, 16777216
  s_mul_i32 s31, s59, 73728
  s_add_u32 s31, s31, 67108864
  s_mul_i32 s32, s60, 73728
  s_add_u32 s32, s32, 67108864
  s_lshl_b32 s62, s21, 8
  s_add_u32 s62, s62, 15745024
  s_lshl_b32 s59, s59, 10
  s_add_u32 s34, s59, s62
  s_lshl_b32 s60, s60, 10
  s_add_u32 s35, s60, s62
  s_lshl_b32 s38, s43, 3
  s_lshl_b32 s39, s21, 1
  s_add_u32 s38, s38, s39
  s_mul_i32 s38, s38, 18432
  s_add_u32 s38, s38, 12582912
  s_add_u32 s39, s38, 18432
  s_lshl_b32 s59, s43, 7
  s_add_u32 s59, s59, 15728640
  v_lshl_add_u32 v183, v1, 12, v184
  v_mul_u32_u24 v5, 18432, v1
  v_add_u32 v185, v5, v184
  v_mov_b32 v186, 1073741824
  v_cmp_eq_u32 vcc, 0, v2
  v_mov_b32 v14, 1
  s_nop 0
  v_cndmask_b32 v186, v186, 0, vcc
  s_mov_b32 s70, 2359296
  s_mov_b32 s71, 0x20000
  s_mul_i32 s72, s43, 1310720
  s_lshr_b32 s60, s42, 1
  s_lshl_b32 s60, s60, 11
  s_add_u32 s72, s72, s60
  s_lshl_b32 s60, s56, 7
  s_add_u32 s72, s72, s60
  s_add_u32 s72, s72, 16777216
  s_mul_i32 s74, s43, 768
  s_add_u32 s74, s74, 15730688
  v_cmp_eq_u32 vcc, 0, v0
  v_mov_b32 v12, 1073741824
  s_nop 0
  v_cndmask_b32 v12, v12, 0, vcc
  s_and_b32 s60, s21, 1
  s_lshr_b32 s61, s21, 1
  v_and_b32 v3, 7, v2
  v_bfe_u32 v4, v2, 3, 1
  v_lshrrev_b32 v5, 4, v2
  v_lshrrev_b32 v6, 5, v2
  v_bfe_u32 v7, v2, 3, 2
  v_mul_u32_u24 v8, 81920, v5
  v_lshl_add_u32 v8, v4, 8, v8
  v_lshl_add_u32 v8, v3, 4, v8
  s_lshl_b32 s62, s61, 9
  s_lshl_b32 s63, s60, 10
  s_add_u32 s62, s62, s63
  v_add_u32 v8, s62, v8
  v_accvgpr_write_b32 a240, v8
  v_lshlrev_b32 v8, 5, v5
  v_lshl_add_u32 v8, v4, 3, v8
  s_lshl_b32 s62, s61, 4
  s_lshl_b32 s63, s60, 6
  s_add_u32 s62, s62, s63
  s_add_u32 s62, s62, 512
  v_add_u32 v8, s62, v8
  v_mul_u32_u24 v9, 1168, v3
  v_add3_u32 v10, v8, v9, 0
  v_add_u32 v10, 147456, v10
  v_add_u32 v8, 160256, v8
KA_I2:
  s_cbranch_execz KA_I3
  v_cmp_gt_u32 vcc, 32, v2
  v_mov_b32 v11, 161920
  s_nop 0
  v_cndmask_b32 v10, v11, v10, vcc
  v_cndmask_b32 v8, v11, v8, vcc
  v_accvgpr_write_b32 a241, v10
  v_accvgpr_write_b32 a242, v8
  v_mul_u32_u24 v8, 163840, v6
  v_lshl_add_u32 v8, v7, 8, v8
  v_lshl_add_u32 v8, v3, 4, v8
  s_mul_i32 s62, s61, 81920
  s_lshl_b32 s63, s60, 10
  s_add_u32 s62, s62, s63
  v_add_u32 v8, s62, v8
  v_accvgpr_write_b32 a243, v8
  v_lshlrev_b32 v8, 5, v6
  v_lshl_add_u32 v8, v7, 3, v8
  s_mul_i32 s62, s61, 640
  s_lshl_b32 s63, s60, 6
  s_add_u32 s62, s62, s63
  v_add_u32 v8, s62, v8
  v_add_u32 v10, v8, v9
  v_add_u32 v10, 147456, v10
  v_add_u32 v8, 160256, v8
  v_accvgpr_write_b32 a244, v10
  v_accvgpr_write_b32 a245, v8
  v_and_b32 v8, 1, v2
  v_lshlrev_b32 v8, 4, v8
  v_mov_b32 v9, 0x3f80
  v_lshlrev_b32 v8, v8, v9
  v_bfe_u32 v9, v2, 1, 1
  v_lshl_or_b32 v10, v4, 1, v9
  v_bfe_u32 v11, v2, 2, 1
  v_and_b32 v3, 1, v5
  v_cmp_eq_u32 s[62:63], v11, v3
  v_lshl_or_b32 v9, v11, 1, v9
  s_nop 0
  v_cndmask_b32 v3, 0, v8, s[62:63]
  v_cmp_eq_u32 s[62:63], 0, v4
  s_nop 1
  v_cndmask_b32 v8, 0, v8, s[62:63]
  v_cmp_eq_u32 vcc, 0, v10
  v_cmp_eq_u32 s[62:63], 0, v9
  s_nop 0
  v_cndmask_b32 v11, 0, v3, vcc
  v_accvgpr_write_b32 a216, v11
  v_cndmask_b32 v11, 0, v8, s[62:63]
  v_accvgpr_write_b32 a220, v11
  v_cmp_eq_u32 vcc, 1, v10
  v_cmp_eq_u32 s[62:63], 1, v9
  s_nop 0
  v_cndmask_b32 v11, 0, v3, vcc
  v_accvgpr_write_b32 a217, v11
  v_cndmask_b32 v11, 0, v8, s[62:63]
  v_accvgpr_write_b32 a221, v11
  v_cmp_eq_u32 vcc, 2, v10
  v_cmp_eq_u32 s[62:63], 2, v9
  s_nop 0
  v_cndmask_b32 v11, 0, v3, vcc
  v_accvgpr_write_b32 a218, v11
  v_cndmask_b32 v11, 0, v8, s[62:63]
  v_accvgpr_write_b32 a222, v11
  v_cmp_eq_u32 vcc, 3, v10
  v_cmp_eq_u32 s[62:63], 3, v9
  s_nop 0
  v_cndmask_b32 v11, 0, v3, vcc
  v_accvgpr_write_b32 a219, v11
  v_cndmask_b32 v11, 0, v8, s[62:63]
  v_accvgpr_write_b32 a223, v11
  s_waitcnt vmcnt(9)
  s_barrier
  s_cmp_lg_u32 s21, 0
  s_cbranch_scc1 KB_NOSIG
  buffer_atomic_add v14, v186, s[48:51], s59 offen sc1
KB_NOSIG:
  v_lshrrev_b32 v3, 4, v2
  v_bfe_u32 v4, v2, 2, 2
  v_and_b32 v5, 3, v2
  v_lshl_add_u32 v6, v3, 3, v4
  v_lshlrev_b32 v6, 7, v6
  v_lshl_add_u32 v6, v5, 3, v6
  v_lshrrev_b32 v7, 1, v4
  v_and_b32 v8, 1, v3
  v_lshl_or_b32 v7, v8, 1, v7
  v_lshl_add_u32 v6, v7, 5, v6
  v_xor_b32 v172, 0, v6
  v_mov_b32 v168, v172
  v_xor_b32 v173, 32, v6
  v_mov_b32 v169, v173
  v_xor_b32 v174, 64, v6
  v_mov_b32 v170, v174
  v_xor_b32 v175, 96, v6
  v_mov_b32 v171, v175
  s_cmp_eq_u32 s21, 0
  s_cbranch_scc1 KB_P0
  s_mov_b64 exec, 0
  s_cmp_eq_u32 s21, 1
  s_cbranch_scc1 KB_I0
  s_cmp_eq_u32 s21, 2
  s_cbranch_scc1 KB_I1
  s_branch KB_I2
KB_BACK:
  s_mov_b64 exec, -1
  s_branch KB_GO
KB_P0:
  s_mov_b32 s54, 200000
KB_POLL:
  buffer_load_dword v15, v186, s[48:51], s59 offen sc1
  s_sub_u32 s54, s54, 1
  s_cmp_eq_u32 s54, 0
  s_cbranch_scc1 KB_GO
  s_waitcnt vmcnt(0)
  v_readfirstlane_b32 s53, v15
  s_nop 0
  s_cmp_ge_u32 s53, 16
  s_cbranch_scc1 KB_GO
  s_sleep 2
  s_branch KB_POLL
  s_branch KB_GO
KA_I3:
  s_branch KA_BACK
KB_P0X:
.p2align 12
KB_GO:
KB_I0:
  s_cbranch_execz KB_I3
  s_waitcnt vmcnt(26)
  s_barrier
  buffer_load_dwordx4 a[0:3], v184, s[48:51], s38 offen offset:0 sc1
  buffer_load_dwordx4 a[72:75], v184, s[48:51], s39 offen offset:0 sc1
  buffer_load_dwordx4 a[4:7], v184, s[48:51], s38 offen offset:1024 sc1
  buffer_load_dwordx4 a[76:79], v184, s[48:51], s39 offen offset:1024 sc1
  buffer_load_dwordx4 a[8:11], v184, s[48:51], s38 offen offset:2048 sc1
  buffer_load_dwordx4 a[80:83], v184, s[48:51], s39 offen offset:2048 sc1
  buffer_load_dwordx4 a[12:15], v184, s[48:51], s38 offen offset:3072 sc1
  s_add_u32 s38, s38, 4096
  buffer_load_dwordx4 a[84:87], v184, s[48:51], s39 offen offset:3072 sc1
  s_add_u32 s39, s39, 4096
  buffer_load_dwordx4 a[16:19], v184, s[48:51], s38 offen offset:0 sc1
  buffer_load_dwordx4 a[88:91], v184, s[48:51], s39 offen offset:0 sc1
  buffer_load_dwordx4 a[20:23], v184, s[48:51], s38 offen offset:1024 sc1
  buffer_load_dwordx4 a[92:95], v184, s[48:51], s39 offen offset:1024 sc1
  ds_read_b64_tr_b16 v[220:221], v168 offset:0
  ds_read_b64_tr_b16 v[222:223], v168 offset:512
  ds_read_b64_tr_b16 v[224:225], v168 offset:4096
  ds_read_b64_tr_b16 v[226:227], v168 offset:4608
  ds_read_b64_tr_b16 v[228:229], v168 offset:8192
  ds_read_b64_tr_b16 v[230:231], v168 offset:8704
  ds_read_b64_tr_b16 v[232:233], v169 offset:0
  ds_read_b64_tr_b16 v[234:235], v169 offset:512
  ds_read_b64_tr_b16 v[236:237], v169 offset:4096
  ds_read_b64_tr_b16 v[238:239], v169 offset:4608
  ds_read_b64_tr_b16 v[240:241], v169 offset:8192
  ds_read_b64_tr_b16 v[242:243], v169 offset:8704
  s_waitcnt vmcnt(6)
  s_waitcnt lgkmcnt(6)
  v_mfma_f32_16x16x32_bf16 v[88:91], v[220:223], a[0:3], 0
  ds_read_b64_tr_b16 v[244:245], v170 offset:0
  buffer_load_dwordx4 a[24:27], v184, s[48:51], s38 offen offset:2048 sc1
  v_mfma_f32_16x16x32_bf16 v[88:91], v[224:227], a[4:7], v[88:91]
  s_waitcnt vmcnt(36)
  ds_read_b64_tr_b16 v[246:247], v170 offset:512
  v_mfma_f32_16x16x32_bf16 v[88:91], v[228:231], a[8:11], v[88:91]
  s_barrier
  v_mfma_f32_16x16x32_bf16 v[92:95], v[228:231], a[80:83], 0
  ds_read_b64_tr_b16 v[248:249], v170 offset:4096
  v_mfma_f32_16x16x32_bf16 v[92:95], v[224:227], a[76:79], v[92:95]
  ds_read_b64_tr_b16 v[250:251], v170 offset:4608
  buffer_load_dwordx4 a[96:99], v184, s[48:51], s39 offen offset:2048 sc1
  v_mfma_f32_16x16x32_bf16 v[92:95], v[220:223], a[72:75], v[92:95]
  s_waitcnt lgkmcnt(4)
  ds_read_b64_tr_b16 v[252:253], v170 offset:8192
  ds_read_b64_tr_b16 v[254:255], v170 offset:8704
  v_mfma_f32_16x16x32_bf16 v[100:103], v[232:235], a[72:75], 0
  ds_read_b64_tr_b16 v[220:221], v171 offset:0
  buffer_load_dwordx4 a[28:31], v184, s[48:51], s38 offen offset:3072 sc1
  s_add_u32 s38, s38, 4096
  v_mfma_f32_16x16x32_bf16 v[100:103], v[236:239], a[76:79], v[100:103]
  ds_read_b64_tr_b16 v[222:223], v171 offset:512
  v_mfma_f32_16x16x32_bf16 v[100:103], v[240:243], a[80:83], v[100:103]
  v_mfma_f32_16x16x32_bf16 v[96:99], v[240:243], a[8:11], 0
  ds_read_b64_tr_b16 v[224:225], v171 offset:4096
  v_mfma_f32_16x16x32_bf16 v[96:99], v[236:239], a[4:7], v[96:99]
  ds_read_b64_tr_b16 v[226:227], v171 offset:4608
  buffer_load_dwordx4 a[100:103], v184, s[48:51], s39 offen offset:3072 sc1
  s_add_u32 s39, s39, 4096
  v_mfma_f32_16x16x32_bf16 v[96:99], v[232:235], a[0:3], v[96:99]
  s_waitcnt lgkmcnt(4)
  ds_read_b64_tr_b16 v[228:229], v171 offset:8192
  ds_read_b64_tr_b16 v[230:231], v171 offset:8704
  v_mfma_f32_16x16x32_bf16 v[104:107], v[244:247], a[0:3], 0
  ds_read_b64_tr_b16 v[232:233], v168 offset:12288
  buffer_load_dwordx4 a[32:35], v184, s[48:51], s38 offen offset:0 sc1
  v_mfma_f32_16x16x32_bf16 v[104:107], v[248:251], a[4:7], v[104:107]
  ds_read_b64_tr_b16 v[234:235], v168 offset:12800
  v_mfma_f32_16x16x32_bf16 v[104:107], v[252:255], a[8:11], v[104:107]
  v_mfma_f32_16x16x32_bf16 v[108:111], v[252:255], a[80:83], 0
  ds_read_b64_tr_b16 v[236:237], v168 offset:16384
  v_mfma_f32_16x16x32_bf16 v[108:111], v[248:251], a[76:79], v[108:111]
  ds_read_b64_tr_b16 v[238:239], v168 offset:16896
  buffer_load_dwordx4 a[104:107], v184, s[48:51], s39 offen offset:0 sc1
  v_mfma_f32_16x16x32_bf16 v[108:111], v[244:247], a[72:75], v[108:111]
  s_waitcnt lgkmcnt(4)
  ds_read_b64_tr_b16 v[240:241], v168 offset:20480
  ds_read_b64_tr_b16 v[242:243], v168 offset:20992
  v_mfma_f32_16x16x32_bf16 v[116:119], v[220:223], a[72:75], 0
  ds_read_b64_tr_b16 v[244:245], v169 offset:12288
  v_mfma_f32_16x16x32_bf16 v[116:119], v[224:227], a[76:79], v[116:119]
  ds_read_b64_tr_b16 v[246:247], v169 offset:12800
  v_mfma_f32_16x16x32_bf16 v[116:119], v[228:231], a[80:83], v[116:119]
  v_mfma_f32_16x16x32_bf16 v[112:115], v[228:231], a[8:11], 0
  s_waitcnt vmcnt(6)
  ds_read_b64_tr_b16 v[248:249], v169 offset:16384
  v_mfma_f32_16x16x32_bf16 v[112:115], v[224:227], a[4:7], v[112:115]
  ds_read_b64_tr_b16 v[250:251], v169 offset:16896
  buffer_load_dwordx4 a[36:39], v184, s[48:51], s38 offen offset:1024 sc1
  v_mfma_f32_16x16x32_bf16 v[112:115], v[220:223], a[0:3], v[112:115]
  s_waitcnt lgkmcnt(4)
  ds_read_b64_tr_b16 v[252:253], v169 offset:20480
  ds_read_b64_tr_b16 v[254:255], v169 offset:20992
  v_mfma_f32_16x16x32_bf16 v[88:91], v[232:235], a[12:15], v[88:91]
  ds_read_b64_tr_b16 v[220:221], v170 offset:12288
  v_mfma_f32_16x16x32_bf16 v[88:91], v[236:239], a[16:19], v[88:91]
  s_waitcnt vmcnt(39)
  ds_read_b64_tr_b16 v[222:223], v170 offset:12800
  v_mfma_f32_16x16x32_bf16 v[88:91], v[240:243], a[20:23], v[88:91]
  s_barrier
  v_mfma_f32_16x16x32_bf16 v[92:95], v[240:243], a[92:95], v[92:95]
  ds_read_b64_tr_b16 v[224:225], v170 offset:16384
  v_mfma_f32_16x16x32_bf16 v[92:95], v[236:239], a[88:91], v[92:95]
  ds_read_b64_tr_b16 v[226:227], v170 offset:16896
  buffer_load_dwordx4 a[108:111], v184, s[48:51], s39 offen offset:1024 sc1
  v_mfma_f32_16x16x32_bf16 v[92:95], v[232:235], a[84:87], v[92:95]
  s_waitcnt lgkmcnt(4)
  ds_read_b64_tr_b16 v[228:229], v170 offset:20480
  ds_read_b64_tr_b16 v[230:231], v170 offset:20992
  v_mfma_f32_16x16x32_bf16 v[100:103], v[244:247], a[84:87], v[100:103]
  s_add_u32 s23, s24, 2654208
  ds_read_b64_tr_b16 v[232:233], v171 offset:12288
  v_mfma_f32_16x16x32_bf16 v[100:103], v[248:251], a[88:91], v[100:103]
  s_add_u32 m0, s22, 73728
  ds_read_b64_tr_b16 v[234:235], v171 offset:12800
  v_mfma_f32_16x16x32_bf16 v[100:103], v[252:255], a[92:95], v[100:103]
  buffer_load_dwordx4 v180, s[8:11], s23 offen lds
  v_mfma_f32_16x16x32_bf16 v[96:99], v[252:255], a[20:23], v[96:99]
  s_add_u32 s23, s23, 294912
  ds_read_b64_tr_b16 v[236:237], v171 offset:16384
  v_mfma_f32_16x16x32_bf16 v[96:99], v[248:251], a[16:19], v[96:99]
  ds_read_b64_tr_b16 v[238:239], v171 offset:16896
  buffer_load_dwordx4 a[40:43], v184, s[48:51], s38 offen offset:2048 sc1
  v_mfma_f32_16x16x32_bf16 v[96:99], v[244:247], a[12:15], v[96:99]
  s_waitcnt lgkmcnt(4)
  ds_read_b64_tr_b16 v[240:241], v171 offset:20480
  ds_read_b64_tr_b16 v[242:243], v171 offset:20992
  v_mfma_f32_16x16x32_bf16 v[104:107], v[220:223], a[12:15], v[104:107]
  ds_read_b64_tr_b16 v[244:245], v168 offset:24576
  v_mfma_f32_16x16x32_bf16 v[104:107], v[224:227], a[16:19], v[104:107]
  s_add_u32 m0, s22, 77824
  ds_read_b64_tr_b16 v[246:247], v168 offset:25088
  v_mfma_f32_16x16x32_bf16 v[104:107], v[228:231], a[20:23], v[104:107]
  buffer_load_dwordx4 v180, s[8:11], s23 offen lds
  v_mfma_f32_16x16x32_bf16 v[108:111], v[228:231], a[92:95], v[108:111]
  s_add_u32 s23, s23, 294912
  ds_read_b64_tr_b16 v[248:249], v168 offset:28672
  v_mfma_f32_16x16x32_bf16 v[108:111], v[224:227], a[88:91], v[108:111]
  ds_read_b64_tr_b16 v[250:251], v168 offset:29184
  buffer_load_dwordx4 a[112:115], v184, s[48:51], s39 offen offset:2048 sc1
  v_mfma_f32_16x16x32_bf16 v[108:111], v[220:223], a[84:87], v[108:111]
  s_waitcnt lgkmcnt(4)
  ds_read_b64_tr_b16 v[252:253], v168 offset:32768
  ds_read_b64_tr_b16 v[254:255], v168 offset:33280
  v_mfma_f32_16x16x32_bf16 v[116:119], v[232:235], a[84:87], v[116:119]
  ds_read_b64_tr_b16 v[220:221], v169 offset:24576
  v_add_u32 v168, 36864, v172
  v_mfma_f32_16x16x32_bf16 v[116:119], v[236:239], a[88:91], v[116:119]
  s_add_u32 m0, s22, 81920
  ds_read_b64_tr_b16 v[222:223], v169 offset:25088
  v_mfma_f32_16x16x32_bf16 v[116:119], v[240:243], a[92:95], v[116:119]
  buffer_load_dwordx4 v180, s[8:11], s23 offen lds
  v_mfma_f32_16x16x32_bf16 v[112:115], v[240:243], a[20:23], v[112:115]
  s_add_u32 s23, s23, 294912
  s_waitcnt vmcnt(7)
  ds_read_b64_tr_b16 v[224:225], v169 offset:28672
  v_mfma_f32_16x16x32_bf16 v[112:115], v[236:239], a[16:19], v[112:115]
  ds_read_b64_tr_b16 v[226:227], v169 offset:29184
  buffer_load_dwordx4 a[44:47], v184, s[48:51], s38 offen offset:3072 sc1
  s_add_u32 s38, s38, 4096
  v_mfma_f32_16x16x32_bf16 v[112:115], v[232:235], a[12:15], v[112:115]
  s_waitcnt lgkmcnt(4)
  ds_read_b64_tr_b16 v[228:229], v169 offset:32768
  ds_read_b64_tr_b16 v[230:231], v169 offset:33280
  v_mfma_f32_16x16x32_bf16 v[88:91], v[244:247], a[24:27], v[88:91]
  ds_read_b64_tr_b16 v[232:233], v170 offset:24576
  v_add_u32 v169, 36864, v173
  v_mfma_f32_16x16x32_bf16 v[88:91], v[248:251], a[28:31], v[88:91]
  s_waitcnt vmcnt(32)
  ds_read_b64_tr_b16 v[234:235], v170 offset:25088
  v_mfma_f32_16x16x32_bf16 v[88:91], v[252:255], a[32:35], v[88:91]
  s_barrier
  v_mfma_f32_16x16x32_bf16 v[92:95], v[252:255], a[104:107], v[92:95]
  ds_read_b64_tr_b16 v[236:237], v170 offset:28672
  v_mfma_f32_16x16x32_bf16 v[92:95], v[248:251], a[100:103], v[92:95]
  ds_read_b64_tr_b16 v[238:239], v170 offset:29184
  buffer_load_dwordx4 a[116:119], v184, s[48:51], s39 offen offset:3072 sc1
  s_add_u32 s39, s39, 4096
  v_mfma_f32_16x16x32_bf16 v[92:95], v[244:247], a[96:99], v[92:95]
  s_waitcnt lgkmcnt(4)
  ds_read_b64_tr_b16 v[240:241], v170 offset:32768
  ds_read_b64_tr_b16 v[242:243], v170 offset:33280
  v_mfma_f32_16x16x32_bf16 v[100:103], v[220:223], a[96:99], v[100:103]
  ds_read_b64_tr_b16 v[244:245], v171 offset:24576
  v_add_u32 v170, 36864, v174
  v_mfma_f32_16x16x32_bf16 v[100:103], v[224:227], a[100:103], v[100:103]
  s_add_u32 m0, s22, 86016
  ds_read_b64_tr_b16 v[246:247], v171 offset:25088
  v_mfma_f32_16x16x32_bf16 v[100:103], v[228:231], a[104:107], v[100:103]
  buffer_load_dwordx4 v180, s[8:11], s23 offen lds
  v_mfma_f32_16x16x32_bf16 v[96:99], v[228:231], a[32:35], v[96:99]
  s_add_u32 s23, s23, 294912
  ds_read_b64_tr_b16 v[248:249], v171 offset:28672
  v_mfma_f32_16x16x32_bf16 v[96:99], v[224:227], a[28:31], v[96:99]
  ds_read_b64_tr_b16 v[250:251], v171 offset:29184
  buffer_load_dwordx4 a[48:51], v184, s[48:51], s38 offen offset:0 sc1
  v_mfma_f32_16x16x32_bf16 v[96:99], v[220:223], a[24:27], v[96:99]
  s_waitcnt lgkmcnt(4)
  ds_read_b64_tr_b16 v[252:253], v171 offset:32768
  ds_read_b64_tr_b16 v[254:255], v171 offset:33280
  v_mfma_f32_16x16x32_bf16 v[104:107], v[232:235], a[24:27], v[104:107]
  ds_read_b64_tr_b16 v[220:221], v168 offset:0
  v_add_u32 v171, 36864, v175
  v_mfma_f32_16x16x32_bf16 v[104:107], v[236:239], a[28:31], v[104:107]
  s_add_u32 m0, s22, 90112
  ds_read_b64_tr_b16 v[222:223], v168 offset:512
  v_mfma_f32_16x16x32_bf16 v[104:107], v[240:243], a[32:35], v[104:107]
  buffer_load_dwordx4 v180, s[8:11], s23 offen lds
  v_mfma_f32_16x16x32_bf16 v[108:111], v[240:243], a[104:107], v[108:111]
  s_add_u32 s23, s23, 294912
  ds_read_b64_tr_b16 v[224:225], v168 offset:4096
  v_mfma_f32_16x16x32_bf16 v[108:111], v[236:239], a[100:103], v[108:111]
  ds_read_b64_tr_b16 v[226:227], v168 offset:4608
  buffer_load_dwordx4 a[120:123], v184, s[48:51], s39 offen offset:0 sc1
  v_mfma_f32_16x16x32_bf16 v[108:111], v[232:235], a[96:99], v[108:111]
  s_waitcnt lgkmcnt(4)
  ds_read_b64_tr_b16 v[228:229], v168 offset:8192
  ds_read_b64_tr_b16 v[230:231], v168 offset:8704
  v_mfma_f32_16x16x32_bf16 v[116:119], v[244:247], a[96:99], v[116:119]
  ds_read_b64_tr_b16 v[232:233], v169 offset:0
  v_mfma_f32_16x16x32_bf16 v[116:119], v[248:251], a[100:103], v[116:119]
  s_add_u32 m0, s22, 94208
  ds_read_b64_tr_b16 v[234:235], v169 offset:512
  v_mfma_f32_16x16x32_bf16 v[116:119], v[252:255], a[104:107], v[116:119]
  buffer_load_dwordx4 v180, s[8:11], s23 offen lds
  v_mfma_f32_16x16x32_bf16 v[112:115], v[252:255], a[32:35], v[112:115]
  s_add_u32 s23, s23, 294912
  ds_read_b64_tr_b16 v[236:237], v169 offset:4096
  v_mfma_f32_16x16x32_bf16 v[112:115], v[248:251], a[28:31], v[112:115]
  ds_read_b64_tr_b16 v[238:239], v169 offset:4608
  buffer_load_dwordx4 a[52:55], v184, s[48:51], s38 offen offset:1024 sc1
  v_mfma_f32_16x16x32_bf16 v[112:115], v[244:247], a[24:27], v[112:115]
  s_waitcnt lgkmcnt(4)
  ds_read_b64_tr_b16 v[240:241], v169 offset:8192
  ds_read_b64_tr_b16 v[242:243], v169 offset:8704
  v_mfma_f32_16x16x32_bf16 v[120:123], v[220:223], a[0:3], 0
  s_nop 0
  ds_read_b64_tr_b16 v[244:245], v170 offset:0
  ds_read_b64_tr_b16 v[246:247], v170 offset:512
  v_mfma_f32_16x16x32_bf16 v[120:123], v[224:227], a[4:7], v[120:123]
  s_waitcnt vmcnt(36)
  ds_read_b64_tr_b16 v[248:249], v170 offset:4096
  v_mfma_f32_16x16x32_bf16 v[120:123], v[228:231], a[8:11], v[120:123]
  s_barrier
  v_mfma_f32_16x16x32_bf16 v[124:127], v[228:231], a[80:83], 0
  ds_read_b64_tr_b16 v[250:251], v170 offset:4608
  v_mfma_f32_16x16x32_bf16 v[124:127], v[224:227], a[76:79], v[124:127]
  buffer_load_dwordx4 a[124:127], v184, s[48:51], s39 offen offset:1024 sc1
  v_mfma_f32_16x16x32_bf16 v[124:127], v[220:223], a[72:75], v[124:127]
  s_waitcnt lgkmcnt(4)
  ds_read_b64_tr_b16 v[252:253], v170 offset:8192
  ds_read_b64_tr_b16 v[254:255], v170 offset:8704
  v_mfma_f32_16x16x32_bf16 v[132:135], v[232:235], a[72:75], 0
  s_nop 0
  ds_read_b64_tr_b16 v[220:221], v171 offset:0
  ds_read_b64_tr_b16 v[222:223], v171 offset:512
  v_mfma_f32_16x16x32_bf16 v[132:135], v[236:239], a[76:79], v[132:135]
  ds_read_b64_tr_b16 v[224:225], v171 offset:4096
  v_mfma_f32_16x16x32_bf16 v[132:135], v[240:243], a[80:83], v[132:135]
  v_mfma_f32_16x16x32_bf16 v[128:131], v[240:243], a[8:11], 0
  ds_read_b64_tr_b16 v[226:227], v171 offset:4608
  v_mfma_f32_16x16x32_bf16 v[128:131], v[236:239], a[4:7], v[128:131]
  buffer_load_dwordx4 a[56:59], v184, s[48:51], s38 offen offset:2048 sc1
  v_mfma_f32_16x16x32_bf16 v[128:131], v[232:235], a[0:3], v[128:131]
  s_waitcnt lgkmcnt(4)
  ds_read_b64_tr_b16 v[228:229], v171 offset:8192
  ds_read_b64_tr_b16 v[230:231], v171 offset:8704
  v_mfma_f32_16x16x32_bf16 v[136:139], v[244:247], a[0:3], 0
  s_nop 0
  ds_read_b64_tr_b16 v[232:233], v168 offset:12288
  ds_read_b64_tr_b16 v[234:235], v168 offset:12800
  v_mfma_f32_16x16x32_bf16 v[136:139], v[248:251], a[4:7], v[136:139]
  ds_read_b64_tr_b16 v[236:237], v168 offset:16384
  v_mfma_f32_16x16x32_bf16 v[136:139], v[252:255], a[8:11], v[136:139]
  v_mfma_f32_16x16x32_bf16 v[140:143], v[252:255], a[80:83], 0
  ds_read_b64_tr_b16 v[238:239], v168 offset:16896
  v_mfma_f32_16x16x32_bf16 v[140:143], v[248:251], a[76:79], v[140:143]
  buffer_load_dwordx4 a[128:131], v184, s[48:51], s39 offen offset:2048 sc1
  v_mfma_f32_16x16x32_bf16 v[140:143], v[244:247], a[72:75], v[140:143]
  s_waitcnt lgkmcnt(4)
  ds_read_b64_tr_b16 v[240:241], v168 offset:20480
  ds_read_b64_tr_b16 v[242:243], v168 offset:20992
  v_mfma_f32_16x16x32_bf16 v[148:151], v[220:223], a[72:75], 0
  s_nop 0
  ds_read_b64_tr_b16 v[244:245], v169 offset:12288
  ds_read_b64_tr_b16 v[246:247], v169 offset:12800
  v_mfma_f32_16x16x32_bf16 v[148:151], v[224:227], a[76:79], v[148:151]
  ds_read_b64_tr_b16 v[248:249], v169 offset:16384
  v_mfma_f32_16x16x32_bf16 v[148:151], v[228:231], a[80:83], v[148:151]
  v_mfma_f32_16x16x32_bf16 v[144:147], v[228:231], a[8:11], 0
  ds_read_b64_tr_b16 v[250:251], v169 offset:16896
  v_mfma_f32_16x16x32_bf16 v[144:147], v[224:227], a[4:7], v[144:147]
  buffer_load_dwordx4 a[60:63], v184, s[48:51], s38 offen offset:3072 sc1
  v_mfma_f32_16x16x32_bf16 v[144:147], v[220:223], a[0:3], v[144:147]
  s_waitcnt lgkmcnt(4)
  ds_read_b64_tr_b16 v[252:253], v169 offset:20480
  ds_read_b64_tr_b16 v[254:255], v169 offset:20992
  v_mfma_f32_16x16x32_bf16 v[120:123], v[232:235], a[12:15], v[120:123]
  s_add_u32 s38, s38, 4096
  ds_read_b64_tr_b16 v[220:221], v170 offset:12288
  ds_read_b64_tr_b16 v[222:223], v170 offset:12800
  v_mfma_f32_16x16x32_bf16 v[120:123], v[236:239], a[16:19], v[120:123]
  s_waitcnt vmcnt(37)
  ds_read_b64_tr_b16 v[224:225], v170 offset:16384
  v_mfma_f32_16x16x32_bf16 v[120:123], v[240:243], a[20:23], v[120:123]
  s_barrier
  v_mfma_f32_16x16x32_bf16 v[124:127], v[240:243], a[92:95], v[124:127]
  ds_read_b64_tr_b16 v[226:227], v170 offset:16896
  v_mfma_f32_16x16x32_bf16 v[124:127], v[236:239], a[88:91], v[124:127]
  buffer_load_dwordx4 a[132:135], v184, s[48:51], s39 offen offset:3072 sc1
  v_mfma_f32_16x16x32_bf16 v[124:127], v[232:235], a[84:87], v[124:127]
  s_waitcnt lgkmcnt(4)
  ds_read_b64_tr_b16 v[228:229], v170 offset:20480
  ds_read_b64_tr_b16 v[230:231], v170 offset:20992
  v_mfma_f32_16x16x32_bf16 v[132:135], v[244:247], a[84:87], v[132:135]
  s_add_u32 s39, s39, 4096
  ds_read_b64_tr_b16 v[232:233], v171 offset:12288
  ds_read_b64_tr_b16 v[234:235], v171 offset:12800
  v_mfma_f32_16x16x32_bf16 v[132:135], v[248:251], a[88:91], v[132:135]
  s_add_u32 m0, s22, 98304
  ds_read_b64_tr_b16 v[236:237], v171 offset:16384
  v_mfma_f32_16x16x32_bf16 v[132:135], v[252:255], a[92:95], v[132:135]
  buffer_load_dwordx4 v180, s[8:11], s23 offen lds
  v_mfma_f32_16x16x32_bf16 v[128:131], v[252:255], a[20:23], v[128:131]
  s_add_u32 s23, s23, 294912
  ds_read_b64_tr_b16 v[238:239], v171 offset:16896
  v_mfma_f32_16x16x32_bf16 v[128:131], v[248:251], a[16:19], v[128:131]
  buffer_load_dwordx4 a[64:67], v184, s[48:51], s38 offen offset:0 sc1
  v_mfma_f32_16x16x32_bf16 v[128:131], v[244:247], a[12:15], v[128:131]
  s_waitcnt lgkmcnt(4)
  ds_read_b64_tr_b16 v[240:241], v171 offset:20480
  ds_read_b64_tr_b16 v[242:243], v171 offset:20992
  v_mfma_f32_16x16x32_bf16 v[136:139], v[220:223], a[12:15], v[136:139]
  s_nop 0
  ds_read_b64_tr_b16 v[244:245], v168 offset:24576
  ds_read_b64_tr_b16 v[246:247], v168 offset:25088
  v_mfma_f32_16x16x32_bf16 v[136:139], v[224:227], a[16:19], v[136:139]
  s_add_u32 m0, s22, 102400
  ds_read_b64_tr_b16 v[248:249], v168 offset:28672
  v_mfma_f32_16x16x32_bf16 v[136:139], v[228:231], a[20:23], v[136:139]
  buffer_load_dwordx4 v180, s[8:11], s23 offen lds
  v_mfma_f32_16x16x32_bf16 v[140:143], v[228:231], a[92:95], v[140:143]
  s_add_u32 s23, s23, 294912
  ds_read_b64_tr_b16 v[250:251], v168 offset:29184
  v_mfma_f32_16x16x32_bf16 v[140:143], v[224:227], a[88:91], v[140:143]
  buffer_load_dwordx4 a[136:139], v184, s[48:51], s39 offen offset:0 sc1
  v_mfma_f32_16x16x32_bf16 v[140:143], v[220:223], a[84:87], v[140:143]
  s_waitcnt lgkmcnt(4)
  ds_read_b64_tr_b16 v[252:253], v168 offset:32768
  ds_read_b64_tr_b16 v[254:255], v168 offset:33280
  v_mfma_f32_16x16x32_bf16 v[148:151], v[232:235], a[84:87], v[148:151]
  s_nop 0
  ds_read_b64_tr_b16 v[220:221], v169 offset:24576
  ds_read_b64_tr_b16 v[222:223], v169 offset:25088
  v_mfma_f32_16x16x32_bf16 v[148:151], v[236:239], a[88:91], v[148:151]
  s_add_u32 m0, s22, 106496
  ds_read_b64_tr_b16 v[224:225], v169 offset:28672
  v_add_u32 v168, 73728, v172
  v_mfma_f32_16x16x32_bf16 v[148:151], v[240:243], a[92:95], v[148:151]
  buffer_load_dwordx4 v180, s[8:11], s23 offen lds
  v_mfma_f32_16x16x32_bf16 v[144:147], v[240:243], a[20:23], v[144:147]
  ds_read_b64_tr_b16 v[226:227], v169 offset:29184
  v_mfma_f32_16x16x32_bf16 v[144:147], v[236:239], a[16:19], v[144:147]
  buffer_load_dwordx4 a[68:71], v184, s[48:51], s38 offen offset:1024 sc1
  v_mfma_f32_16x16x32_bf16 v[144:147], v[232:235], a[12:15], v[144:147]
  s_waitcnt lgkmcnt(4)
  ds_read_b64_tr_b16 v[228:229], v169 offset:32768
  ds_read_b64_tr_b16 v[230:231], v169 offset:33280
  v_mfma_f32_16x16x32_bf16 v[120:123], v[244:247], a[24:27], v[120:123]
  s_nop 0
  ds_read_b64_tr_b16 v[232:233], v170 offset:24576
  ds_read_b64_tr_b16 v[234:235], v170 offset:25088
  v_mfma_f32_16x16x32_bf16 v[120:123], v[248:251], a[28:31], v[120:123]
  s_waitcnt vmcnt(19)
  ds_read_b64_tr_b16 v[236:237], v170 offset:28672
  v_add_u32 v169, 73728, v173
  v_mfma_f32_16x16x32_bf16 v[120:123], v[252:255], a[32:35], v[120:123]
  s_barrier
  v_mfma_f32_16x16x32_bf16 v[124:127], v[252:255], a[104:107], v[124:127]
  ds_read_b64_tr_b16 v[238:239], v170 offset:29184
  v_mfma_f32_16x16x32_bf16 v[124:127], v[248:251], a[100:103], v[124:127]
  buffer_load_dwordx4 a[140:143], v184, s[48:51], s39 offen offset:1024 sc1
  v_mfma_f32_16x16x32_bf16 v[124:127], v[244:247], a[96:99], v[124:127]
  s_waitcnt lgkmcnt(4)
  ds_read_b64_tr_b16 v[240:241], v170 offset:32768
  ds_read_b64_tr_b16 v[242:243], v170 offset:33280
  v_mfma_f32_16x16x32_bf16 v[132:135], v[220:223], a[96:99], v[132:135]
  s_add_u32 s23, s24, 2654208
  ds_read_b64_tr_b16 v[244:245], v171 offset:24576
  v_add_u32 v170, 73728, v174
  v_mfma_f32_16x16x32_bf16 v[132:135], v[224:227], a[100:103], v[132:135]
  s_add_u32 m0, s22, 110592
  ds_read_b64_tr_b16 v[246:247], v171 offset:25088
  v_mfma_f32_16x16x32_bf16 v[132:135], v[228:231], a[104:107], v[132:135]
  buffer_load_dwordx4 v180, s[12:15], s23 offen lds
  v_mfma_f32_16x16x32_bf16 v[128:131], v[228:231], a[32:35], v[128:131]
  s_add_u32 s23, s23, 294912
  ds_read_b64_tr_b16 v[248:249], v171 offset:28672
  v_mfma_f32_16x16x32_bf16 v[128:131], v[224:227], a[28:31], v[128:131]
  ds_read_b64_tr_b16 v[250:251], v171 offset:29184
  v_mfma_f32_16x16x32_bf16 v[128:131], v[220:223], a[24:27], v[128:131]
  s_waitcnt lgkmcnt(4)
  ds_read_b64_tr_b16 v[252:253], v171 offset:32768
  ds_read_b64_tr_b16 v[254:255], v171 offset:33280
  v_mfma_f32_16x16x32_bf16 v[136:139], v[232:235], a[24:27], v[136:139]
  ds_read_b64_tr_b16 v[220:221], v168 offset:0
  v_add_u32 v171, 73728, v175
  v_mfma_f32_16x16x32_bf16 v[136:139], v[236:239], a[28:31], v[136:139]
  s_add_u32 m0, s22, 114688
  ds_read_b64_tr_b16 v[222:223], v168 offset:512
  v_mfma_f32_16x16x32_bf16 v[136:139], v[240:243], a[32:35], v[136:139]
  buffer_load_dwordx4 v180, s[12:15], s23 offen lds
  v_mfma_f32_16x16x32_bf16 v[140:143], v[240:243], a[104:107], v[140:143]
  s_add_u32 s23, s23, 294912
  ds_read_b64_tr_b16 v[224:225], v168 offset:4096
  v_mfma_f32_16x16x32_bf16 v[140:143], v[236:239], a[100:103], v[140:143]
  ds_read_b64_tr_b16 v[226:227], v168 offset:4608
  v_mfma_f32_16x16x32_bf16 v[140:143], v[232:235], a[96:99], v[140:143]
  s_waitcnt lgkmcnt(4)
  ds_read_b64_tr_b16 v[228:229], v168 offset:8192
  ds_read_b64_tr_b16 v[230:231], v168 offset:8704
  v_mfma_f32_16x16x32_bf16 v[148:151], v[244:247], a[96:99], v[148:151]
  ds_read_b64_tr_b16 v[232:233], v169 offset:0
  v_mfma_f32_16x16x32_bf16 v[148:151], v[248:251], a[100:103], v[148:151]
  s_add_u32 m0, s22, 118784
  ds_read_b64_tr_b16 v[234:235], v169 offset:512
  v_mfma_f32_16x16x32_bf16 v[148:151], v[252:255], a[104:107], v[148:151]
  buffer_load_dwordx4 v180, s[12:15], s23 offen lds
  v_mfma_f32_16x16x32_bf16 v[144:147], v[252:255], a[32:35], v[144:147]
  s_add_u32 s23, s23, 294912
  s_waitcnt vmcnt(21)
  ds_read_b64_tr_b16 v[236:237], v169 offset:4096
  v_mfma_f32_16x16x32_bf16 v[144:147], v[248:251], a[28:31], v[144:147]
  ds_read_b64_tr_b16 v[238:239], v169 offset:4608
  v_mfma_f32_16x16x32_bf16 v[144:147], v[244:247], a[24:27], v[144:147]
  s_waitcnt lgkmcnt(4)
  ds_read_b64_tr_b16 v[240:241], v169 offset:8192
  ds_read_b64_tr_b16 v[242:243], v169 offset:8704
  v_mfma_f32_16x16x32_bf16 v[88:91], v[220:223], a[36:39], v[88:91]
  ds_read_b64_tr_b16 v[244:245], v170 offset:0
  v_mfma_f32_16x16x32_bf16 v[88:91], v[224:227], a[40:43], v[88:91]
  s_waitcnt vmcnt(0)
  ds_read_b64_tr_b16 v[246:247], v170 offset:512
  v_mfma_f32_16x16x32_bf16 v[88:91], v[228:231], a[44:47], v[88:91]
  s_barrier
  v_mfma_f32_16x16x32_bf16 v[92:95], v[228:231], a[116:119], v[92:95]
  ds_read_b64_tr_b16 v[248:249], v170 offset:4096
  v_mfma_f32_16x16x32_bf16 v[92:95], v[224:227], a[112:115], v[92:95]
  ds_read_b64_tr_b16 v[250:251], v170 offset:4608
  v_mfma_f32_16x16x32_bf16 v[92:95], v[220:223], a[108:111], v[92:95]
  s_waitcnt lgkmcnt(4)
  ds_read_b64_tr_b16 v[252:253], v170 offset:8192
  ds_read_b64_tr_b16 v[254:255], v170 offset:8704
  v_mfma_f32_16x16x32_bf16 v[100:103], v[232:235], a[108:111], v[100:103]
  s_nop 0
  ds_read_b64_tr_b16 v[220:221], v171 offset:0
  ds_read_b64_tr_b16 v[222:223], v171 offset:512
  v_mfma_f32_16x16x32_bf16 v[100:103], v[236:239], a[112:115], v[100:103]
  s_add_u32 m0, s22, 122880
  ds_read_b64_tr_b16 v[224:225], v171 offset:4096
  v_mfma_f32_16x16x32_bf16 v[100:103], v[240:243], a[116:119], v[100:103]
  buffer_load_dwordx4 v180, s[12:15], s23 offen lds
  v_mfma_f32_16x16x32_bf16 v[96:99], v[240:243], a[44:47], v[96:99]
  s_add_u32 s23, s23, 294912
  s_add_u32 m0, s22, 126976
  ds_read_b64_tr_b16 v[226:227], v171 offset:4608
  v_mfma_f32_16x16x32_bf16 v[96:99], v[236:239], a[40:43], v[96:99]
  buffer_load_dwordx4 v180, s[12:15], s23 offen lds
  v_mfma_f32_16x16x32_bf16 v[96:99], v[232:235], a[36:39], v[96:99]
  s_waitcnt lgkmcnt(4)
  ds_read_b64_tr_b16 v[228:229], v171 offset:8192
  ds_read_b64_tr_b16 v[230:231], v171 offset:8704
  v_mfma_f32_16x16x32_bf16 v[104:107], v[244:247], a[36:39], v[104:107]
  s_add_u32 s23, s23, 294912
  ds_read_b64_tr_b16 v[232:233], v168 offset:12288
  v_mfma_f32_16x16x32_bf16 v[104:107], v[248:251], a[40:43], v[104:107]
  s_add_u32 m0, s22, 131072
  ds_read_b64_tr_b16 v[234:235], v168 offset:12800
  v_mfma_f32_16x16x32_bf16 v[104:107], v[252:255], a[44:47], v[104:107]
  buffer_load_dwordx4 v180, s[12:15], s23 offen lds
  v_mfma_f32_16x16x32_bf16 v[108:111], v[252:255], a[116:119], v[108:111]
  s_add_u32 s23, s23, 294912
  ds_read_b64_tr_b16 v[236:237], v168 offset:16384
  v_mfma_f32_16x16x32_bf16 v[108:111], v[248:251], a[112:115], v[108:111]
  ds_read_b64_tr_b16 v[238:239], v168 offset:16896
  v_mfma_f32_16x16x32_bf16 v[108:111], v[244:247], a[108:111], v[108:111]
  s_waitcnt lgkmcnt(4)
  ds_read_b64_tr_b16 v[240:241], v168 offset:20480
  ds_read_b64_tr_b16 v[242:243], v168 offset:20992
  v_mfma_f32_16x16x32_bf16 v[116:119], v[220:223], a[108:111], v[116:119]
  ds_read_b64_tr_b16 v[244:245], v169 offset:12288
  v_mfma_f32_16x16x32_bf16 v[116:119], v[224:227], a[112:115], v[116:119]
  s_add_u32 m0, s22, 135168
  ds_read_b64_tr_b16 v[246:247], v169 offset:12800
  v_mfma_f32_16x16x32_bf16 v[116:119], v[228:231], a[116:119], v[116:119]
  buffer_load_dwordx4 v180, s[12:15], s23 offen lds
  v_mfma_f32_16x16x32_bf16 v[112:115], v[228:231], a[44:47], v[112:115]
  s_add_u32 s23, s23, 294912
  s_waitcnt vmcnt(16)
  ds_read_b64_tr_b16 v[248:249], v169 offset:16384
  v_mfma_f32_16x16x32_bf16 v[112:115], v[224:227], a[40:43], v[112:115]
  ds_read_b64_tr_b16 v[250:251], v169 offset:16896
  v_mfma_f32_16x16x32_bf16 v[112:115], v[220:223], a[36:39], v[112:115]
  s_waitcnt lgkmcnt(4)
  ds_read_b64_tr_b16 v[252:253], v169 offset:20480
  ds_read_b64_tr_b16 v[254:255], v169 offset:20992
  v_mfma_f32_16x16x32_bf16 v[88:91], v[232:235], a[48:51], v[88:91]
  ds_read_b64_tr_b16 v[220:221], v170 offset:12288
  v_mfma_f32_16x16x32_bf16 v[88:91], v[236:239], a[52:55], v[88:91]
  s_add_u32 m0, s22, 139264
  ds_read_b64_tr_b16 v[222:223], v170 offset:12800
  v_mfma_f32_16x16x32_bf16 v[88:91], v[240:243], a[56:59], v[88:91]
  buffer_load_dwordx4 v180, s[12:15], s23 offen lds
  v_mfma_f32_16x16x32_bf16 v[92:95], v[240:243], a[128:131], v[92:95]
  s_add_u32 s23, s23, 294912
  ds_read_b64_tr_b16 v[224:225], v170 offset:16384
  v_mfma_f32_16x16x32_bf16 v[92:95], v[236:239], a[124:127], v[92:95]
  ds_read_b64_tr_b16 v[226:227], v170 offset:16896
  v_mfma_f32_16x16x32_bf16 v[92:95], v[232:235], a[120:123], v[92:95]
  s_waitcnt lgkmcnt(4)
  ds_read_b64_tr_b16 v[228:229], v170 offset:20480
  ds_read_b64_tr_b16 v[230:231], v170 offset:20992
  v_mfma_f32_16x16x32_bf16 v[100:103], v[244:247], a[120:123], v[100:103]
  ds_read_b64_tr_b16 v[232:233], v171 offset:12288
  v_mfma_f32_16x16x32_bf16 v[100:103], v[248:251], a[124:127], v[100:103]
  s_add_u32 m0, s22, 143360
  ds_read_b64_tr_b16 v[234:235], v171 offset:12800
  v_mfma_f32_16x16x32_bf16 v[100:103], v[252:255], a[128:131], v[100:103]
  buffer_load_dwordx4 v180, s[12:15], s23 offen lds
  v_mfma_f32_16x16x32_bf16 v[96:99], v[252:255], a[56:59], v[96:99]
  ds_read_b64_tr_b16 v[236:237], v171 offset:16384
  v_mfma_f32_16x16x32_bf16 v[96:99], v[248:251], a[52:55], v[96:99]
  ds_read_b64_tr_b16 v[238:239], v171 offset:16896
  v_mfma_f32_16x16x32_bf16 v[96:99], v[244:247], a[48:51], v[96:99]
  s_waitcnt lgkmcnt(4)
  ds_read_b64_tr_b16 v[240:241], v171 offset:20480
  ds_read_b64_tr_b16 v[242:243], v171 offset:20992
  v_mfma_f32_16x16x32_bf16 v[104:107], v[220:223], a[48:51], v[104:107]
  s_add_u32 s23, s24, 128
  ds_read_b64_tr_b16 v[244:245], v168 offset:24576
  v_mfma_f32_16x16x32_bf16 v[104:107], v[224:227], a[52:55], v[104:107]
KB_I1:
  s_cbranch_execz KB_I4
  s_add_u32 m0, s22, 0
  ds_read_b64_tr_b16 v[246:247], v168 offset:25088
  v_mfma_f32_16x16x32_bf16 v[104:107], v[228:231], a[56:59], v[104:107]
  buffer_load_dwordx4 v180, s[8:11], s23 offen lds
  v_mfma_f32_16x16x32_bf16 v[108:111], v[228:231], a[128:131], v[108:111]
  s_add_u32 s23, s23, 294912
  ds_read_b64_tr_b16 v[248:249], v168 offset:28672
  v_mfma_f32_16x16x32_bf16 v[108:111], v[224:227], a[124:127], v[108:111]
  ds_read_b64_tr_b16 v[250:251], v168 offset:29184
  v_mfma_f32_16x16x32_bf16 v[108:111], v[220:223], a[120:123], v[108:111]
  s_waitcnt lgkmcnt(4)
  ds_read_b64_tr_b16 v[252:253], v168 offset:32768
  ds_read_b64_tr_b16 v[254:255], v168 offset:33280
  v_mfma_f32_16x16x32_bf16 v[116:119], v[232:235], a[120:123], v[116:119]
  ds_read_b64_tr_b16 v[220:221], v169 offset:24576
  v_add_u32 v168, 110592, v172
  v_mfma_f32_16x16x32_bf16 v[116:119], v[236:239], a[124:127], v[116:119]
  s_add_u32 m0, s22, 4096
  ds_read_b64_tr_b16 v[222:223], v169 offset:25088
  v_mfma_f32_16x16x32_bf16 v[116:119], v[240:243], a[128:131], v[116:119]
  buffer_load_dwordx4 v180, s[8:11], s23 offen lds
  v_mfma_f32_16x16x32_bf16 v[112:115], v[240:243], a[56:59], v[112:115]
  s_add_u32 s23, s23, 294912
  s_waitcnt vmcnt(11)
  ds_read_b64_tr_b16 v[224:225], v169 offset:28672
  v_mfma_f32_16x16x32_bf16 v[112:115], v[236:239], a[52:55], v[112:115]
  ds_read_b64_tr_b16 v[226:227], v169 offset:29184
  v_mfma_f32_16x16x32_bf16 v[112:115], v[232:235], a[48:51], v[112:115]
  s_waitcnt lgkmcnt(4)
  ds_read_b64_tr_b16 v[228:229], v169 offset:32768
  ds_read_b64_tr_b16 v[230:231], v169 offset:33280
  v_mfma_f32_16x16x32_bf16 v[88:91], v[244:247], a[60:63], v[88:91]
  ds_read_b64_tr_b16 v[232:233], v170 offset:24576
  v_add_u32 v169, 110592, v173
  v_mfma_f32_16x16x32_bf16 v[88:91], v[248:251], a[64:67], v[88:91]
  s_add_u32 m0, s22, 8192
  ds_read_b64_tr_b16 v[234:235], v170 offset:25088
  v_mfma_f32_16x16x32_bf16 v[88:91], v[252:255], a[68:71], v[88:91]
  buffer_load_dwordx4 v180, s[8:11], s23 offen lds
  v_mfma_f32_16x16x32_bf16 v[92:95], v[252:255], a[140:143], v[92:95]
  s_add_u32 s23, s23, 294912
  ds_read_b64_tr_b16 v[236:237], v170 offset:28672
  v_mfma_f32_16x16x32_bf16 v[92:95], v[248:251], a[136:139], v[92:95]
  ds_read_b64_tr_b16 v[238:239], v170 offset:29184
  v_mfma_f32_16x16x32_bf16 v[92:95], v[244:247], a[132:135], v[92:95]
  s_waitcnt lgkmcnt(4)
  ds_read_b64_tr_b16 v[240:241], v170 offset:32768
  ds_read_b64_tr_b16 v[242:243], v170 offset:33280
  v_mfma_f32_16x16x32_bf16 v[100:103], v[220:223], a[132:135], v[100:103]
  ds_read_b64_tr_b16 v[244:245], v171 offset:24576
  v_add_u32 v170, 110592, v174
  v_mfma_f32_16x16x32_bf16 v[100:103], v[224:227], a[136:139], v[100:103]
  s_add_u32 m0, s22, 12288
  ds_read_b64_tr_b16 v[246:247], v171 offset:25088
  v_mfma_f32_16x16x32_bf16 v[100:103], v[228:231], a[140:143], v[100:103]
  buffer_load_dwordx4 v180, s[8:11], s23 offen lds
  v_mfma_f32_16x16x32_bf16 v[96:99], v[228:231], a[68:71], v[96:99]
  s_add_u32 s23, s23, 294912
  ds_read_b64_tr_b16 v[248:249], v171 offset:28672
  v_max_f32 v188, 0, v88
  v_mfma_f32_16x16x32_bf16 v[96:99], v[224:227], a[64:67], v[96:99]
  ds_read_b64_tr_b16 v[250:251], v171 offset:29184
  v_max_f32 v189, 0, v89
  v_mfma_f32_16x16x32_bf16 v[96:99], v[220:223], a[60:63], v[96:99]
  s_waitcnt lgkmcnt(4)
  ds_read_b64_tr_b16 v[252:253], v171 offset:32768
  ds_read_b64_tr_b16 v[254:255], v171 offset:33280
  v_mfma_f32_16x16x32_bf16 v[104:107], v[232:235], a[60:63], v[104:107]
  ds_read_b64_tr_b16 v[220:221], v168 offset:0
  v_add_u32 v171, 110592, v175
  v_mfma_f32_16x16x32_bf16 v[104:107], v[236:239], a[64:67], v[104:107]
  s_add_u32 m0, s22, 16384
  ds_read_b64_tr_b16 v[222:223], v168 offset:512
  v_max_f32 v190, 0, v90
  v_mfma_f32_16x16x32_bf16 v[104:107], v[240:243], a[68:71], v[104:107]
  buffer_load_dwordx4 v180, s[8:11], s23 offen lds
  v_mfma_f32_16x16x32_bf16 v[108:111], v[240:243], a[140:143], v[108:111]
  s_add_u32 s23, s23, 294912
  ds_read_b64_tr_b16 v[224:225], v168 offset:4096
  v_max_f32 v191, 0, v91
  v_mfma_f32_16x16x32_bf16 v[108:111], v[236:239], a[136:139], v[108:111]
  ds_read_b64_tr_b16 v[226:227], v168 offset:4608
  v_max_f32 v192, 0, v92
  v_mfma_f32_16x16x32_bf16 v[108:111], v[232:235], a[132:135], v[108:111]
  s_waitcnt lgkmcnt(4)
  ds_read_b64_tr_b16 v[228:229], v168 offset:8192
  ds_read_b64_tr_b16 v[230:231], v168 offset:8704
  v_mfma_f32_16x16x32_bf16 v[116:119], v[244:247], a[132:135], v[116:119]
  ds_read_b64_tr_b16 v[232:233], v169 offset:0
  v_max_f32 v193, 0, v93
  v_mfma_f32_16x16x32_bf16 v[116:119], v[248:251], a[136:139], v[116:119]
  s_add_u32 m0, s22, 20480
  ds_read_b64_tr_b16 v[234:235], v169 offset:512
  v_max_f32 v194, 0, v94
  v_mfma_f32_16x16x32_bf16 v[116:119], v[252:255], a[140:143], v[116:119]
  buffer_load_dwordx4 v180, s[8:11], s23 offen lds
  v_mfma_f32_16x16x32_bf16 v[112:115], v[252:255], a[68:71], v[112:115]
  s_add_u32 s23, s23, 294912
  ds_read_b64_tr_b16 v[236:237], v169 offset:4096
  v_max_f32 v195, 0, v95
  v_mfma_f32_16x16x32_bf16 v[112:115], v[248:251], a[64:67], v[112:115]
  ds_read_b64_tr_b16 v[238:239], v169 offset:4608
  v_max_f32 v196, 0, v96
  v_mfma_f32_16x16x32_bf16 v[112:115], v[244:247], a[60:63], v[112:115]
  s_waitcnt lgkmcnt(4)
  ds_read_b64_tr_b16 v[240:241], v169 offset:8192
  ds_read_b64_tr_b16 v[242:243], v169 offset:8704
  v_mfma_f32_16x16x32_bf16 v[120:123], v[220:223], a[36:39], v[120:123]
  ds_read_b64_tr_b16 v[244:245], v170 offset:0
  v_max_f32 v197, 0, v97
  v_mfma_f32_16x16x32_bf16 v[120:123], v[224:227], a[40:43], v[120:123]
  s_waitcnt vmcnt(3)
  ds_read_b64_tr_b16 v[246:247], v170 offset:512
  v_max_f32 v198, 0, v98
  v_mfma_f32_16x16x32_bf16 v[120:123], v[228:231], a[44:47], v[120:123]
  s_barrier
  v_mfma_f32_16x16x32_bf16 v[124:127], v[228:231], a[116:119], v[124:127]
  ds_read_b64_tr_b16 v[248:249], v170 offset:4096
  v_max_f32 v199, 0, v99
  v_mfma_f32_16x16x32_bf16 v[124:127], v[224:227], a[112:115], v[124:127]
  ds_read_b64_tr_b16 v[250:251], v170 offset:4608
  v_max_f32 v200, 0, v100
  v_mfma_f32_16x16x32_bf16 v[124:127], v[220:223], a[108:111], v[124:127]
  s_waitcnt lgkmcnt(4)
  ds_read_b64_tr_b16 v[252:253], v170 offset:8192
  ds_read_b64_tr_b16 v[254:255], v170 offset:8704
  v_mfma_f32_16x16x32_bf16 v[132:135], v[232:235], a[108:111], v[132:135]
  s_nop 0
  ds_read_b64_tr_b16 v[220:221], v171 offset:0
  ds_read_b64_tr_b16 v[222:223], v171 offset:512
  v_mfma_f32_16x16x32_bf16 v[132:135], v[236:239], a[112:115], v[132:135]
  s_add_u32 m0, s22, 24576
  ds_read_b64_tr_b16 v[224:225], v171 offset:4096
  v_max_f32 v201, 0, v101
  v_mfma_f32_16x16x32_bf16 v[132:135], v[240:243], a[116:119], v[132:135]
  buffer_load_dwordx4 v180, s[8:11], s23 offen lds
  v_mfma_f32_16x16x32_bf16 v[128:131], v[240:243], a[44:47], v[128:131]
  s_add_u32 s23, s23, 294912
  s_add_u32 m0, s22, 28672
  ds_read_b64_tr_b16 v[226:227], v171 offset:4608
  v_mfma_f32_16x16x32_bf16 v[128:131], v[236:239], a[40:43], v[128:131]
  buffer_load_dwordx4 v180, s[8:11], s23 offen lds
  v_mfma_f32_16x16x32_bf16 v[128:131], v[232:235], a[36:39], v[128:131]
  s_waitcnt lgkmcnt(4)
  ds_read_b64_tr_b16 v[228:229], v171 offset:8192
  ds_read_b64_tr_b16 v[230:231], v171 offset:8704
  v_mfma_f32_16x16x32_bf16 v[136:139], v[244:247], a[36:39], v[136:139]
  s_add_u32 s23, s23, 294912
  ds_read_b64_tr_b16 v[232:233], v168 offset:12288
  v_max_f32 v202, 0, v102
  v_mfma_f32_16x16x32_bf16 v[136:139], v[248:251], a[40:43], v[136:139]
  s_add_u32 m0, s22, 32768
  ds_read_b64_tr_b16 v[234:235], v168 offset:12800
  v_max_f32 v203, 0, v103
  v_mfma_f32_16x16x32_bf16 v[136:139], v[252:255], a[44:47], v[136:139]
  buffer_load_dwordx4 v180, s[8:11], s23 offen lds
  v_mfma_f32_16x16x32_bf16 v[140:143], v[252:255], a[116:119], v[140:143]
  s_add_u32 s23, s23, 294912
  ds_read_b64_tr_b16 v[236:237], v168 offset:16384
  v_max_f32 v204, 0, v104
  v_mfma_f32_16x16x32_bf16 v[140:143], v[248:251], a[112:115], v[140:143]
  ds_read_b64_tr_b16 v[238:239], v168 offset:16896
  v_max_f32 v205, 0, v105
  v_mfma_f32_16x16x32_bf16 v[140:143], v[244:247], a[108:111], v[140:143]
  s_waitcnt lgkmcnt(4)
  ds_read_b64_tr_b16 v[240:241], v168 offset:20480
  ds_read_b64_tr_b16 v[242:243], v168 offset:20992
  v_mfma_f32_16x16x32_bf16 v[148:151], v[220:223], a[108:111], v[148:151]
  ds_read_b64_tr_b16 v[244:245], v169 offset:12288
  v_max_f32 v206, 0, v106
  v_mfma_f32_16x16x32_bf16 v[148:151], v[224:227], a[112:115], v[148:151]
  s_add_u32 m0, s22, 36864
  ds_read_b64_tr_b16 v[246:247], v169 offset:12800
  v_max_f32 v207, 0, v107
  v_mfma_f32_16x16x32_bf16 v[148:151], v[228:231], a[116:119], v[148:151]
  buffer_load_dwordx4 v180, s[8:11], s23 offen lds
  v_mfma_f32_16x16x32_bf16 v[144:147], v[228:231], a[44:47], v[144:147]
  s_add_u32 s23, s23, 294912
  ds_read_b64_tr_b16 v[248:249], v169 offset:16384
  v_max_f32 v208, 0, v108
  v_mfma_f32_16x16x32_bf16 v[144:147], v[224:227], a[40:43], v[144:147]
  ds_read_b64_tr_b16 v[250:251], v169 offset:16896
  v_max_f32 v209, 0, v109
  v_mfma_f32_16x16x32_bf16 v[144:147], v[220:223], a[36:39], v[144:147]
  s_waitcnt lgkmcnt(4)
  ds_read_b64_tr_b16 v[252:253], v169 offset:20480
  ds_read_b64_tr_b16 v[254:255], v169 offset:20992
  v_mfma_f32_16x16x32_bf16 v[120:123], v[232:235], a[48:51], v[120:123]
  ds_read_b64_tr_b16 v[220:221], v170 offset:12288
  v_max_f32 v210, 0, v110
  v_mfma_f32_16x16x32_bf16 v[120:123], v[236:239], a[52:55], v[120:123]
  s_add_u32 m0, s22, 40960
  ds_read_b64_tr_b16 v[222:223], v170 offset:12800
  v_max_f32 v211, 0, v111
  v_mfma_f32_16x16x32_bf16 v[120:123], v[240:243], a[56:59], v[120:123]
  buffer_load_dwordx4 v180, s[8:11], s23 offen lds
  v_mfma_f32_16x16x32_bf16 v[124:127], v[240:243], a[128:131], v[124:127]
  s_add_u32 s23, s23, 294912
  ds_read_b64_tr_b16 v[224:225], v170 offset:16384
  v_max_f32 v212, 0, v112
  v_mfma_f32_16x16x32_bf16 v[124:127], v[236:239], a[124:127], v[124:127]
  ds_read_b64_tr_b16 v[226:227], v170 offset:16896
  v_max_f32 v213, 0, v113
  v_mfma_f32_16x16x32_bf16 v[124:127], v[232:235], a[120:123], v[124:127]
  s_waitcnt lgkmcnt(4)
  ds_read_b64_tr_b16 v[228:229], v170 offset:20480
  ds_read_b64_tr_b16 v[230:231], v170 offset:20992
  v_mfma_f32_16x16x32_bf16 v[132:135], v[244:247], a[120:123], v[132:135]
  ds_read_b64_tr_b16 v[232:233], v171 offset:12288
  v_max_f32 v214, 0, v114
  v_mfma_f32_16x16x32_bf16 v[132:135], v[248:251], a[124:127], v[132:135]
  s_add_u32 m0, s22, 45056
  ds_read_b64_tr_b16 v[234:235], v171 offset:12800
  v_max_f32 v215, 0, v115
  v_mfma_f32_16x16x32_bf16 v[132:135], v[252:255], a[128:131], v[132:135]
  buffer_load_dwordx4 v180, s[8:11], s23 offen lds
  v_mfma_f32_16x16x32_bf16 v[128:131], v[252:255], a[56:59], v[128:131]
  s_add_u32 s23, s23, 294912
  ds_read_b64_tr_b16 v[236:237], v171 offset:16384
  v_max_f32 v216, 0, v116
  v_mfma_f32_16x16x32_bf16 v[128:131], v[248:251], a[52:55], v[128:131]
  ds_read_b64_tr_b16 v[238:239], v171 offset:16896
  v_max_f32 v217, 0, v117
  v_mfma_f32_16x16x32_bf16 v[128:131], v[244:247], a[48:51], v[128:131]
  s_waitcnt lgkmcnt(4)
  ds_read_b64_tr_b16 v[240:241], v171 offset:20480
  ds_read_b64_tr_b16 v[242:243], v171 offset:20992
  v_mfma_f32_16x16x32_bf16 v[136:139], v[220:223], a[48:51], v[136:139]
  ds_read_b64_tr_b16 v[244:245], v168 offset:24576
  v_max_f32 v218, 0, v118
  v_mfma_f32_16x16x32_bf16 v[136:139], v[224:227], a[52:55], v[136:139]
  s_add_u32 m0, s22, 49152
  ds_read_b64_tr_b16 v[246:247], v168 offset:25088
  v_max_f32 v219, 0, v119
  v_mfma_f32_16x16x32_bf16 v[136:139], v[228:231], a[56:59], v[136:139]
  buffer_load_dwordx4 v180, s[8:11], s23 offen lds
  v_mfma_f32_16x16x32_bf16 v[140:143], v[228:231], a[128:131], v[140:143]
  s_add_u32 s23, s23, 294912
  ds_read_b64_tr_b16 v[248:249], v168 offset:28672
  v_mfma_f32_16x16x32_bf16 v[140:143], v[224:227], a[124:127], v[140:143]
  ds_read_b64_tr_b16 v[250:251], v168 offset:29184
  v_mfma_f32_16x16x32_bf16 v[140:143], v[220:223], a[120:123], v[140:143]
  s_waitcnt lgkmcnt(4)
  ds_read_b64_tr_b16 v[252:253], v168 offset:32768
  ds_read_b64_tr_b16 v[254:255], v168 offset:33280
  v_mfma_f32_16x16x32_bf16 v[148:151], v[232:235], a[120:123], v[148:151]
  ds_read_b64_tr_b16 v[220:221], v169 offset:24576
  v_add_u32 v168, 0, v172
  v_mfma_f32_16x16x32_bf16 v[148:151], v[236:239], a[124:127], v[148:151]
  s_add_u32 m0, s22, 53248
  ds_read_b64_tr_b16 v[222:223], v169 offset:25088
  v_mfma_f32_16x16x32_bf16 v[148:151], v[240:243], a[128:131], v[148:151]
  buffer_load_dwordx4 v180, s[8:11], s23 offen lds
  v_mfma_f32_16x16x32_bf16 v[144:147], v[240:243], a[56:59], v[144:147]
  s_add_u32 s23, s23, 294912
  ds_read_b64_tr_b16 v[224:225], v169 offset:28672
  v_mfma_f32_16x16x32_bf16 v[144:147], v[236:239], a[52:55], v[144:147]
  ds_read_b64_tr_b16 v[226:227], v169 offset:29184
  v_mfma_f32_16x16x32_bf16 v[144:147], v[232:235], a[48:51], v[144:147]
  s_waitcnt lgkmcnt(4)
  ds_read_b64_tr_b16 v[228:229], v169 offset:32768
  ds_read_b64_tr_b16 v[230:231], v169 offset:33280
  v_mfma_f32_16x16x32_bf16 v[120:123], v[244:247], a[60:63], v[120:123]
  ds_read_b64_tr_b16 v[232:233], v170 offset:24576
  v_add_u32 v169, 0, v173
  v_mfma_f32_16x16x32_bf16 v[120:123], v[248:251], a[64:67], v[120:123]
  s_add_u32 m0, s22, 57344
  ds_read_b64_tr_b16 v[234:235], v170 offset:25088
  v_mfma_f32_16x16x32_bf16 v[120:123], v[252:255], a[68:71], v[120:123]
  buffer_load_dwordx4 v180, s[8:11], s23 offen lds
  v_mfma_f32_16x16x32_bf16 v[124:127], v[252:255], a[140:143], v[124:127]
  s_add_u32 s23, s23, 294912
  ds_read_b64_tr_b16 v[236:237], v170 offset:28672
  v_mfma_f32_16x16x32_bf16 v[124:127], v[248:251], a[136:139], v[124:127]
  ds_read_b64_tr_b16 v[238:239], v170 offset:29184
  v_mfma_f32_16x16x32_bf16 v[124:127], v[244:247], a[132:135], v[124:127]
  s_waitcnt lgkmcnt(4)
  ds_read_b64_tr_b16 v[240:241], v170 offset:32768
  ds_read_b64_tr_b16 v[242:243], v170 offset:33280
  v_mfma_f32_16x16x32_bf16 v[132:135], v[220:223], a[132:135], v[132:135]
  ds_read_b64_tr_b16 v[244:245], v171 offset:24576
  v_add_u32 v170, 0, v174
  v_mfma_f32_16x16x32_bf16 v[132:135], v[224:227], a[136:139], v[132:135]
  s_add_u32 m0, s22, 61440
  ds_read_b64_tr_b16 v[246:247], v171 offset:25088
  v_mfma_f32_16x16x32_bf16 v[132:135], v[228:231], a[140:143], v[132:135]
  buffer_load_dwordx4 v180, s[8:11], s23 offen lds
  v_mfma_f32_16x16x32_bf16 v[128:131], v[228:231], a[68:71], v[128:131]
  s_add_u32 s23, s23, 294912
  ds_read_b64_tr_b16 v[248:249], v171 offset:28672
  v_mul_f32 v120, v188, v120
  v_mfma_f32_16x16x32_bf16 v[128:131], v[224:227], a[64:67], v[128:131]
  ds_read_b64_tr_b16 v[250:251], v171 offset:29184
  v_mul_f32 v121, v189, v121
  v_mfma_f32_16x16x32_bf16 v[128:131], v[220:223], a[60:63], v[128:131]
  s_waitcnt lgkmcnt(4)
  ds_read_b64_tr_b16 v[252:253], v171 offset:32768
  ds_read_b64_tr_b16 v[254:255], v171 offset:33280
  v_mfma_f32_16x16x32_bf16 v[136:139], v[232:235], a[60:63], v[136:139]
  ds_read_b64_tr_b16 v[220:221], v168 offset:0
  v_add_u32 v171, 0, v175
  v_mfma_f32_16x16x32_bf16 v[136:139], v[236:239], a[64:67], v[136:139]
  s_add_u32 m0, s22, 65536
  ds_read_b64_tr_b16 v[222:223], v168 offset:512
  v_mul_f32 v122, v190, v122
  v_mfma_f32_16x16x32_bf16 v[136:139], v[240:243], a[68:71], v[136:139]
  buffer_load_dwordx4 v180, s[8:11], s23 offen lds
  v_mfma_f32_16x16x32_bf16 v[140:143], v[240:243], a[140:143], v[140:143]
  s_add_u32 s23, s23, 294912
  ds_read_b64_tr_b16 v[224:225], v168 offset:4096
  v_mul_f32 v123, v191, v123
  v_mfma_f32_16x16x32_bf16 v[140:143], v[236:239], a[136:139], v[140:143]
  ds_read_b64_tr_b16 v[226:227], v168 offset:4608
  v_mul_f32 v124, v192, v124
  v_mfma_f32_16x16x32_bf16 v[140:143], v[232:235], a[132:135], v[140:143]
  s_waitcnt lgkmcnt(4)
  ds_read_b64_tr_b16 v[228:229], v168 offset:8192
  ds_read_b64_tr_b16 v[230:231], v168 offset:8704
  v_mfma_f32_16x16x32_bf16 v[148:151], v[244:247], a[132:135], v[148:151]
  ds_read_b64_tr_b16 v[232:233], v169 offset:0
  v_mul_f32 v125, v193, v125
  v_mfma_f32_16x16x32_bf16 v[148:151], v[248:251], a[136:139], v[148:151]
  s_add_u32 m0, s22, 69632
  ds_read_b64_tr_b16 v[234:235], v169 offset:512
  v_mul_f32 v126, v194, v126
  v_mfma_f32_16x16x32_bf16 v[148:151], v[252:255], a[140:143], v[148:151]
  buffer_load_dwordx4 v180, s[8:11], s23 offen lds
  v_mfma_f32_16x16x32_bf16 v[144:147], v[252:255], a[68:71], v[144:147]
  ds_read_b64_tr_b16 v[236:237], v169 offset:4096
  v_mul_f32 v127, v195, v127
  v_mfma_f32_16x16x32_bf16 v[144:147], v[248:251], a[64:67], v[144:147]
  ds_read_b64_tr_b16 v[238:239], v169 offset:4608
  v_cvt_pk_bf16_f32 v16, v120, v121
  v_mfma_f32_16x16x32_bf16 v[144:147], v[244:247], a[60:63], v[144:147]
  s_waitcnt lgkmcnt(4)
  ds_read_b64_tr_b16 v[240:241], v169 offset:8192
  ds_read_b64_tr_b16 v[242:243], v169 offset:8704
  v_mfma_f32_16x16x32_bf16 v[88:91], v[220:223], a[0:3], 0
  ds_read_b64_tr_b16 v[244:245], v170 offset:0
  v_cvt_pk_bf16_f32 v17, v122, v123
  v_mfma_f32_16x16x32_bf16 v[88:91], v[224:227], a[4:7], v[88:91]
  s_waitcnt vmcnt(6)
  ds_read_b64_tr_b16 v[246:247], v170 offset:512
  v_cvt_pk_bf16_f32 v20, v124, v125
  v_mfma_f32_16x16x32_bf16 v[88:91], v[228:231], a[8:11], v[88:91]
  s_barrier
  v_mfma_f32_16x16x32_bf16 v[92:95], v[228:231], a[80:83], 0
  ds_read_b64_tr_b16 v[248:249], v170 offset:4096
  v_cvt_pk_bf16_f32 v21, v126, v127
  v_mfma_f32_16x16x32_bf16 v[92:95], v[224:227], a[76:79], v[92:95]
  ds_read_b64_tr_b16 v[250:251], v170 offset:4608
  v_mul_f32 v128, v196, v128
  v_mfma_f32_16x16x32_bf16 v[92:95], v[220:223], a[72:75], v[92:95]
  s_waitcnt lgkmcnt(4)
  ds_read_b64_tr_b16 v[252:253], v170 offset:8192
  ds_read_b64_tr_b16 v[254:255], v170 offset:8704
  v_mfma_f32_16x16x32_bf16 v[100:103], v[232:235], a[72:75], 0
  s_nop 0
  ds_read_b64_tr_b16 v[220:221], v171 offset:0
  ds_read_b64_tr_b16 v[222:223], v171 offset:512
  v_mfma_f32_16x16x32_bf16 v[100:103], v[236:239], a[76:79], v[100:103]
  s_add_u32 s23, s24, 128
  s_add_u32 m0, s22, 73728
  ds_read_b64_tr_b16 v[224:225], v171 offset:4096
  v_mul_f32 v129, v197, v129
  v_mfma_f32_16x16x32_bf16 v[100:103], v[240:243], a[80:83], v[100:103]
  buffer_load_dwordx4 v180, s[12:15], s23 offen lds
  v_mfma_f32_16x16x32_bf16 v[96:99], v[240:243], a[8:11], 0
  s_add_u32 s23, s23, 294912
  s_add_u32 m0, s22, 77824
  ds_read_b64_tr_b16 v[226:227], v171 offset:4608
  v_mfma_f32_16x16x32_bf16 v[96:99], v[236:239], a[4:7], v[96:99]
  buffer_load_dwordx4 v180, s[12:15], s23 offen lds
  v_mfma_f32_16x16x32_bf16 v[96:99], v[232:235], a[0:3], v[96:99]
  s_waitcnt lgkmcnt(4)
  ds_read_b64_tr_b16 v[228:229], v171 offset:8192
  ds_read_b64_tr_b16 v[230:231], v171 offset:8704
  v_mfma_f32_16x16x32_bf16 v[104:107], v[244:247], a[0:3], 0
  s_add_u32 s23, s23, 294912
  ds_read_b64_tr_b16 v[232:233], v168 offset:12288
  v_mul_f32 v130, v198, v130
  v_mfma_f32_16x16x32_bf16 v[104:107], v[248:251], a[4:7], v[104:107]
  s_add_u32 m0, s22, 81920
  ds_read_b64_tr_b16 v[234:235], v168 offset:12800
  v_mul_f32 v131, v199, v131
  v_mfma_f32_16x16x32_bf16 v[104:107], v[252:255], a[8:11], v[104:107]
  buffer_load_dwordx4 v180, s[12:15], s23 offen lds
  v_mfma_f32_16x16x32_bf16 v[108:111], v[252:255], a[80:83], 0
  s_add_u32 s23, s23, 294912
  ds_read_b64_tr_b16 v[236:237], v168 offset:16384
  v_mul_f32 v132, v200, v132
  v_mfma_f32_16x16x32_bf16 v[108:111], v[248:251], a[76:79], v[108:111]
  ds_read_b64_tr_b16 v[238:239], v168 offset:16896
  v_mul_f32 v133, v201, v133
  v_mfma_f32_16x16x32_bf16 v[108:111], v[244:247], a[72:75], v[108:111]
  s_waitcnt lgkmcnt(4)
  ds_read_b64_tr_b16 v[240:241], v168 offset:20480
  ds_read_b64_tr_b16 v[242:243], v168 offset:20992
  v_mfma_f32_16x16x32_bf16 v[116:119], v[220:223], a[72:75], 0
  ds_read_b64_tr_b16 v[244:245], v169 offset:12288
  v_mul_f32 v134, v202, v134
  v_mfma_f32_16x16x32_bf16 v[116:119], v[224:227], a[76:79], v[116:119]
  s_add_u32 m0, s22, 86016
  ds_read_b64_tr_b16 v[246:247], v169 offset:12800
  v_mul_f32 v135, v203, v135
  v_mfma_f32_16x16x32_bf16 v[116:119], v[228:231], a[80:83], v[116:119]
  buffer_load_dwordx4 v180, s[12:15], s23 offen lds
  v_mfma_f32_16x16x32_bf16 v[112:115], v[228:231], a[8:11], 0
  s_add_u32 s23, s23, 294912
  ds_read_b64_tr_b16 v[248:249], v169 offset:16384
  v_cvt_pk_bf16_f32 v18, v128, v129
  v_mfma_f32_16x16x32_bf16 v[112:115], v[224:227], a[4:7], v[112:115]
  ds_read_b64_tr_b16 v[250:251], v169 offset:16896
  v_cvt_pk_bf16_f32 v19, v130, v131
  v_mfma_f32_16x16x32_bf16 v[112:115], v[220:223], a[0:3], v[112:115]
  s_waitcnt lgkmcnt(4)
  ds_read_b64_tr_b16 v[252:253], v169 offset:20480
  ds_read_b64_tr_b16 v[254:255], v169 offset:20992
  v_mfma_f32_16x16x32_bf16 v[88:91], v[232:235], a[12:15], v[88:91]
  ds_read_b64_tr_b16 v[220:221], v170 offset:12288
  v_cvt_pk_bf16_f32 v22, v132, v133
  v_mfma_f32_16x16x32_bf16 v[88:91], v[236:239], a[16:19], v[88:91]
  s_add_u32 m0, s22, 90112
  ds_read_b64_tr_b16 v[222:223], v170 offset:12800
  v_cvt_pk_bf16_f32 v23, v134, v135
  v_mfma_f32_16x16x32_bf16 v[88:91], v[240:243], a[20:23], v[88:91]
  buffer_load_dwordx4 v180, s[12:15], s23 offen lds
  v_mfma_f32_16x16x32_bf16 v[92:95], v[240:243], a[92:95], v[92:95]
  s_add_u32 s23, s23, 294912
  ds_read_b64_tr_b16 v[224:225], v170 offset:16384
  v_mul_f32 v136, v204, v136
  v_mfma_f32_16x16x32_bf16 v[92:95], v[236:239], a[88:91], v[92:95]
  ds_read_b64_tr_b16 v[226:227], v170 offset:16896
  v_mul_f32 v137, v205, v137
  v_mfma_f32_16x16x32_bf16 v[92:95], v[232:235], a[84:87], v[92:95]
  s_waitcnt lgkmcnt(4)
  ds_read_b64_tr_b16 v[228:229], v170 offset:20480
  ds_read_b64_tr_b16 v[230:231], v170 offset:20992
  v_mfma_f32_16x16x32_bf16 v[100:103], v[244:247], a[84:87], v[100:103]
  ds_read_b64_tr_b16 v[232:233], v171 offset:12288
  v_mul_f32 v138, v206, v138
  v_mfma_f32_16x16x32_bf16 v[100:103], v[248:251], a[88:91], v[100:103]
  s_add_u32 m0, s22, 94208
  ds_read_b64_tr_b16 v[234:235], v171 offset:12800
  v_mul_f32 v139, v207, v139
  v_mfma_f32_16x16x32_bf16 v[100:103], v[252:255], a[92:95], v[100:103]
  buffer_load_dwordx4 v180, s[12:15], s23 offen lds
  v_mfma_f32_16x16x32_bf16 v[96:99], v[252:255], a[20:23], v[96:99]
  s_add_u32 s23, s23, 294912
  ds_read_b64_tr_b16 v[236:237], v171 offset:16384
  v_mul_f32 v140, v208, v140
  v_mfma_f32_16x16x32_bf16 v[96:99], v[248:251], a[16:19], v[96:99]
  ds_read_b64_tr_b16 v[238:239], v171 offset:16896
  v_mul_f32 v141, v209, v141
  v_mfma_f32_16x16x32_bf16 v[96:99], v[244:247], a[12:15], v[96:99]
  s_waitcnt lgkmcnt(4)
  ds_read_b64_tr_b16 v[240:241], v171 offset:20480
  ds_read_b64_tr_b16 v[242:243], v171 offset:20992
  v_mfma_f32_16x16x32_bf16 v[104:107], v[220:223], a[12:15], v[104:107]
  ds_read_b64_tr_b16 v[244:245], v168 offset:24576
  v_mul_f32 v142, v210, v142
  v_mfma_f32_16x16x32_bf16 v[104:107], v[224:227], a[16:19], v[104:107]
  s_add_u32 m0, s22, 98304
  ds_read_b64_tr_b16 v[246:247], v168 offset:25088
  v_mul_f32 v143, v211, v143
  v_mfma_f32_16x16x32_bf16 v[104:107], v[228:231], a[20:23], v[104:107]
  buffer_load_dwordx4 v180, s[12:15], s23 offen lds
  v_mfma_f32_16x16x32_bf16 v[108:111], v[228:231], a[92:95], v[108:111]
  s_add_u32 s23, s23, 294912
  ds_read_b64_tr_b16 v[248:249], v168 offset:28672
  v_cvt_pk_bf16_f32 v24, v136, v137
  v_mfma_f32_16x16x32_bf16 v[108:111], v[224:227], a[88:91], v[108:111]
  ds_read_b64_tr_b16 v[250:251], v168 offset:29184
  v_cvt_pk_bf16_f32 v25, v138, v139
  v_mfma_f32_16x16x32_bf16 v[108:111], v[220:223], a[84:87], v[108:111]
  s_waitcnt lgkmcnt(4)
  ds_read_b64_tr_b16 v[252:253], v168 offset:32768
  ds_read_b64_tr_b16 v[254:255], v168 offset:33280
  v_mfma_f32_16x16x32_bf16 v[116:119], v[232:235], a[84:87], v[116:119]
  ds_read_b64_tr_b16 v[220:221], v169 offset:24576
  v_add_u32 v168, 36864, v172
  v_mfma_f32_16x16x32_bf16 v[116:119], v[236:239], a[88:91], v[116:119]
  s_add_u32 m0, s22, 102400
  ds_read_b64_tr_b16 v[222:223], v169 offset:25088
  v_cvt_pk_bf16_f32 v28, v140, v141
  v_mfma_f32_16x16x32_bf16 v[116:119], v[240:243], a[92:95], v[116:119]
  buffer_load_dwordx4 v180, s[12:15], s23 offen lds
  v_mfma_f32_16x16x32_bf16 v[112:115], v[240:243], a[20:23], v[112:115]
  s_add_u32 s23, s23, 294912
  ds_read_b64_tr_b16 v[224:225], v169 offset:28672
  v_cvt_pk_bf16_f32 v29, v142, v143
  v_mfma_f32_16x16x32_bf16 v[112:115], v[236:239], a[16:19], v[112:115]
  ds_read_b64_tr_b16 v[226:227], v169 offset:29184
  v_mul_f32 v144, v212, v144
  v_mfma_f32_16x16x32_bf16 v[112:115], v[232:235], a[12:15], v[112:115]
  s_waitcnt lgkmcnt(4)
  ds_read_b64_tr_b16 v[228:229], v169 offset:32768
  ds_read_b64_tr_b16 v[230:231], v169 offset:33280
  v_mfma_f32_16x16x32_bf16 v[88:91], v[244:247], a[24:27], v[88:91]
  ds_read_b64_tr_b16 v[232:233], v170 offset:24576
  v_add_u32 v169, 36864, v173
  v_mfma_f32_16x16x32_bf16 v[88:91], v[248:251], a[28:31], v[88:91]
  s_add_u32 m0, s22, 106496
  ds_read_b64_tr_b16 v[234:235], v170 offset:25088
  v_mul_f32 v145, v213, v145
  v_mfma_f32_16x16x32_bf16 v[88:91], v[252:255], a[32:35], v[88:91]
  buffer_load_dwordx4 v180, s[12:15], s23 offen lds
  v_mfma_f32_16x16x32_bf16 v[92:95], v[252:255], a[104:107], v[92:95]
  s_add_u32 s23, s23, 294912
  ds_read_b64_tr_b16 v[236:237], v170 offset:28672
  v_mul_f32 v146, v214, v146
  v_mfma_f32_16x16x32_bf16 v[92:95], v[248:251], a[100:103], v[92:95]
  ds_read_b64_tr_b16 v[238:239], v170 offset:29184
  v_mul_f32 v147, v215, v147
  v_mfma_f32_16x16x32_bf16 v[92:95], v[244:247], a[96:99], v[92:95]
  s_waitcnt lgkmcnt(4)
  ds_read_b64_tr_b16 v[240:241], v170 offset:32768
  ds_read_b64_tr_b16 v[242:243], v170 offset:33280
  v_mfma_f32_16x16x32_bf16 v[100:103], v[220:223], a[96:99], v[100:103]
  ds_read_b64_tr_b16 v[244:245], v171 offset:24576
  v_add_u32 v170, 36864, v174
  v_mfma_f32_16x16x32_bf16 v[100:103], v[224:227], a[100:103], v[100:103]
  s_add_u32 m0, s22, 110592
  ds_read_b64_tr_b16 v[246:247], v171 offset:25088
  v_mul_f32 v148, v216, v148
  v_mfma_f32_16x16x32_bf16 v[100:103], v[228:231], a[104:107], v[100:103]
  buffer_load_dwordx4 v180, s[12:15], s23 offen lds
  v_mfma_f32_16x16x32_bf16 v[96:99], v[228:231], a[32:35], v[96:99]
  s_add_u32 s23, s23, 294912
  ds_read_b64_tr_b16 v[248:249], v171 offset:28672
  v_mul_f32 v149, v217, v149
  v_mfma_f32_16x16x32_bf16 v[96:99], v[224:227], a[28:31], v[96:99]
  ds_read_b64_tr_b16 v[250:251], v171 offset:29184
  v_mul_f32 v150, v218, v150
  v_mfma_f32_16x16x32_bf16 v[96:99], v[220:223], a[24:27], v[96:99]
  s_waitcnt lgkmcnt(4)
  ds_read_b64_tr_b16 v[252:253], v171 offset:32768
  ds_read_b64_tr_b16 v[254:255], v171 offset:33280
  v_mfma_f32_16x16x32_bf16 v[104:107], v[232:235], a[24:27], v[104:107]
  ds_read_b64_tr_b16 v[220:221], v168 offset:0
  v_add_u32 v171, 36864, v175
  v_mfma_f32_16x16x32_bf16 v[104:107], v[236:239], a[28:31], v[104:107]
  s_add_u32 m0, s22, 114688
  ds_read_b64_tr_b16 v[222:223], v168 offset:512
  v_mul_f32 v151, v219, v151
  v_mfma_f32_16x16x32_bf16 v[104:107], v[240:243], a[32:35], v[104:107]
  buffer_load_dwordx4 v180, s[12:15], s23 offen lds
  v_mfma_f32_16x16x32_bf16 v[108:111], v[240:243], a[104:107], v[108:111]
  s_add_u32 s23, s23, 294912
  ds_read_b64_tr_b16 v[224:225], v168 offset:4096
  v_cvt_pk_bf16_f32 v26, v144, v145
  v_mfma_f32_16x16x32_bf16 v[108:111], v[236:239], a[100:103], v[108:111]
  ds_read_b64_tr_b16 v[226:227], v168 offset:4608
  v_cvt_pk_bf16_f32 v27, v146, v147
  v_mfma_f32_16x16x32_bf16 v[108:111], v[232:235], a[96:99], v[108:111]
  s_waitcnt lgkmcnt(4)
  ds_read_b64_tr_b16 v[228:229], v168 offset:8192
  ds_read_b64_tr_b16 v[230:231], v168 offset:8704
  v_mfma_f32_16x16x32_bf16 v[116:119], v[244:247], a[96:99], v[116:119]
  ds_read_b64_tr_b16 v[232:233], v169 offset:0
  v_cvt_pk_bf16_f32 v30, v148, v149
  v_mfma_f32_16x16x32_bf16 v[116:119], v[248:251], a[100:103], v[116:119]
  s_add_u32 m0, s22, 118784
  ds_read_b64_tr_b16 v[234:235], v169 offset:512
  v_cvt_pk_bf16_f32 v31, v150, v151
  v_mfma_f32_16x16x32_bf16 v[116:119], v[252:255], a[104:107], v[116:119]
KB_I2:
  s_cbranch_execz KB_I5
  buffer_load_dwordx4 v180, s[12:15], s23 offen lds
  v_mfma_f32_16x16x32_bf16 v[112:115], v[252:255], a[32:35], v[112:115]
  s_add_u32 s23, s23, 294912
  ds_read_b64_tr_b16 v[236:237], v169 offset:4096
  v_mfma_f32_16x16x32_bf16 v[112:115], v[248:251], a[28:31], v[112:115]
  ds_read_b64_tr_b16 v[238:239], v169 offset:4608
  v_mfma_f32_16x16x32_bf16 v[112:115], v[244:247], a[24:27], v[112:115]
  s_waitcnt lgkmcnt(4)
  ds_read_b64_tr_b16 v[240:241], v169 offset:8192
  ds_read_b64_tr_b16 v[242:243], v169 offset:8704
  v_mfma_f32_16x16x32_bf16 v[88:91], v[220:223], a[36:39], v[88:91]
  ds_read_b64_tr_b16 v[244:245], v170 offset:0
  v_mfma_f32_16x16x32_bf16 v[88:91], v[224:227], a[40:43], v[88:91]
  s_waitcnt vmcnt(9)
  ds_read_b64_tr_b16 v[246:247], v170 offset:512
  v_mfma_f32_16x16x32_bf16 v[88:91], v[228:231], a[44:47], v[88:91]
  s_barrier
  v_mfma_f32_16x16x32_bf16 v[92:95], v[228:231], a[116:119], v[92:95]
  ds_read_b64_tr_b16 v[248:249], v170 offset:4096
  v_mfma_f32_16x16x32_bf16 v[92:95], v[224:227], a[112:115], v[92:95]
  ds_read_b64_tr_b16 v[250:251], v170 offset:4608
  v_mfma_f32_16x16x32_bf16 v[92:95], v[220:223], a[108:111], v[92:95]
  s_waitcnt lgkmcnt(4)
  ds_read_b64_tr_b16 v[252:253], v170 offset:8192
  ds_read_b64_tr_b16 v[254:255], v170 offset:8704
  v_mfma_f32_16x16x32_bf16 v[100:103], v[232:235], a[108:111], v[100:103]
  s_nop 0
  ds_read_b64_tr_b16 v[220:221], v171 offset:0
  ds_read_b64_tr_b16 v[222:223], v171 offset:512
  v_mfma_f32_16x16x32_bf16 v[100:103], v[236:239], a[112:115], v[100:103]
  s_add_u32 m0, s22, 122880
  ds_read_b64_tr_b16 v[224:225], v171 offset:4096
  v_mfma_f32_16x16x32_bf16 v[100:103], v[240:243], a[116:119], v[100:103]
  buffer_load_dwordx4 v180, s[12:15], s23 offen lds
  v_mfma_f32_16x16x32_bf16 v[96:99], v[240:243], a[44:47], v[96:99]
  s_add_u32 s23, s23, 294912
  s_add_u32 m0, s22, 126976
  ds_read_b64_tr_b16 v[226:227], v171 offset:4608
  v_mfma_f32_16x16x32_bf16 v[96:99], v[236:239], a[40:43], v[96:99]
  buffer_load_dwordx4 v180, s[12:15], s23 offen lds
  v_mfma_f32_16x16x32_bf16 v[96:99], v[232:235], a[36:39], v[96:99]
  s_waitcnt lgkmcnt(4)
  ds_read_b64_tr_b16 v[228:229], v171 offset:8192
  ds_read_b64_tr_b16 v[230:231], v171 offset:8704
  v_mfma_f32_16x16x32_bf16 v[104:107], v[244:247], a[36:39], v[104:107]
  s_add_u32 s23, s23, 294912
  ds_read_b64_tr_b16 v[232:233], v168 offset:12288
  v_mfma_f32_16x16x32_bf16 v[104:107], v[248:251], a[40:43], v[104:107]
  s_add_u32 m0, s22, 131072
  ds_read_b64_tr_b16 v[234:235], v168 offset:12800
  v_mfma_f32_16x16x32_bf16 v[104:107], v[252:255], a[44:47], v[104:107]
  buffer_load_dwordx4 v180, s[12:15], s23 offen lds
  v_mfma_f32_16x16x32_bf16 v[108:111], v[252:255], a[116:119], v[108:111]
  s_add_u32 s23, s23, 294912
  ds_read_b64_tr_b16 v[236:237], v168 offset:16384
  v_mfma_f32_16x16x32_bf16 v[108:111], v[248:251], a[112:115], v[108:111]
  ds_read_b64_tr_b16 v[238:239], v168 offset:16896
  v_mfma_f32_16x16x32_bf16 v[108:111], v[244:247], a[108:111], v[108:111]
  s_waitcnt lgkmcnt(4)
  ds_read_b64_tr_b16 v[240:241], v168 offset:20480
  ds_read_b64_tr_b16 v[242:243], v168 offset:20992
  v_mfma_f32_16x16x32_bf16 v[116:119], v[220:223], a[108:111], v[116:119]
  ds_read_b64_tr_b16 v[244:245], v169 offset:12288
  v_mfma_f32_16x16x32_bf16 v[116:119], v[224:227], a[112:115], v[116:119]
  s_add_u32 m0, s22, 135168
  ds_read_b64_tr_b16 v[246:247], v169 offset:12800
  v_mfma_f32_16x16x32_bf16 v[116:119], v[228:231], a[116:119], v[116:119]
  buffer_load_dwordx4 v180, s[12:15], s23 offen lds
  v_mfma_f32_16x16x32_bf16 v[112:115], v[228:231], a[44:47], v[112:115]
  s_add_u32 s23, s23, 294912
  ds_read_b64_tr_b16 v[248:249], v169 offset:16384
  v_mfma_f32_16x16x32_bf16 v[112:115], v[224:227], a[40:43], v[112:115]
  ds_read_b64_tr_b16 v[250:251], v169 offset:16896
  v_mfma_f32_16x16x32_bf16 v[112:115], v[220:223], a[36:39], v[112:115]
  s_waitcnt lgkmcnt(4)
  ds_read_b64_tr_b16 v[252:253], v169 offset:20480
  ds_read_b64_tr_b16 v[254:255], v169 offset:20992
  v_mfma_f32_16x16x32_bf16 v[88:91], v[232:235], a[48:51], v[88:91]
  ds_read_b64_tr_b16 v[220:221], v170 offset:12288
  v_mfma_f32_16x16x32_bf16 v[88:91], v[236:239], a[52:55], v[88:91]
  ds_read_b64_tr_b16 v[222:223], v170 offset:12800
  v_mfma_f32_16x16x32_bf16 v[88:91], v[240:243], a[56:59], v[88:91]
  buffer_store_dwordx4 v[16:19], v185, s[48:51], s31 offen offset:0 sc1
  v_mfma_f32_16x16x32_bf16 v[92:95], v[240:243], a[128:131], v[92:95]
  ds_read_b64_tr_b16 v[224:225], v170 offset:16384
  v_mfma_f32_16x16x32_bf16 v[92:95], v[236:239], a[124:127], v[92:95]
  ds_read_b64_tr_b16 v[226:227], v170 offset:16896
  v_mfma_f32_16x16x32_bf16 v[92:95], v[232:235], a[120:123], v[92:95]
  s_waitcnt lgkmcnt(4)
  ds_read_b64_tr_b16 v[228:229], v170 offset:20480
  ds_read_b64_tr_b16 v[230:231], v170 offset:20992
  v_mfma_f32_16x16x32_bf16 v[100:103], v[244:247], a[120:123], v[100:103]
  s_nop 0
  ds_read_b64_tr_b16 v[232:233], v171 offset:12288
  ds_read_b64_tr_b16 v[234:235], v171 offset:12800
  v_mfma_f32_16x16x32_bf16 v[100:103], v[248:251], a[124:127], v[100:103]
  s_add_u32 m0, s22, 139264
  ds_read_b64_tr_b16 v[236:237], v171 offset:16384
  v_mfma_f32_16x16x32_bf16 v[100:103], v[252:255], a[128:131], v[100:103]
  buffer_load_dwordx4 v180, s[12:15], s23 offen lds
  v_mfma_f32_16x16x32_bf16 v[96:99], v[252:255], a[56:59], v[96:99]
  s_add_u32 s23, s23, 294912
  ds_read_b64_tr_b16 v[238:239], v171 offset:16896
  v_mfma_f32_16x16x32_bf16 v[96:99], v[248:251], a[52:55], v[96:99]
  buffer_store_dwordx4 v[20:23], v185, s[48:51], s31 offen offset:1024 sc1
  v_mfma_f32_16x16x32_bf16 v[96:99], v[244:247], a[48:51], v[96:99]
  s_waitcnt lgkmcnt(4)
  ds_read_b64_tr_b16 v[240:241], v171 offset:20480
  ds_read_b64_tr_b16 v[242:243], v171 offset:20992
  v_mfma_f32_16x16x32_bf16 v[104:107], v[220:223], a[48:51], v[104:107]
  s_nop 0
  ds_read_b64_tr_b16 v[244:245], v168 offset:24576
  ds_read_b64_tr_b16 v[246:247], v168 offset:25088
  v_mfma_f32_16x16x32_bf16 v[104:107], v[224:227], a[52:55], v[104:107]
  s_add_u32 m0, s22, 143360
  ds_read_b64_tr_b16 v[248:249], v168 offset:28672
  v_mfma_f32_16x16x32_bf16 v[104:107], v[228:231], a[56:59], v[104:107]
  buffer_load_dwordx4 v180, s[12:15], s23 offen lds
  v_mfma_f32_16x16x32_bf16 v[108:111], v[228:231], a[128:131], v[108:111]
  ds_read_b64_tr_b16 v[250:251], v168 offset:29184
  v_mfma_f32_16x16x32_bf16 v[108:111], v[224:227], a[124:127], v[108:111]
  buffer_store_dwordx4 v[24:27], v185, s[48:51], s31 offen offset:2048 sc1
  v_mfma_f32_16x16x32_bf16 v[108:111], v[220:223], a[120:123], v[108:111]
  s_waitcnt lgkmcnt(4)
  ds_read_b64_tr_b16 v[252:253], v168 offset:32768
  ds_read_b64_tr_b16 v[254:255], v168 offset:33280
  v_mfma_f32_16x16x32_bf16 v[116:119], v[232:235], a[120:123], v[116:119]
  s_add_u32 s23, s24, 256
  ds_read_b64_tr_b16 v[220:221], v169 offset:24576
  v_add_u32 v168, 73728, v172
  v_mfma_f32_16x16x32_bf16 v[116:119], v[236:239], a[124:127], v[116:119]
  s_add_u32 m0, s22, 0
  ds_read_b64_tr_b16 v[222:223], v169 offset:25088
  v_mfma_f32_16x16x32_bf16 v[116:119], v[240:243], a[128:131], v[116:119]
  buffer_load_dwordx4 v180, s[8:11], s23 offen lds
  v_mfma_f32_16x16x32_bf16 v[112:115], v[240:243], a[56:59], v[112:115]
  s_add_u32 s23, s23, 294912
  ds_read_b64_tr_b16 v[224:225], v169 offset:28672
  v_mfma_f32_16x16x32_bf16 v[112:115], v[236:239], a[52:55], v[112:115]
  ds_read_b64_tr_b16 v[226:227], v169 offset:29184
  v_mfma_f32_16x16x32_bf16 v[112:115], v[232:235], a[48:51], v[112:115]
  s_waitcnt lgkmcnt(4)
  ds_read_b64_tr_b16 v[228:229], v169 offset:32768
  ds_read_b64_tr_b16 v[230:231], v169 offset:33280
  v_mfma_f32_16x16x32_bf16 v[88:91], v[244:247], a[60:63], v[88:91]
  ds_read_b64_tr_b16 v[232:233], v170 offset:24576
  v_add_u32 v169, 73728, v173
  v_mfma_f32_16x16x32_bf16 v[88:91], v[248:251], a[64:67], v[88:91]
  ds_read_b64_tr_b16 v[234:235], v170 offset:25088
  v_mfma_f32_16x16x32_bf16 v[88:91], v[252:255], a[68:71], v[88:91]
  buffer_store_dwordx4 v[28:31], v185, s[48:51], s31 offen offset:3072 sc1
  v_mfma_f32_16x16x32_bf16 v[92:95], v[252:255], a[140:143], v[92:95]
  s_add_u32 s31, s31, 4096
  ds_read_b64_tr_b16 v[236:237], v170 offset:28672
  v_mfma_f32_16x16x32_bf16 v[92:95], v[248:251], a[136:139], v[92:95]
  ds_read_b64_tr_b16 v[238:239], v170 offset:29184
  v_mfma_f32_16x16x32_bf16 v[92:95], v[244:247], a[132:135], v[92:95]
  s_waitcnt lgkmcnt(4)
  ds_read_b64_tr_b16 v[240:241], v170 offset:32768
  ds_read_b64_tr_b16 v[242:243], v170 offset:33280
  v_mfma_f32_16x16x32_bf16 v[100:103], v[220:223], a[132:135], v[100:103]
  s_nop 0
  ds_read_b64_tr_b16 v[244:245], v171 offset:24576
  ds_read_b64_tr_b16 v[246:247], v171 offset:25088
  v_mfma_f32_16x16x32_bf16 v[100:103], v[224:227], a[136:139], v[100:103]
  s_add_u32 m0, s22, 4096
  ds_read_b64_tr_b16 v[248:249], v171 offset:28672
  v_add_u32 v170, 73728, v174
  v_mfma_f32_16x16x32_bf16 v[100:103], v[228:231], a[140:143], v[100:103]
  buffer_load_dwordx4 v180, s[8:11], s23 offen lds
  v_mfma_f32_16x16x32_bf16 v[96:99], v[228:231], a[68:71], v[96:99]
  s_add_u32 s23, s23, 294912
  s_add_u32 m0, s22, 8192
  ds_read_b64_tr_b16 v[250:251], v171 offset:29184
  v_mfma_f32_16x16x32_bf16 v[96:99], v[224:227], a[64:67], v[96:99]
  buffer_load_dwordx4 v180, s[8:11], s23 offen lds
  v_mfma_f32_16x16x32_bf16 v[96:99], v[220:223], a[60:63], v[96:99]
  s_waitcnt lgkmcnt(4)
  ds_read_b64_tr_b16 v[252:253], v171 offset:32768
  ds_read_b64_tr_b16 v[254:255], v171 offset:33280
  v_mfma_f32_16x16x32_bf16 v[104:107], v[232:235], a[60:63], v[104:107]
  s_add_u32 s23, s23, 294912
  ds_read_b64_tr_b16 v[220:221], v168 offset:0
  v_add_u32 v171, 73728, v175
  v_mfma_f32_16x16x32_bf16 v[104:107], v[236:239], a[64:67], v[104:107]
  s_add_u32 m0, s22, 12288
  ds_read_b64_tr_b16 v[222:223], v168 offset:512
  v_max_f32 v188, 0, v88
  v_mfma_f32_16x16x32_bf16 v[104:107], v[240:243], a[68:71], v[104:107]
  buffer_load_dwordx4 v180, s[8:11], s23 offen lds
  v_mfma_f32_16x16x32_bf16 v[108:111], v[240:243], a[140:143], v[108:111]
  s_add_u32 s23, s23, 294912
  ds_read_b64_tr_b16 v[224:225], v168 offset:4096
  v_max_f32 v189, 0, v89
  v_mfma_f32_16x16x32_bf16 v[108:111], v[236:239], a[136:139], v[108:111]
  ds_read_b64_tr_b16 v[226:227], v168 offset:4608
  v_max_f32 v190, 0, v90
  v_mfma_f32_16x16x32_bf16 v[108:111], v[232:235], a[132:135], v[108:111]
  s_waitcnt lgkmcnt(4)
  ds_read_b64_tr_b16 v[228:229], v168 offset:8192
  ds_read_b64_tr_b16 v[230:231], v168 offset:8704
  v_mfma_f32_16x16x32_bf16 v[116:119], v[244:247], a[132:135], v[116:119]
  ds_read_b64_tr_b16 v[232:233], v169 offset:0
  v_max_f32 v191, 0, v91
  v_mfma_f32_16x16x32_bf16 v[116:119], v[248:251], a[136:139], v[116:119]
  s_add_u32 m0, s22, 16384
  ds_read_b64_tr_b16 v[234:235], v169 offset:512
  v_max_f32 v192, 0, v92
  v_mfma_f32_16x16x32_bf16 v[116:119], v[252:255], a[140:143], v[116:119]
  buffer_load_dwordx4 v180, s[8:11], s23 offen lds
  v_mfma_f32_16x16x32_bf16 v[112:115], v[252:255], a[68:71], v[112:115]
  s_add_u32 s23, s23, 294912
  ds_read_b64_tr_b16 v[236:237], v169 offset:4096
  v_max_f32 v193, 0, v93
  v_mfma_f32_16x16x32_bf16 v[112:115], v[248:251], a[64:67], v[112:115]
  ds_read_b64_tr_b16 v[238:239], v169 offset:4608
  v_max_f32 v194, 0, v94
  v_mfma_f32_16x16x32_bf16 v[112:115], v[244:247], a[60:63], v[112:115]
  s_waitcnt lgkmcnt(4)
  ds_read_b64_tr_b16 v[240:241], v169 offset:8192
  ds_read_b64_tr_b16 v[242:243], v169 offset:8704
  v_mfma_f32_16x16x32_bf16 v[120:123], v[220:223], a[0:3], 0
  ds_read_b64_tr_b16 v[244:245], v170 offset:0
  v_max_f32 v195, 0, v95
  v_mfma_f32_16x16x32_bf16 v[120:123], v[224:227], a[4:7], v[120:123]
  s_waitcnt vmcnt(15)
  ds_read_b64_tr_b16 v[246:247], v170 offset:512
  v_max_f32 v196, 0, v96
  v_mfma_f32_16x16x32_bf16 v[120:123], v[228:231], a[8:11], v[120:123]
  s_barrier
  v_mfma_f32_16x16x32_bf16 v[124:127], v[228:231], a[80:83], 0
  ds_read_b64_tr_b16 v[248:249], v170 offset:4096
  v_max_f32 v197, 0, v97
  v_mfma_f32_16x16x32_bf16 v[124:127], v[224:227], a[76:79], v[124:127]
  ds_read_b64_tr_b16 v[250:251], v170 offset:4608
  v_max_f32 v198, 0, v98
  v_mfma_f32_16x16x32_bf16 v[124:127], v[220:223], a[72:75], v[124:127]
  s_waitcnt lgkmcnt(4)
  ds_read_b64_tr_b16 v[252:253], v170 offset:8192
  ds_read_b64_tr_b16 v[254:255], v170 offset:8704
  v_mfma_f32_16x16x32_bf16 v[132:135], v[232:235], a[72:75], 0
  s_nop 0
  ds_read_b64_tr_b16 v[220:221], v171 offset:0
  ds_read_b64_tr_b16 v[222:223], v171 offset:512
  v_mfma_f32_16x16x32_bf16 v[132:135], v[236:239], a[76:79], v[132:135]
  s_add_u32 m0, s22, 20480
  ds_read_b64_tr_b16 v[224:225], v171 offset:4096
  v_max_f32 v199, 0, v99
  v_mfma_f32_16x16x32_bf16 v[132:135], v[240:243], a[80:83], v[132:135]
  buffer_load_dwordx4 v180, s[8:11], s23 offen lds
  v_mfma_f32_16x16x32_bf16 v[128:131], v[240:243], a[8:11], 0
  s_add_u32 s23, s23, 294912
  s_add_u32 m0, s22, 24576
  ds_read_b64_tr_b16 v[226:227], v171 offset:4608
  v_mfma_f32_16x16x32_bf16 v[128:131], v[236:239], a[4:7], v[128:131]
  buffer_load_dwordx4 v180, s[8:11], s23 offen lds
  v_mfma_f32_16x16x32_bf16 v[128:131], v[232:235], a[0:3], v[128:131]
  s_waitcnt lgkmcnt(4)
  ds_read_b64_tr_b16 v[228:229], v171 offset:8192
  ds_read_b64_tr_b16 v[230:231], v171 offset:8704
  v_mfma_f32_16x16x32_bf16 v[136:139], v[244:247], a[0:3], 0
  s_add_u32 s23, s23, 294912
  ds_read_b64_tr_b16 v[232:233], v168 offset:12288
  v_max_f32 v200, 0, v100
  v_mfma_f32_16x16x32_bf16 v[136:139], v[248:251], a[4:7], v[136:139]
  s_add_u32 m0, s22, 28672
  ds_read_b64_tr_b16 v[234:235], v168 offset:12800
  v_max_f32 v201, 0, v101
  v_mfma_f32_16x16x32_bf16 v[136:139], v[252:255], a[8:11], v[136:139]
  buffer_load_dwordx4 v180, s[8:11], s23 offen lds
  v_mfma_f32_16x16x32_bf16 v[140:143], v[252:255], a[80:83], 0
  s_add_u32 s23, s23, 294912
  ds_read_b64_tr_b16 v[236:237], v168 offset:16384
  v_max_f32 v202, 0, v102
  v_mfma_f32_16x16x32_bf16 v[140:143], v[248:251], a[76:79], v[140:143]
  ds_read_b64_tr_b16 v[238:239], v168 offset:16896
  v_max_f32 v203, 0, v103
  v_mfma_f32_16x16x32_bf16 v[140:143], v[244:247], a[72:75], v[140:143]
  s_waitcnt lgkmcnt(4)
  ds_read_b64_tr_b16 v[240:241], v168 offset:20480
  ds_read_b64_tr_b16 v[242:243], v168 offset:20992
  v_mfma_f32_16x16x32_bf16 v[148:151], v[220:223], a[72:75], 0
  ds_read_b64_tr_b16 v[244:245], v169 offset:12288
  v_max_f32 v204, 0, v104
  v_mfma_f32_16x16x32_bf16 v[148:151], v[224:227], a[76:79], v[148:151]
  s_add_u32 m0, s22, 32768
  ds_read_b64_tr_b16 v[246:247], v169 offset:12800
  v_max_f32 v205, 0, v105
  v_mfma_f32_16x16x32_bf16 v[148:151], v[228:231], a[80:83], v[148:151]
  buffer_load_dwordx4 v180, s[8:11], s23 offen lds
  v_mfma_f32_16x16x32_bf16 v[144:147], v[228:231], a[8:11], 0
  s_add_u32 s23, s23, 294912
  ds_read_b64_tr_b16 v[248:249], v169 offset:16384
  v_max_f32 v206, 0, v106
  v_mfma_f32_16x16x32_bf16 v[144:147], v[224:227], a[4:7], v[144:147]
  ds_read_b64_tr_b16 v[250:251], v169 offset:16896
  v_max_f32 v207, 0, v107
  v_mfma_f32_16x16x32_bf16 v[144:147], v[220:223], a[0:3], v[144:147]
  s_waitcnt lgkmcnt(4)
  ds_read_b64_tr_b16 v[252:253], v169 offset:20480
  ds_read_b64_tr_b16 v[254:255], v169 offset:20992
  v_mfma_f32_16x16x32_bf16 v[120:123], v[232:235], a[12:15], v[120:123]
  ds_read_b64_tr_b16 v[220:221], v170 offset:12288
  v_max_f32 v208, 0, v108
  v_mfma_f32_16x16x32_bf16 v[120:123], v[236:239], a[16:19], v[120:123]
  s_add_u32 m0, s22, 36864
  ds_read_b64_tr_b16 v[222:223], v170 offset:12800
  v_max_f32 v209, 0, v109
  v_mfma_f32_16x16x32_bf16 v[120:123], v[240:243], a[20:23], v[120:123]
  buffer_load_dwordx4 v180, s[8:11], s23 offen lds
  v_mfma_f32_16x16x32_bf16 v[124:127], v[240:243], a[92:95], v[124:127]
  s_add_u32 s23, s23, 294912
  ds_read_b64_tr_b16 v[224:225], v170 offset:16384
  v_max_f32 v210, 0, v110
  v_mfma_f32_16x16x32_bf16 v[124:127], v[236:239], a[88:91], v[124:127]
  ds_read_b64_tr_b16 v[226:227], v170 offset:16896
  v_max_f32 v211, 0, v111
  v_mfma_f32_16x16x32_bf16 v[124:127], v[232:235], a[84:87], v[124:127]
  s_waitcnt lgkmcnt(4)
  ds_read_b64_tr_b16 v[228:229], v170 offset:20480
  ds_read_b64_tr_b16 v[230:231], v170 offset:20992
  v_mfma_f32_16x16x32_bf16 v[132:135], v[244:247], a[84:87], v[132:135]
  ds_read_b64_tr_b16 v[232:233], v171 offset:12288
  v_max_f32 v212, 0, v112
  v_mfma_f32_16x16x32_bf16 v[132:135], v[248:251], a[88:91], v[132:135]
  s_add_u32 m0, s22, 40960
  ds_read_b64_tr_b16 v[234:235], v171 offset:12800
  v_max_f32 v213, 0, v113
  v_mfma_f32_16x16x32_bf16 v[132:135], v[252:255], a[92:95], v[132:135]
  buffer_load_dwordx4 v180, s[8:11], s23 offen lds
  v_mfma_f32_16x16x32_bf16 v[128:131], v[252:255], a[20:23], v[128:131]
  s_add_u32 s23, s23, 294912
  ds_read_b64_tr_b16 v[236:237], v171 offset:16384
  v_max_f32 v214, 0, v114
  v_mfma_f32_16x16x32_bf16 v[128:131], v[248:251], a[16:19], v[128:131]
  ds_read_b64_tr_b16 v[238:239], v171 offset:16896
  v_max_f32 v215, 0, v115
  v_mfma_f32_16x16x32_bf16 v[128:131], v[244:247], a[12:15], v[128:131]
  s_waitcnt lgkmcnt(4)
  ds_read_b64_tr_b16 v[240:241], v171 offset:20480
  ds_read_b64_tr_b16 v[242:243], v171 offset:20992
  v_mfma_f32_16x16x32_bf16 v[136:139], v[220:223], a[12:15], v[136:139]
  ds_read_b64_tr_b16 v[244:245], v168 offset:24576
  v_max_f32 v216, 0, v116
  v_mfma_f32_16x16x32_bf16 v[136:139], v[224:227], a[16:19], v[136:139]
  s_add_u32 m0, s22, 45056
  ds_read_b64_tr_b16 v[246:247], v168 offset:25088
  v_max_f32 v217, 0, v117
  v_mfma_f32_16x16x32_bf16 v[136:139], v[228:231], a[20:23], v[136:139]
  buffer_load_dwordx4 v180, s[8:11], s23 offen lds
  v_mfma_f32_16x16x32_bf16 v[140:143], v[228:231], a[92:95], v[140:143]
  s_add_u32 s23, s23, 294912
  ds_read_b64_tr_b16 v[248:249], v168 offset:28672
  v_max_f32 v218, 0, v118
  v_mfma_f32_16x16x32_bf16 v[140:143], v[224:227], a[88:91], v[140:143]
  ds_read_b64_tr_b16 v[250:251], v168 offset:29184
  v_max_f32 v219, 0, v119
  v_mfma_f32_16x16x32_bf16 v[140:143], v[220:223], a[84:87], v[140:143]
  s_waitcnt lgkmcnt(4)
  ds_read_b64_tr_b16 v[252:253], v168 offset:32768
  ds_read_b64_tr_b16 v[254:255], v168 offset:33280
  v_mfma_f32_16x16x32_bf16 v[148:151], v[232:235], a[84:87], v[148:151]
  ds_read_b64_tr_b16 v[220:221], v169 offset:24576
  v_add_u32 v168, 110592, v172
  v_mfma_f32_16x16x32_bf16 v[148:151], v[236:239], a[88:91], v[148:151]
  s_add_u32 m0, s22, 49152
  ds_read_b64_tr_b16 v[222:223], v169 offset:25088
  v_mfma_f32_16x16x32_bf16 v[148:151], v[240:243], a[92:95], v[148:151]
  buffer_load_dwordx4 v180, s[8:11], s23 offen lds
  v_mfma_f32_16x16x32_bf16 v[144:147], v[240:243], a[20:23], v[144:147]
  s_add_u32 s23, s23, 294912
  ds_read_b64_tr_b16 v[224:225], v169 offset:28672
  v_mfma_f32_16x16x32_bf16 v[144:147], v[236:239], a[16:19], v[144:147]
  ds_read_b64_tr_b16 v[226:227], v169 offset:29184
  v_mfma_f32_16x16x32_bf16 v[144:147], v[232:235], a[12:15], v[144:147]
  s_waitcnt lgkmcnt(4)
  ds_read_b64_tr_b16 v[228:229], v169 offset:32768
  ds_read_b64_tr_b16 v[230:231], v169 offset:33280
  v_mfma_f32_16x16x32_bf16 v[120:123], v[244:247], a[24:27], v[120:123]
  ds_read_b64_tr_b16 v[232:233], v170 offset:24576
  v_add_u32 v169, 110592, v173
  v_mfma_f32_16x16x32_bf16 v[120:123], v[248:251], a[28:31], v[120:123]
  s_waitcnt vmcnt(12)
  ds_read_b64_tr_b16 v[234:235], v170 offset:25088
  v_mfma_f32_16x16x32_bf16 v[120:123], v[252:255], a[32:35], v[120:123]
  buffer_store_dword v14, v186, s[48:51], s34 offen offset:0 sc1
  v_mfma_f32_16x16x32_bf16 v[124:127], v[252:255], a[104:107], v[124:127]
  ds_read_b64_tr_b16 v[236:237], v170 offset:28672
  v_mfma_f32_16x16x32_bf16 v[124:127], v[248:251], a[100:103], v[124:127]
  ds_read_b64_tr_b16 v[238:239], v170 offset:29184
  v_mfma_f32_16x16x32_bf16 v[124:127], v[244:247], a[96:99], v[124:127]
  s_waitcnt lgkmcnt(4)
  ds_read_b64_tr_b16 v[240:241], v170 offset:32768
  ds_read_b64_tr_b16 v[242:243], v170 offset:33280
  v_mfma_f32_16x16x32_bf16 v[132:135], v[220:223], a[96:99], v[132:135]
  ds_read_b64_tr_b16 v[244:245], v171 offset:24576
  v_add_u32 v170, 110592, v174
  v_mfma_f32_16x16x32_bf16 v[132:135], v[224:227], a[100:103], v[132:135]
  s_add_u32 m0, s22, 53248
  ds_read_b64_tr_b16 v[246:247], v171 offset:25088
  v_mfma_f32_16x16x32_bf16 v[132:135], v[228:231], a[104:107], v[132:135]
  buffer_load_dwordx4 v180, s[8:11], s23 offen lds
  v_mfma_f32_16x16x32_bf16 v[128:131], v[228:231], a[32:35], v[128:131]
  s_add_u32 s23, s23, 294912
  ds_read_b64_tr_b16 v[248:249], v171 offset:28672
  v_mfma_f32_16x16x32_bf16 v[128:131], v[224:227], a[28:31], v[128:131]
  ds_read_b64_tr_b16 v[250:251], v171 offset:29184
  v_mfma_f32_16x16x32_bf16 v[128:131], v[220:223], a[24:27], v[128:131]
  s_waitcnt lgkmcnt(4)
  ds_read_b64_tr_b16 v[252:253], v171 offset:32768
  ds_read_b64_tr_b16 v[254:255], v171 offset:33280
  v_mfma_f32_16x16x32_bf16 v[136:139], v[232:235], a[24:27], v[136:139]
  ds_read_b64_tr_b16 v[220:221], v168 offset:0
  v_add_u32 v171, 110592, v175
  v_mfma_f32_16x16x32_bf16 v[136:139], v[236:239], a[28:31], v[136:139]
  s_add_u32 m0, s22, 57344
  ds_read_b64_tr_b16 v[222:223], v168 offset:512
  v_mfma_f32_16x16x32_bf16 v[136:139], v[240:243], a[32:35], v[136:139]
  buffer_load_dwordx4 v180, s[8:11], s23 offen lds
  v_mfma_f32_16x16x32_bf16 v[140:143], v[240:243], a[104:107], v[140:143]
  s_add_u32 s23, s23, 294912
  ds_read_b64_tr_b16 v[224:225], v168 offset:4096
  v_mfma_f32_16x16x32_bf16 v[140:143], v[236:239], a[100:103], v[140:143]
  ds_read_b64_tr_b16 v[226:227], v168 offset:4608
  v_mfma_f32_16x16x32_bf16 v[140:143], v[232:235], a[96:99], v[140:143]
  s_waitcnt lgkmcnt(4)
  ds_read_b64_tr_b16 v[228:229], v168 offset:8192
  ds_read_b64_tr_b16 v[230:231], v168 offset:8704
  v_mfma_f32_16x16x32_bf16 v[148:151], v[244:247], a[96:99], v[148:151]
  ds_read_b64_tr_b16 v[232:233], v169 offset:0
  v_mfma_f32_16x16x32_bf16 v[148:151], v[248:251], a[100:103], v[148:151]
  s_add_u32 m0, s22, 61440
  ds_read_b64_tr_b16 v[234:235], v169 offset:512
  v_mfma_f32_16x16x32_bf16 v[148:151], v[252:255], a[104:107], v[148:151]
  buffer_load_dwordx4 v180, s[8:11], s23 offen lds
  v_mfma_f32_16x16x32_bf16 v[144:147], v[252:255], a[32:35], v[144:147]
  s_add_u32 s23, s23, 294912
  ds_read_b64_tr_b16 v[236:237], v169 offset:4096
  v_mfma_f32_16x16x32_bf16 v[144:147], v[248:251], a[28:31], v[144:147]
  ds_read_b64_tr_b16 v[238:239], v169 offset:4608
  v_mfma_f32_16x16x32_bf16 v[144:147], v[244:247], a[24:27], v[144:147]
  s_waitcnt lgkmcnt(4)
  ds_read_b64_tr_b16 v[240:241], v169 offset:8192
  ds_read_b64_tr_b16 v[242:243], v169 offset:8704
  v_mfma_f32_16x16x32_bf16 v[120:123], v[220:223], a[36:39], v[120:123]
  ds_read_b64_tr_b16 v[244:245], v170 offset:0
  v_mfma_f32_16x16x32_bf16 v[120:123], v[224:227], a[40:43], v[120:123]
  s_waitcnt vmcnt(14)
  ds_read_b64_tr_b16 v[246:247], v170 offset:512
  v_mfma_f32_16x16x32_bf16 v[120:123], v[228:231], a[44:47], v[120:123]
  s_barrier
  v_mfma_f32_16x16x32_bf16 v[124:127], v[228:231], a[116:119], v[124:127]
  ds_read_b64_tr_b16 v[248:249], v170 offset:4096
  v_mfma_f32_16x16x32_bf16 v[124:127], v[224:227], a[112:115], v[124:127]
  ds_read_b64_tr_b16 v[250:251], v170 offset:4608
  v_mfma_f32_16x16x32_bf16 v[124:127], v[220:223], a[108:111], v[124:127]
  s_waitcnt lgkmcnt(4)
  ds_read_b64_tr_b16 v[252:253], v170 offset:8192
  ds_read_b64_tr_b16 v[254:255], v170 offset:8704
  v_mfma_f32_16x16x32_bf16 v[132:135], v[232:235], a[108:111], v[132:135]
  s_nop 0
  ds_read_b64_tr_b16 v[220:221], v171 offset:0
  ds_read_b64_tr_b16 v[222:223], v171 offset:512
  v_mfma_f32_16x16x32_bf16 v[132:135], v[236:239], a[112:115], v[132:135]
  s_add_u32 m0, s22, 65536
  ds_read_b64_tr_b16 v[224:225], v171 offset:4096
  v_mfma_f32_16x16x32_bf16 v[132:135], v[240:243], a[116:119], v[132:135]
  buffer_load_dwordx4 v180, s[8:11], s23 offen lds
  v_mfma_f32_16x16x32_bf16 v[128:131], v[240:243], a[44:47], v[128:131]
  s_add_u32 s23, s23, 294912
  s_add_u32 m0, s22, 69632
  ds_read_b64_tr_b16 v[226:227], v171 offset:4608
  v_mfma_f32_16x16x32_bf16 v[128:131], v[236:239], a[40:43], v[128:131]
  buffer_load_dwordx4 v180, s[8:11], s23 offen lds
  v_mfma_f32_16x16x32_bf16 v[128:131], v[232:235], a[36:39], v[128:131]
  s_waitcnt lgkmcnt(4)
  ds_read_b64_tr_b16 v[228:229], v171 offset:8192
  ds_read_b64_tr_b16 v[230:231], v171 offset:8704
  v_mfma_f32_16x16x32_bf16 v[136:139], v[244:247], a[36:39], v[136:139]
  s_add_u32 s23, s24, 256
  ds_read_b64_tr_b16 v[232:233], v168 offset:12288
  v_mfma_f32_16x16x32_bf16 v[136:139], v[248:251], a[40:43], v[136:139]
  s_add_u32 m0, s22, 73728
  ds_read_b64_tr_b16 v[234:235], v168 offset:12800
  v_mfma_f32_16x16x32_bf16 v[136:139], v[252:255], a[44:47], v[136:139]
  buffer_load_dwordx4 v180, s[12:15], s23 offen lds
  v_mfma_f32_16x16x32_bf16 v[140:143], v[252:255], a[116:119], v[140:143]
  s_add_u32 s23, s23, 294912
  ds_read_b64_tr_b16 v[236:237], v168 offset:16384
  v_mfma_f32_16x16x32_bf16 v[140:143], v[248:251], a[112:115], v[140:143]
  ds_read_b64_tr_b16 v[238:239], v168 offset:16896
  v_mfma_f32_16x16x32_bf16 v[140:143], v[244:247], a[108:111], v[140:143]
  s_waitcnt lgkmcnt(4)
  ds_read_b64_tr_b16 v[240:241], v168 offset:20480
  ds_read_b64_tr_b16 v[242:243], v168 offset:20992
  v_mfma_f32_16x16x32_bf16 v[148:151], v[220:223], a[108:111], v[148:151]
  ds_read_b64_tr_b16 v[244:245], v169 offset:12288
  v_mfma_f32_16x16x32_bf16 v[148:151], v[224:227], a[112:115], v[148:151]
  s_add_u32 m0, s22, 77824
  ds_read_b64_tr_b16 v[246:247], v169 offset:12800
  v_mfma_f32_16x16x32_bf16 v[148:151], v[228:231], a[116:119], v[148:151]
  buffer_load_dwordx4 v180, s[12:15], s23 offen lds
  v_mfma_f32_16x16x32_bf16 v[144:147], v[228:231], a[44:47], v[144:147]
  s_add_u32 s23, s23, 294912
  ds_read_b64_tr_b16 v[248:249], v169 offset:16384
  v_mfma_f32_16x16x32_bf16 v[144:147], v[224:227], a[40:43], v[144:147]
  ds_read_b64_tr_b16 v[250:251], v169 offset:16896
  v_mfma_f32_16x16x32_bf16 v[144:147], v[220:223], a[36:39], v[144:147]
  s_waitcnt lgkmcnt(4)
  ds_read_b64_tr_b16 v[252:253], v169 offset:20480
  ds_read_b64_tr_b16 v[254:255], v169 offset:20992
  v_mfma_f32_16x16x32_bf16 v[120:123], v[232:235], a[48:51], v[120:123]
  ds_read_b64_tr_b16 v[220:221], v170 offset:12288
  v_mfma_f32_16x16x32_bf16 v[120:123], v[236:239], a[52:55], v[120:123]
  s_add_u32 m0, s22, 81920
  ds_read_b64_tr_b16 v[222:223], v170 offset:12800
  v_mfma_f32_16x16x32_bf16 v[120:123], v[240:243], a[56:59], v[120:123]
  buffer_load_dwordx4 v180, s[12:15], s23 offen lds
  v_mfma_f32_16x16x32_bf16 v[124:127], v[240:243], a[128:131], v[124:127]
  s_add_u32 s23, s23, 294912
  ds_read_b64_tr_b16 v[224:225], v170 offset:16384
  v_mfma_f32_16x16x32_bf16 v[124:127], v[236:239], a[124:127], v[124:127]
  ds_read_b64_tr_b16 v[226:227], v170 offset:16896
  v_mfma_f32_16x16x32_bf16 v[124:127], v[232:235], a[120:123], v[124:127]
  s_waitcnt lgkmcnt(4)
  ds_read_b64_tr_b16 v[228:229], v170 offset:20480
  ds_read_b64_tr_b16 v[230:231], v170 offset:20992
  v_mfma_f32_16x16x32_bf16 v[132:135], v[244:247], a[120:123], v[132:135]
  ds_read_b64_tr_b16 v[232:233], v171 offset:12288
  v_mfma_f32_16x16x32_bf16 v[132:135], v[248:251], a[124:127], v[132:135]
  s_add_u32 m0, s22, 86016
  ds_read_b64_tr_b16 v[234:235], v171 offset:12800
  v_mfma_f32_16x16x32_bf16 v[132:135], v[252:255], a[128:131], v[132:135]
  buffer_load_dwordx4 v180, s[12:15], s23 offen lds
  v_mfma_f32_16x16x32_bf16 v[128:131], v[252:255], a[56:59], v[128:131]
  s_add_u32 s23, s23, 294912
  ds_read_b64_tr_b16 v[236:237], v171 offset:16384
  v_mfma_f32_16x16x32_bf16 v[128:131], v[248:251], a[52:55], v[128:131]
  ds_read_b64_tr_b16 v[238:239], v171 offset:16896
  v_mfma_f32_16x16x32_bf16 v[128:131], v[244:247], a[48:51], v[128:131]
  s_waitcnt lgkmcnt(4)
  ds_read_b64_tr_b16 v[240:241], v171 offset:20480
  ds_read_b64_tr_b16 v[242:243], v171 offset:20992
  v_mfma_f32_16x16x32_bf16 v[136:139], v[220:223], a[48:51], v[136:139]
  ds_read_b64_tr_b16 v[244:245], v168 offset:24576
  v_mfma_f32_16x16x32_bf16 v[136:139], v[224:227], a[52:55], v[136:139]
  s_add_u32 m0, s22, 90112
  ds_read_b64_tr_b16 v[246:247], v168 offset:25088
  v_mfma_f32_16x16x32_bf16 v[136:139], v[228:231], a[56:59], v[136:139]
KB_I3:
  s_cbranch_execz KB_I6
  buffer_load_dwordx4 v180, s[12:15], s23 offen lds
  v_mfma_f32_16x16x32_bf16 v[140:143], v[228:231], a[128:131], v[140:143]
  s_add_u32 s23, s23, 294912
  ds_read_b64_tr_b16 v[248:249], v168 offset:28672
  v_mfma_f32_16x16x32_bf16 v[140:143], v[224:227], a[124:127], v[140:143]
  ds_read_b64_tr_b16 v[250:251], v168 offset:29184
  v_mfma_f32_16x16x32_bf16 v[140:143], v[220:223], a[120:123], v[140:143]
  s_waitcnt lgkmcnt(4)
  ds_read_b64_tr_b16 v[252:253], v168 offset:32768
  ds_read_b64_tr_b16 v[254:255], v168 offset:33280
  v_mfma_f32_16x16x32_bf16 v[148:151], v[232:235], a[120:123], v[148:151]
  ds_read_b64_tr_b16 v[220:221], v169 offset:24576
  v_add_u32 v168, 0, v172
  v_mfma_f32_16x16x32_bf16 v[148:151], v[236:239], a[124:127], v[148:151]
  s_add_u32 m0, s22, 94208
  ds_read_b64_tr_b16 v[222:223], v169 offset:25088
  v_mfma_f32_16x16x32_bf16 v[148:151], v[240:243], a[128:131], v[148:151]
  buffer_load_dwordx4 v180, s[12:15], s23 offen lds
  v_mfma_f32_16x16x32_bf16 v[144:147], v[240:243], a[56:59], v[144:147]
  s_add_u32 s23, s23, 294912
  ds_read_b64_tr_b16 v[224:225], v169 offset:28672
  v_mfma_f32_16x16x32_bf16 v[144:147], v[236:239], a[52:55], v[144:147]
  ds_read_b64_tr_b16 v[226:227], v169 offset:29184
  v_mfma_f32_16x16x32_bf16 v[144:147], v[232:235], a[48:51], v[144:147]
  s_waitcnt lgkmcnt(4)
  ds_read_b64_tr_b16 v[228:229], v169 offset:32768
  ds_read_b64_tr_b16 v[230:231], v169 offset:33280
  v_mfma_f32_16x16x32_bf16 v[120:123], v[244:247], a[60:63], v[120:123]
  ds_read_b64_tr_b16 v[232:233], v170 offset:24576
  v_add_u32 v169, 0, v173
  v_mfma_f32_16x16x32_bf16 v[120:123], v[248:251], a[64:67], v[120:123]
  ds_read_b64_tr_b16 v[234:235], v170 offset:25088
  v_mfma_f32_16x16x32_bf16 v[120:123], v[252:255], a[68:71], v[120:123]
  buffer_load_dword v15, v186, s[48:51], s35 offen offset:0 sc1
  v_mfma_f32_16x16x32_bf16 v[124:127], v[252:255], a[140:143], v[124:127]
  ds_read_b64_tr_b16 v[236:237], v170 offset:28672
  v_mfma_f32_16x16x32_bf16 v[124:127], v[248:251], a[136:139], v[124:127]
  ds_read_b64_tr_b16 v[238:239], v170 offset:29184
  v_mfma_f32_16x16x32_bf16 v[124:127], v[244:247], a[132:135], v[124:127]
  s_waitcnt lgkmcnt(4)
  ds_read_b64_tr_b16 v[240:241], v170 offset:32768
  ds_read_b64_tr_b16 v[242:243], v170 offset:33280
  v_mfma_f32_16x16x32_bf16 v[132:135], v[220:223], a[132:135], v[132:135]
  ds_read_b64_tr_b16 v[244:245], v171 offset:24576
  v_add_u32 v170, 0, v174
  v_mfma_f32_16x16x32_bf16 v[132:135], v[224:227], a[136:139], v[132:135]
  s_add_u32 m0, s22, 98304
  ds_read_b64_tr_b16 v[246:247], v171 offset:25088
  v_mfma_f32_16x16x32_bf16 v[132:135], v[228:231], a[140:143], v[132:135]
  buffer_load_dwordx4 v180, s[12:15], s23 offen lds
  v_mfma_f32_16x16x32_bf16 v[128:131], v[228:231], a[68:71], v[128:131]
  s_add_u32 s23, s23, 294912
  ds_read_b64_tr_b16 v[248:249], v171 offset:28672
  v_mul_f32 v120, v188, v120
  v_mfma_f32_16x16x32_bf16 v[128:131], v[224:227], a[64:67], v[128:131]
  ds_read_b64_tr_b16 v[250:251], v171 offset:29184
  v_mul_f32 v121, v189, v121
  v_mfma_f32_16x16x32_bf16 v[128:131], v[220:223], a[60:63], v[128:131]
  s_waitcnt lgkmcnt(4)
  ds_read_b64_tr_b16 v[252:253], v171 offset:32768
  ds_read_b64_tr_b16 v[254:255], v171 offset:33280
  v_mfma_f32_16x16x32_bf16 v[136:139], v[232:235], a[60:63], v[136:139]
  ds_read_b64_tr_b16 v[220:221], v168 offset:0
  v_add_u32 v171, 0, v175
  v_mfma_f32_16x16x32_bf16 v[136:139], v[236:239], a[64:67], v[136:139]
  s_add_u32 m0, s22, 102400
  ds_read_b64_tr_b16 v[222:223], v168 offset:512
  v_mul_f32 v122, v190, v122
  v_mfma_f32_16x16x32_bf16 v[136:139], v[240:243], a[68:71], v[136:139]
  buffer_load_dwordx4 v180, s[12:15], s23 offen lds
  v_mfma_f32_16x16x32_bf16 v[140:143], v[240:243], a[140:143], v[140:143]
  s_add_u32 s23, s23, 294912
  ds_read_b64_tr_b16 v[224:225], v168 offset:4096
  v_mul_f32 v123, v191, v123
  v_mfma_f32_16x16x32_bf16 v[140:143], v[236:239], a[136:139], v[140:143]
  ds_read_b64_tr_b16 v[226:227], v168 offset:4608
  v_mul_f32 v124, v192, v124
  v_mfma_f32_16x16x32_bf16 v[140:143], v[232:235], a[132:135], v[140:143]
  s_waitcnt lgkmcnt(4)
  ds_read_b64_tr_b16 v[228:229], v168 offset:8192
  ds_read_b64_tr_b16 v[230:231], v168 offset:8704
  v_mfma_f32_16x16x32_bf16 v[148:151], v[244:247], a[132:135], v[148:151]
  ds_read_b64_tr_b16 v[232:233], v169 offset:0
  v_mul_f32 v125, v193, v125
  v_mfma_f32_16x16x32_bf16 v[148:151], v[248:251], a[136:139], v[148:151]
  s_add_u32 m0, s22, 106496
  ds_read_b64_tr_b16 v[234:235], v169 offset:512
  v_mul_f32 v126, v194, v126
  v_mfma_f32_16x16x32_bf16 v[148:151], v[252:255], a[140:143], v[148:151]
  buffer_load_dwordx4 v180, s[12:15], s23 offen lds
  v_mfma_f32_16x16x32_bf16 v[144:147], v[252:255], a[68:71], v[144:147]
  s_add_u32 s23, s23, 294912
  ds_read_b64_tr_b16 v[236:237], v169 offset:4096
  v_mul_f32 v127, v195, v127
  v_mfma_f32_16x16x32_bf16 v[144:147], v[248:251], a[64:67], v[144:147]
  ds_read_b64_tr_b16 v[238:239], v169 offset:4608
  v_cvt_pk_bf16_f32 v32, v120, v121
  v_mfma_f32_16x16x32_bf16 v[144:147], v[244:247], a[60:63], v[144:147]
  s_waitcnt lgkmcnt(4)
  ds_read_b64_tr_b16 v[240:241], v169 offset:8192
  ds_read_b64_tr_b16 v[242:243], v169 offset:8704
  v_mfma_f32_16x16x32_bf16 v[88:91], v[220:223], a[0:3], 0
  ds_read_b64_tr_b16 v[244:245], v170 offset:0
  v_cvt_pk_bf16_f32 v33, v122, v123
  v_mfma_f32_16x16x32_bf16 v[88:91], v[224:227], a[4:7], v[88:91]
  s_waitcnt vmcnt(17)
  ds_read_b64_tr_b16 v[246:247], v170 offset:512
  v_cvt_pk_bf16_f32 v36, v124, v125
  v_mfma_f32_16x16x32_bf16 v[88:91], v[228:231], a[8:11], v[88:91]
  s_barrier
  v_mfma_f32_16x16x32_bf16 v[92:95], v[228:231], a[80:83], 0
  ds_read_b64_tr_b16 v[248:249], v170 offset:4096
  v_cvt_pk_bf16_f32 v37, v126, v127
  v_mfma_f32_16x16x32_bf16 v[92:95], v[224:227], a[76:79], v[92:95]
  ds_read_b64_tr_b16 v[250:251], v170 offset:4608
  v_mul_f32 v128, v196, v128
  v_mfma_f32_16x16x32_bf16 v[92:95], v[220:223], a[72:75], v[92:95]
  s_waitcnt lgkmcnt(4)
  ds_read_b64_tr_b16 v[252:253], v170 offset:8192
  ds_read_b64_tr_b16 v[254:255], v170 offset:8704
  v_mfma_f32_16x16x32_bf16 v[100:103], v[232:235], a[72:75], 0
  ds_read_b64_tr_b16 v[220:221], v171 offset:0
  v_mul_f32 v129, v197, v129
  v_mfma_f32_16x16x32_bf16 v[100:103], v[236:239], a[76:79], v[100:103]
  s_add_u32 m0, s22, 110592
  ds_read_b64_tr_b16 v[222:223], v171 offset:512
  v_mul_f32 v130, v198, v130
  v_mfma_f32_16x16x32_bf16 v[100:103], v[240:243], a[80:83], v[100:103]
  buffer_load_dwordx4 v180, s[12:15], s23 offen lds
  v_mfma_f32_16x16x32_bf16 v[96:99], v[240:243], a[8:11], 0
  s_add_u32 s23, s23, 294912
  ds_read_b64_tr_b16 v[224:225], v171 offset:4096
  v_mul_f32 v131, v199, v131
  v_mfma_f32_16x16x32_bf16 v[96:99], v[236:239], a[4:7], v[96:99]
  ds_read_b64_tr_b16 v[226:227], v171 offset:4608
  v_mul_f32 v132, v200, v132
  v_mfma_f32_16x16x32_bf16 v[96:99], v[232:235], a[0:3], v[96:99]
  s_waitcnt lgkmcnt(4)
  ds_read_b64_tr_b16 v[228:229], v171 offset:8192
  ds_read_b64_tr_b16 v[230:231], v171 offset:8704
  v_mfma_f32_16x16x32_bf16 v[104:107], v[244:247], a[0:3], 0
  ds_read_b64_tr_b16 v[232:233], v168 offset:12288
  v_mul_f32 v133, v201, v133
  v_mfma_f32_16x16x32_bf16 v[104:107], v[248:251], a[4:7], v[104:107]
  s_add_u32 m0, s22, 114688
  ds_read_b64_tr_b16 v[234:235], v168 offset:12800
  v_mul_f32 v134, v202, v134
  v_mfma_f32_16x16x32_bf16 v[104:107], v[252:255], a[8:11], v[104:107]
  buffer_load_dwordx4 v180, s[12:15], s23 offen lds
  v_mfma_f32_16x16x32_bf16 v[108:111], v[252:255], a[80:83], 0
  s_add_u32 s23, s23, 294912
  ds_read_b64_tr_b16 v[236:237], v168 offset:16384
  v_mul_f32 v135, v203, v135
  v_mfma_f32_16x16x32_bf16 v[108:111], v[248:251], a[76:79], v[108:111]
  ds_read_b64_tr_b16 v[238:239], v168 offset:16896
  v_cvt_pk_bf16_f32 v34, v128, v129
  v_mfma_f32_16x16x32_bf16 v[108:111], v[244:247], a[72:75], v[108:111]
  s_waitcnt lgkmcnt(4)
  ds_read_b64_tr_b16 v[240:241], v168 offset:20480
  ds_read_b64_tr_b16 v[242:243], v168 offset:20992
  v_mfma_f32_16x16x32_bf16 v[116:119], v[220:223], a[72:75], 0
  ds_read_b64_tr_b16 v[244:245], v169 offset:12288
  v_cvt_pk_bf16_f32 v35, v130, v131
  v_mfma_f32_16x16x32_bf16 v[116:119], v[224:227], a[76:79], v[116:119]
  s_add_u32 m0, s22, 118784
  ds_read_b64_tr_b16 v[246:247], v169 offset:12800
  v_cvt_pk_bf16_f32 v38, v132, v133
  v_mfma_f32_16x16x32_bf16 v[116:119], v[228:231], a[80:83], v[116:119]
  buffer_load_dwordx4 v180, s[12:15], s23 offen lds
  v_mfma_f32_16x16x32_bf16 v[112:115], v[228:231], a[8:11], 0
  s_add_u32 s23, s23, 294912
  ds_read_b64_tr_b16 v[248:249], v169 offset:16384
  v_cvt_pk_bf16_f32 v39, v134, v135
  v_mfma_f32_16x16x32_bf16 v[112:115], v[224:227], a[4:7], v[112:115]
  ds_read_b64_tr_b16 v[250:251], v169 offset:16896
  v_mul_f32 v136, v204, v136
  v_mfma_f32_16x16x32_bf16 v[112:115], v[220:223], a[0:3], v[112:115]
  s_waitcnt lgkmcnt(4)
  ds_read_b64_tr_b16 v[252:253], v169 offset:20480
  ds_read_b64_tr_b16 v[254:255], v169 offset:20992
  v_mfma_f32_16x16x32_bf16 v[88:91], v[232:235], a[12:15], v[88:91]
  s_waitcnt vmcnt(6)
  ds_read_b64_tr_b16 v[220:221], v170 offset:12288
  v_mul_f32 v137, v205, v137
  v_mfma_f32_16x16x32_bf16 v[88:91], v[236:239], a[16:19], v[88:91]
  ds_read_b64_tr_b16 v[222:223], v170 offset:12800
  v_readfirstlane_b32 s53, v15
  v_mfma_f32_16x16x32_bf16 v[88:91], v[240:243], a[20:23], v[88:91]
  v_mfma_f32_16x16x32_bf16 v[92:95], v[240:243], a[92:95], v[92:95]
  s_cmp_eq_u32 s53, 1
  s_cbranch_scc0 KB_SLOW0
KB_RES0:
  ds_read_b64_tr_b16 v[224:225], v170 offset:16384
  v_mfma_f32_16x16x32_bf16 v[92:95], v[236:239], a[88:91], v[92:95]
  ds_read_b64_tr_b16 v[226:227], v170 offset:16896
  v_mul_f32 v138, v206, v138
  v_mfma_f32_16x16x32_bf16 v[92:95], v[232:235], a[84:87], v[92:95]
  s_waitcnt lgkmcnt(4)
  ds_read_b64_tr_b16 v[228:229], v170 offset:20480
  ds_read_b64_tr_b16 v[230:231], v170 offset:20992
  v_mfma_f32_16x16x32_bf16 v[100:103], v[244:247], a[84:87], v[100:103]
  s_nop 0
  ds_read_b64_tr_b16 v[232:233], v171 offset:12288
  ds_read_b64_tr_b16 v[234:235], v171 offset:12800
  v_mfma_f32_16x16x32_bf16 v[100:103], v[248:251], a[88:91], v[100:103]
  s_add_u32 m0, s22, 122880
  ds_read_b64_tr_b16 v[236:237], v171 offset:16384
  v_mul_f32 v139, v207, v139
  v_mfma_f32_16x16x32_bf16 v[100:103], v[252:255], a[92:95], v[100:103]
  buffer_load_dwordx4 v180, s[12:15], s23 offen lds
  v_mfma_f32_16x16x32_bf16 v[96:99], v[252:255], a[20:23], v[96:99]
  s_add_u32 s23, s23, 294912
  ds_read_b64_tr_b16 v[238:239], v171 offset:16896
  v_mul_f32 v140, v208, v140
  v_mfma_f32_16x16x32_bf16 v[96:99], v[248:251], a[16:19], v[96:99]
  buffer_load_dwordx4 a[144:147], v185, s[48:51], s32 offen offset:0 sc1
  v_mfma_f32_16x16x32_bf16 v[96:99], v[244:247], a[12:15], v[96:99]
  s_waitcnt lgkmcnt(4)
  ds_read_b64_tr_b16 v[240:241], v171 offset:20480
  ds_read_b64_tr_b16 v[242:243], v171 offset:20992
  v_mfma_f32_16x16x32_bf16 v[104:107], v[220:223], a[12:15], v[104:107]
  s_nop 0
  ds_read_b64_tr_b16 v[244:245], v168 offset:24576
  ds_read_b64_tr_b16 v[246:247], v168 offset:25088
  v_mfma_f32_16x16x32_bf16 v[104:107], v[224:227], a[16:19], v[104:107]
  s_add_u32 m0, s22, 126976
  ds_read_b64_tr_b16 v[248:249], v168 offset:28672
  v_mul_f32 v141, v209, v141
  v_mfma_f32_16x16x32_bf16 v[104:107], v[228:231], a[20:23], v[104:107]
  buffer_load_dwordx4 v180, s[12:15], s23 offen lds
  v_mfma_f32_16x16x32_bf16 v[108:111], v[228:231], a[92:95], v[108:111]
  s_add_u32 s23, s23, 294912
  ds_read_b64_tr_b16 v[250:251], v168 offset:29184
  v_mul_f32 v142, v210, v142
  v_mfma_f32_16x16x32_bf16 v[108:111], v[224:227], a[88:91], v[108:111]
  buffer_load_dwordx4 a[148:151], v185, s[48:51], s32 offen offset:1024 sc1
  v_mfma_f32_16x16x32_bf16 v[108:111], v[220:223], a[84:87], v[108:111]
  s_waitcnt lgkmcnt(4)
  ds_read_b64_tr_b16 v[252:253], v168 offset:32768
  ds_read_b64_tr_b16 v[254:255], v168 offset:33280
  v_mfma_f32_16x16x32_bf16 v[116:119], v[232:235], a[84:87], v[116:119]
  ds_read_b64_tr_b16 v[220:221], v169 offset:24576
  v_add_u32 v168, 36864, v172
  v_mfma_f32_16x16x32_bf16 v[116:119], v[236:239], a[88:91], v[116:119]
  s_add_u32 m0, s22, 131072
  ds_read_b64_tr_b16 v[222:223], v169 offset:25088
  v_mul_f32 v143, v211, v143
  v_mfma_f32_16x16x32_bf16 v[116:119], v[240:243], a[92:95], v[116:119]
  buffer_load_dwordx4 v180, s[12:15], s23 offen lds
  v_mfma_f32_16x16x32_bf16 v[112:115], v[240:243], a[20:23], v[112:115]
  s_add_u32 s23, s23, 294912
  ds_read_b64_tr_b16 v[224:225], v169 offset:28672
  v_cvt_pk_bf16_f32 v40, v136, v137
  v_mfma_f32_16x16x32_bf16 v[112:115], v[236:239], a[16:19], v[112:115]
  ds_read_b64_tr_b16 v[226:227], v169 offset:29184
  v_cvt_pk_bf16_f32 v41, v138, v139
  v_mfma_f32_16x16x32_bf16 v[112:115], v[232:235], a[12:15], v[112:115]
  s_waitcnt lgkmcnt(4)
  ds_read_b64_tr_b16 v[228:229], v169 offset:32768
  ds_read_b64_tr_b16 v[230:231], v169 offset:33280
  v_mfma_f32_16x16x32_bf16 v[88:91], v[244:247], a[24:27], v[88:91]
  ds_read_b64_tr_b16 v[232:233], v170 offset:24576
  v_add_u32 v169, 36864, v173
  v_mfma_f32_16x16x32_bf16 v[88:91], v[248:251], a[28:31], v[88:91]
  ds_read_b64_tr_b16 v[234:235], v170 offset:25088
  v_cvt_pk_bf16_f32 v44, v140, v141
  v_mfma_f32_16x16x32_bf16 v[88:91], v[252:255], a[32:35], v[88:91]
  buffer_load_dwordx4 a[152:155], v185, s[48:51], s32 offen offset:2048 sc1
  v_mfma_f32_16x16x32_bf16 v[92:95], v[252:255], a[104:107], v[92:95]
  ds_read_b64_tr_b16 v[236:237], v170 offset:28672
  v_cvt_pk_bf16_f32 v45, v142, v143
  v_mfma_f32_16x16x32_bf16 v[92:95], v[248:251], a[100:103], v[92:95]
  ds_read_b64_tr_b16 v[238:239], v170 offset:29184
  v_mul_f32 v144, v212, v144
  v_mfma_f32_16x16x32_bf16 v[92:95], v[244:247], a[96:99], v[92:95]
  s_waitcnt lgkmcnt(4)
  ds_read_b64_tr_b16 v[240:241], v170 offset:32768
  ds_read_b64_tr_b16 v[242:243], v170 offset:33280
  v_mfma_f32_16x16x32_bf16 v[100:103], v[220:223], a[96:99], v[100:103]
  s_nop 0
  ds_read_b64_tr_b16 v[244:245], v171 offset:24576
  ds_read_b64_tr_b16 v[246:247], v171 offset:25088
  v_mfma_f32_16x16x32_bf16 v[100:103], v[224:227], a[100:103], v[100:103]
  s_add_u32 m0, s22, 135168
  ds_read_b64_tr_b16 v[248:249], v171 offset:28672
  v_add_u32 v170, 36864, v174
  v_mfma_f32_16x16x32_bf16 v[100:103], v[228:231], a[104:107], v[100:103]
  buffer_load_dwordx4 v180, s[12:15], s23 offen lds
  v_mfma_f32_16x16x32_bf16 v[96:99], v[228:231], a[32:35], v[96:99]
  s_add_u32 s23, s23, 294912
  ds_read_b64_tr_b16 v[250:251], v171 offset:29184
  v_mul_f32 v145, v213, v145
  v_mfma_f32_16x16x32_bf16 v[96:99], v[224:227], a[28:31], v[96:99]
  buffer_load_dwordx4 a[156:159], v185, s[48:51], s32 offen offset:3072 sc1
  v_mfma_f32_16x16x32_bf16 v[96:99], v[220:223], a[24:27], v[96:99]
  s_waitcnt lgkmcnt(4)
  ds_read_b64_tr_b16 v[252:253], v171 offset:32768
  ds_read_b64_tr_b16 v[254:255], v171 offset:33280
  v_mfma_f32_16x16x32_bf16 v[104:107], v[232:235], a[24:27], v[104:107]
  s_add_u32 s32, s32, 4096
  ds_read_b64_tr_b16 v[220:221], v168 offset:0
  v_add_u32 v171, 36864, v175
  v_mfma_f32_16x16x32_bf16 v[104:107], v[236:239], a[28:31], v[104:107]
  s_add_u32 m0, s22, 139264
  ds_read_b64_tr_b16 v[222:223], v168 offset:512
  v_mul_f32 v146, v214, v146
  v_mfma_f32_16x16x32_bf16 v[104:107], v[240:243], a[32:35], v[104:107]
  buffer_load_dwordx4 v180, s[12:15], s23 offen lds
  v_mfma_f32_16x16x32_bf16 v[108:111], v[240:243], a[104:107], v[108:111]
  s_add_u32 s23, s23, 294912
  ds_read_b64_tr_b16 v[224:225], v168 offset:4096
  v_mul_f32 v147, v215, v147
  v_mfma_f32_16x16x32_bf16 v[108:111], v[236:239], a[100:103], v[108:111]
  ds_read_b64_tr_b16 v[226:227], v168 offset:4608
  v_mul_f32 v148, v216, v148
  v_mfma_f32_16x16x32_bf16 v[108:111], v[232:235], a[96:99], v[108:111]
  s_waitcnt lgkmcnt(4)
  ds_read_b64_tr_b16 v[228:229], v168 offset:8192
  ds_read_b64_tr_b16 v[230:231], v168 offset:8704
  v_mfma_f32_16x16x32_bf16 v[116:119], v[244:247], a[96:99], v[116:119]
  ds_read_b64_tr_b16 v[232:233], v169 offset:0
  v_mul_f32 v149, v217, v149
  v_mfma_f32_16x16x32_bf16 v[116:119], v[248:251], a[100:103], v[116:119]
  s_add_u32 m0, s22, 143360
  ds_read_b64_tr_b16 v[234:235], v169 offset:512
  v_mul_f32 v150, v218, v150
  v_mfma_f32_16x16x32_bf16 v[116:119], v[252:255], a[104:107], v[116:119]
  buffer_load_dwordx4 v180, s[12:15], s23 offen lds
  v_mfma_f32_16x16x32_bf16 v[112:115], v[252:255], a[32:35], v[112:115]
  ds_read_b64_tr_b16 v[236:237], v169 offset:4096
  v_mul_f32 v151, v219, v151
  v_mfma_f32_16x16x32_bf16 v[112:115], v[248:251], a[28:31], v[112:115]
  ds_read_b64_tr_b16 v[238:239], v169 offset:4608
  v_cvt_pk_bf16_f32 v42, v144, v145
  v_mfma_f32_16x16x32_bf16 v[112:115], v[244:247], a[24:27], v[112:115]
  s_waitcnt lgkmcnt(4)
  ds_read_b64_tr_b16 v[240:241], v169 offset:8192
  ds_read_b64_tr_b16 v[242:243], v169 offset:8704
  v_mfma_f32_16x16x32_bf16 v[88:91], v[220:223], a[36:39], v[88:91]
  ds_read_b64_tr_b16 v[244:245], v170 offset:0
  v_cvt_pk_bf16_f32 v43, v146, v147
  v_mfma_f32_16x16x32_bf16 v[88:91], v[224:227], a[40:43], v[88:91]
  s_waitcnt vmcnt(20)
  ds_read_b64_tr_b16 v[246:247], v170 offset:512
  v_cvt_pk_bf16_f32 v46, v148, v149
  v_mfma_f32_16x16x32_bf16 v[88:91], v[228:231], a[44:47], v[88:91]
  s_barrier
  v_mfma_f32_16x16x32_bf16 v[92:95], v[228:231], a[116:119], v[92:95]
  ds_read_b64_tr_b16 v[248:249], v170 offset:4096
  v_cvt_pk_bf16_f32 v47, v150, v151
  v_mfma_f32_16x16x32_bf16 v[92:95], v[224:227], a[112:115], v[92:95]
  ds_read_b64_tr_b16 v[250:251], v170 offset:4608
  v_mfma_f32_16x16x32_bf16 v[92:95], v[220:223], a[108:111], v[92:95]
  s_waitcnt lgkmcnt(4)
  ds_read_b64_tr_b16 v[252:253], v170 offset:8192
  ds_read_b64_tr_b16 v[254:255], v170 offset:8704
  v_mfma_f32_16x16x32_bf16 v[100:103], v[232:235], a[108:111], v[100:103]
  s_add_u32 s23, s24, 384
  ds_read_b64_tr_b16 v[220:221], v171 offset:0
  v_mfma_f32_16x16x32_bf16 v[100:103], v[236:239], a[112:115], v[100:103]
  s_add_u32 m0, s22, 0
  ds_read_b64_tr_b16 v[222:223], v171 offset:512
  v_mfma_f32_16x16x32_bf16 v[100:103], v[240:243], a[116:119], v[100:103]
  buffer_load_dwordx4 v180, s[8:11], s23 offen lds
  v_mfma_f32_16x16x32_bf16 v[96:99], v[240:243], a[44:47], v[96:99]
  s_add_u32 s23, s23, 294912
  ds_read_b64_tr_b16 v[224:225], v171 offset:4096
  v_mfma_f32_16x16x32_bf16 v[96:99], v[236:239], a[40:43], v[96:99]
  ds_read_b64_tr_b16 v[226:227], v171 offset:4608
  v_mfma_f32_16x16x32_bf16 v[96:99], v[232:235], a[36:39], v[96:99]
  s_waitcnt lgkmcnt(4)
  ds_read_b64_tr_b16 v[228:229], v171 offset:8192
  ds_read_b64_tr_b16 v[230:231], v171 offset:8704
  v_mfma_f32_16x16x32_bf16 v[104:107], v[244:247], a[36:39], v[104:107]
  ds_read_b64_tr_b16 v[232:233], v168 offset:12288
  v_mfma_f32_16x16x32_bf16 v[104:107], v[248:251], a[40:43], v[104:107]
  s_add_u32 m0, s22, 4096
  ds_read_b64_tr_b16 v[234:235], v168 offset:12800
  v_mfma_f32_16x16x32_bf16 v[104:107], v[252:255], a[44:47], v[104:107]
  buffer_load_dwordx4 v180, s[8:11], s23 offen lds
  v_mfma_f32_16x16x32_bf16 v[108:111], v[252:255], a[116:119], v[108:111]
  s_add_u32 s23, s23, 294912
  ds_read_b64_tr_b16 v[236:237], v168 offset:16384
  v_mfma_f32_16x16x32_bf16 v[108:111], v[248:251], a[112:115], v[108:111]
  ds_read_b64_tr_b16 v[238:239], v168 offset:16896
  v_mfma_f32_16x16x32_bf16 v[108:111], v[244:247], a[108:111], v[108:111]
  s_waitcnt lgkmcnt(4)
  ds_read_b64_tr_b16 v[240:241], v168 offset:20480
  ds_read_b64_tr_b16 v[242:243], v168 offset:20992
  v_mfma_f32_16x16x32_bf16 v[116:119], v[220:223], a[108:111], v[116:119]
  ds_read_b64_tr_b16 v[244:245], v169 offset:12288
  v_mfma_f32_16x16x32_bf16 v[116:119], v[224:227], a[112:115], v[116:119]
  s_add_u32 m0, s22, 8192
  ds_read_b64_tr_b16 v[246:247], v169 offset:12800
  v_mfma_f32_16x16x32_bf16 v[116:119], v[228:231], a[116:119], v[116:119]
  buffer_load_dwordx4 v180, s[8:11], s23 offen lds
  v_mfma_f32_16x16x32_bf16 v[112:115], v[228:231], a[44:47], v[112:115]
  s_add_u32 s23, s23, 294912
  ds_read_b64_tr_b16 v[248:249], v169 offset:16384
  v_mfma_f32_16x16x32_bf16 v[112:115], v[224:227], a[40:43], v[112:115]
  ds_read_b64_tr_b16 v[250:251], v169 offset:16896
  v_mfma_f32_16x16x32_bf16 v[112:115], v[220:223], a[36:39], v[112:115]
  s_waitcnt lgkmcnt(4)
  ds_read_b64_tr_b16 v[252:253], v169 offset:20480
  ds_read_b64_tr_b16 v[254:255], v169 offset:20992
  v_mfma_f32_16x16x32_bf16 v[88:91], v[232:235], a[48:51], v[88:91]
  ds_read_b64_tr_b16 v[220:221], v170 offset:12288
  v_mfma_f32_16x16x32_bf16 v[88:91], v[236:239], a[52:55], v[88:91]
  ds_read_b64_tr_b16 v[222:223], v170 offset:12800
  v_mfma_f32_16x16x32_bf16 v[88:91], v[240:243], a[56:59], v[88:91]
  buffer_store_dwordx4 v[32:35], v185, s[48:51], s31 offen offset:0 sc1
  v_mfma_f32_16x16x32_bf16 v[92:95], v[240:243], a[128:131], v[92:95]
  ds_read_b64_tr_b16 v[224:225], v170 offset:16384
  v_mfma_f32_16x16x32_bf16 v[92:95], v[236:239], a[124:127], v[92:95]
  ds_read_b64_tr_b16 v[226:227], v170 offset:16896
  v_mfma_f32_16x16x32_bf16 v[92:95], v[232:235], a[120:123], v[92:95]
  s_waitcnt lgkmcnt(4)
  ds_read_b64_tr_b16 v[228:229], v170 offset:20480
  ds_read_b64_tr_b16 v[230:231], v170 offset:20992
  v_mfma_f32_16x16x32_bf16 v[100:103], v[244:247], a[120:123], v[100:103]
  s_nop 0
  ds_read_b64_tr_b16 v[232:233], v171 offset:12288
  ds_read_b64_tr_b16 v[234:235], v171 offset:12800
  v_mfma_f32_16x16x32_bf16 v[100:103], v[248:251], a[124:127], v[100:103]
  s_add_u32 m0, s22, 12288
  ds_read_b64_tr_b16 v[236:237], v171 offset:16384
  v_mfma_f32_16x16x32_bf16 v[100:103], v[252:255], a[128:131], v[100:103]
  buffer_load_dwordx4 v180, s[8:11], s23 offen lds
  v_mfma_f32_16x16x32_bf16 v[96:99], v[252:255], a[56:59], v[96:99]
  s_add_u32 s23, s23, 294912
  ds_read_b64_tr_b16 v[238:239], v171 offset:16896
  v_mfma_f32_16x16x32_bf16 v[96:99], v[248:251], a[52:55], v[96:99]
  buffer_store_dwordx4 v[36:39], v185, s[48:51], s31 offen offset:1024 sc1
  v_mfma_f32_16x16x32_bf16 v[96:99], v[244:247], a[48:51], v[96:99]
  s_waitcnt lgkmcnt(4)
  ds_read_b64_tr_b16 v[240:241], v171 offset:20480
  ds_read_b64_tr_b16 v[242:243], v171 offset:20992
  v_mfma_f32_16x16x32_bf16 v[104:107], v[220:223], a[48:51], v[104:107]
  s_nop 0
  ds_read_b64_tr_b16 v[244:245], v168 offset:24576
  ds_read_b64_tr_b16 v[246:247], v168 offset:25088
  v_mfma_f32_16x16x32_bf16 v[104:107], v[224:227], a[52:55], v[104:107]
  s_add_u32 m0, s22, 16384
  ds_read_b64_tr_b16 v[248:249], v168 offset:28672
  v_mfma_f32_16x16x32_bf16 v[104:107], v[228:231], a[56:59], v[104:107]
  buffer_load_dwordx4 v180, s[8:11], s23 offen lds
  v_mfma_f32_16x16x32_bf16 v[108:111], v[228:231], a[128:131], v[108:111]
  s_add_u32 s23, s23, 294912
  ds_read_b64_tr_b16 v[250:251], v168 offset:29184
  v_mfma_f32_16x16x32_bf16 v[108:111], v[224:227], a[124:127], v[108:111]
  buffer_store_dwordx4 v[40:43], v185, s[48:51], s31 offen offset:2048 sc1
  v_mfma_f32_16x16x32_bf16 v[108:111], v[220:223], a[120:123], v[108:111]
  s_waitcnt lgkmcnt(4)
  ds_read_b64_tr_b16 v[252:253], v168 offset:32768
  ds_read_b64_tr_b16 v[254:255], v168 offset:33280
  v_mfma_f32_16x16x32_bf16 v[116:119], v[232:235], a[120:123], v[116:119]
  ds_read_b64_tr_b16 v[220:221], v169 offset:24576
  v_add_u32 v168, 73728, v172
  v_mfma_f32_16x16x32_bf16 v[116:119], v[236:239], a[124:127], v[116:119]
  s_add_u32 m0, s22, 20480
  ds_read_b64_tr_b16 v[222:223], v169 offset:25088
  v_mfma_f32_16x16x32_bf16 v[116:119], v[240:243], a[128:131], v[116:119]
  buffer_load_dwordx4 v180, s[8:11], s23 offen lds
  v_mfma_f32_16x16x32_bf16 v[112:115], v[240:243], a[56:59], v[112:115]
  s_add_u32 s23, s23, 294912
  ds_read_b64_tr_b16 v[224:225], v169 offset:28672
  v_mfma_f32_16x16x32_bf16 v[112:115], v[236:239], a[52:55], v[112:115]
  ds_read_b64_tr_b16 v[226:227], v169 offset:29184
  v_mfma_f32_16x16x32_bf16 v[112:115], v[232:235], a[48:51], v[112:115]
  s_waitcnt lgkmcnt(4)
  ds_read_b64_tr_b16 v[228:229], v169 offset:32768
  ds_read_b64_tr_b16 v[230:231], v169 offset:33280
  v_mfma_f32_16x16x32_bf16 v[88:91], v[244:247], a[60:63], v[88:91]
  ds_read_b64_tr_b16 v[232:233], v170 offset:24576
  v_add_u32 v169, 73728, v173
  v_mfma_f32_16x16x32_bf16 v[88:91], v[248:251], a[64:67], v[88:91]
  ds_read_b64_tr_b16 v[234:235], v170 offset:25088
  v_mfma_f32_16x16x32_bf16 v[88:91], v[252:255], a[68:71], v[88:91]
  buffer_store_dwordx4 v[44:47], v185, s[48:51], s31 offen offset:3072 sc1
  v_mfma_f32_16x16x32_bf16 v[92:95], v[252:255], a[140:143], v[92:95]
  s_add_u32 s31, s31, 4096
  ds_read_b64_tr_b16 v[236:237], v170 offset:28672
  v_mfma_f32_16x16x32_bf16 v[92:95], v[248:251], a[136:139], v[92:95]
  ds_read_b64_tr_b16 v[238:239], v170 offset:29184
  v_mfma_f32_16x16x32_bf16 v[92:95], v[244:247], a[132:135], v[92:95]
  s_waitcnt lgkmcnt(4)
  ds_read_b64_tr_b16 v[240:241], v170 offset:32768
  ds_read_b64_tr_b16 v[242:243], v170 offset:33280
  v_mfma_f32_16x16x32_bf16 v[100:103], v[220:223], a[132:135], v[100:103]
  ds_read_b64_tr_b16 v[244:245], v171 offset:24576
  v_add_u32 v170, 73728, v174
  v_mfma_f32_16x16x32_bf16 v[100:103], v[224:227], a[136:139], v[100:103]
  s_add_u32 m0, s22, 24576
  ds_read_b64_tr_b16 v[246:247], v171 offset:25088
  v_mfma_f32_16x16x32_bf16 v[100:103], v[228:231], a[140:143], v[100:103]
  buffer_load_dwordx4 v180, s[8:11], s23 offen lds
  v_mfma_f32_16x16x32_bf16 v[96:99], v[228:231], a[68:71], v[96:99]
  s_add_u32 s23, s23, 294912
  ds_read_b64_tr_b16 v[248:249], v171 offset:28672
  v_max_f32 v188, 0, v88
  v_mfma_f32_16x16x32_bf16 v[96:99], v[224:227], a[64:67], v[96:99]
  ds_read_b64_tr_b16 v[250:251], v171 offset:29184
  v_max_f32 v189, 0, v89
  v_mfma_f32_16x16x32_bf16 v[96:99], v[220:223], a[60:63], v[96:99]
  s_waitcnt lgkmcnt(4)
  ds_read_b64_tr_b16 v[252:253], v171 offset:32768
  ds_read_b64_tr_b16 v[254:255], v171 offset:33280
  v_mfma_f32_16x16x32_bf16 v[104:107], v[232:235], a[60:63], v[104:107]
  ds_read_b64_tr_b16 v[220:221], v168 offset:0
  v_add_u32 v171, 73728, v175
  v_mfma_f32_16x16x32_bf16 v[104:107], v[236:239], a[64:67], v[104:107]
  s_add_u32 m0, s22, 28672
  ds_read_b64_tr_b16 v[222:223], v168 offset:512
  v_max_f32 v190, 0, v90
  v_mfma_f32_16x16x32_bf16 v[104:107], v[240:243], a[68:71], v[104:107]
  buffer_load_dwordx4 v180, s[8:11], s23 offen lds
  v_mfma_f32_16x16x32_bf16 v[108:111], v[240:243], a[140:143], v[108:111]
  s_add_u32 s23, s23, 294912
  ds_read_b64_tr_b16 v[224:225], v168 offset:4096
  v_max_f32 v191, 0, v91
  v_mfma_f32_16x16x32_bf16 v[108:111], v[236:239], a[136:139], v[108:111]
  ds_read_b64_tr_b16 v[226:227], v168 offset:4608
  v_max_f32 v192, 0, v92
  v_mfma_f32_16x16x32_bf16 v[108:111], v[232:235], a[132:135], v[108:111]
  s_waitcnt lgkmcnt(4)
  ds_read_b64_tr_b16 v[228:229], v168 offset:8192
  ds_read_b64_tr_b16 v[230:231], v168 offset:8704
  v_mfma_f32_16x16x32_bf16 v[116:119], v[244:247], a[132:135], v[116:119]
  ds_read_b64_tr_b16 v[232:233], v169 offset:0
  v_max_f32 v193, 0, v93
  v_mfma_f32_16x16x32_bf16 v[116:119], v[248:251], a[136:139], v[116:119]
  s_add_u32 m0, s22, 32768
  ds_read_b64_tr_b16 v[234:235], v169 offset:512
  v_max_f32 v194, 0, v94
  v_mfma_f32_16x16x32_bf16 v[116:119], v[252:255], a[140:143], v[116:119]
  buffer_load_dwordx4 v180, s[8:11], s23 offen lds
  v_mfma_f32_16x16x32_bf16 v[112:115], v[252:255], a[68:71], v[112:115]
  s_add_u32 s23, s23, 294912
  ds_read_b64_tr_b16 v[236:237], v169 offset:4096
  v_max_f32 v195, 0, v95
  v_mfma_f32_16x16x32_bf16 v[112:115], v[248:251], a[64:67], v[112:115]
  ds_read_b64_tr_b16 v[238:239], v169 offset:4608
  v_max_f32 v196, 0, v96
  v_mfma_f32_16x16x32_bf16 v[112:115], v[244:247], a[60:63], v[112:115]
  s_waitcnt lgkmcnt(4)
  ds_read_b64_tr_b16 v[240:241], v169 offset:8192
  ds_read_b64_tr_b16 v[242:243], v169 offset:8704
  v_mfma_f32_16x16x32_bf16 v[120:123], v[220:223], a[0:3], 0
  ds_read_b64_tr_b16 v[244:245], v170 offset:0
  v_max_f32 v197, 0, v97
  v_mfma_f32_16x16x32_bf16 v[120:123], v[224:227], a[4:7], v[120:123]
  s_waitcnt vmcnt(23)
  ds_read_b64_tr_b16 v[246:247], v170 offset:512
  v_max_f32 v198, 0, v98
  v_mfma_f32_16x16x32_bf16 v[120:123], v[228:231], a[8:11], v[120:123]
  s_barrier
  v_mfma_f32_16x16x32_bf16 v[124:127], v[228:231], a[80:83], 0
  ds_read_b64_tr_b16 v[248:249], v170 offset:4096
  v_max_f32 v199, 0, v99
  v_mfma_f32_16x16x32_bf16 v[124:127], v[224:227], a[76:79], v[124:127]
KB_I4:
  s_cbranch_execz KB_I7
  ds_read_b64_tr_b16 v[250:251], v170 offset:4608
  v_max_f32 v200, 0, v100
  v_mfma_f32_16x16x32_bf16 v[124:127], v[220:223], a[72:75], v[124:127]
  s_waitcnt lgkmcnt(4)
  ds_read_b64_tr_b16 v[252:253], v170 offset:8192
  ds_read_b64_tr_b16 v[254:255], v170 offset:8704
  v_mfma_f32_16x16x32_bf16 v[132:135], v[232:235], a[72:75], 0
  ds_read_b64_tr_b16 v[220:221], v171 offset:0
  v_max_f32 v201, 0, v101
  v_mfma_f32_16x16x32_bf16 v[132:135], v[236:239], a[76:79], v[132:135]
  s_add_u32 m0, s22, 36864
  ds_read_b64_tr_b16 v[222:223], v171 offset:512
  v_max_f32 v202, 0, v102
  v_mfma_f32_16x16x32_bf16 v[132:135], v[240:243], a[80:83], v[132:135]
  buffer_load_dwordx4 v180, s[8:11], s23 offen lds
  v_mfma_f32_16x16x32_bf16 v[128:131], v[240:243], a[8:11], 0
  s_add_u32 s23, s23, 294912
  ds_read_b64_tr_b16 v[224:225], v171 offset:4096
  v_max_f32 v203, 0, v103
  v_mfma_f32_16x16x32_bf16 v[128:131], v[236:239], a[4:7], v[128:131]
  ds_read_b64_tr_b16 v[226:227], v171 offset:4608
  v_max_f32 v204, 0, v104
  v_mfma_f32_16x16x32_bf16 v[128:131], v[232:235], a[0:3], v[128:131]
  s_waitcnt lgkmcnt(4)
  ds_read_b64_tr_b16 v[228:229], v171 offset:8192
  ds_read_b64_tr_b16 v[230:231], v171 offset:8704
  v_mfma_f32_16x16x32_bf16 v[136:139], v[244:247], a[0:3], 0
  ds_read_b64_tr_b16 v[232:233], v168 offset:12288
  v_max_f32 v205, 0, v105
  v_mfma_f32_16x16x32_bf16 v[136:139], v[248:251], a[4:7], v[136:139]
  s_add_u32 m0, s22, 40960
  ds_read_b64_tr_b16 v[234:235], v168 offset:12800
  v_max_f32 v206, 0, v106
  v_mfma_f32_16x16x32_bf16 v[136:139], v[252:255], a[8:11], v[136:139]
  buffer_load_dwordx4 v180, s[8:11], s23 offen lds
  v_mfma_f32_16x16x32_bf16 v[140:143], v[252:255], a[80:83], 0
  s_add_u32 s23, s23, 294912
  ds_read_b64_tr_b16 v[236:237], v168 offset:16384
  v_max_f32 v207, 0, v107
  v_mfma_f32_16x16x32_bf16 v[140:143], v[248:251], a[76:79], v[140:143]
  ds_read_b64_tr_b16 v[238:239], v168 offset:16896
  v_max_f32 v208, 0, v108
  v_mfma_f32_16x16x32_bf16 v[140:143], v[244:247], a[72:75], v[140:143]
  s_waitcnt lgkmcnt(4)
  ds_read_b64_tr_b16 v[240:241], v168 offset:20480
  ds_read_b64_tr_b16 v[242:243], v168 offset:20992
  v_mfma_f32_16x16x32_bf16 v[148:151], v[220:223], a[72:75], 0
  ds_read_b64_tr_b16 v[244:245], v169 offset:12288
  v_max_f32 v209, 0, v109
  v_mfma_f32_16x16x32_bf16 v[148:151], v[224:227], a[76:79], v[148:151]
  s_add_u32 m0, s22, 45056
  ds_read_b64_tr_b16 v[246:247], v169 offset:12800
  v_max_f32 v210, 0, v110
  v_mfma_f32_16x16x32_bf16 v[148:151], v[228:231], a[80:83], v[148:151]
  buffer_load_dwordx4 v180, s[8:11], s23 offen lds
  v_mfma_f32_16x16x32_bf16 v[144:147], v[228:231], a[8:11], 0
  s_add_u32 s23, s23, 294912
  ds_read_b64_tr_b16 v[248:249], v169 offset:16384
  v_max_f32 v211, 0, v111
  v_mfma_f32_16x16x32_bf16 v[144:147], v[224:227], a[4:7], v[144:147]
  ds_read_b64_tr_b16 v[250:251], v169 offset:16896
  v_max_f32 v212, 0, v112
  v_mfma_f32_16x16x32_bf16 v[144:147], v[220:223], a[0:3], v[144:147]
  s_waitcnt lgkmcnt(4)
  ds_read_b64_tr_b16 v[252:253], v169 offset:20480
  ds_read_b64_tr_b16 v[254:255], v169 offset:20992
  v_mfma_f32_16x16x32_bf16 v[120:123], v[232:235], a[12:15], v[120:123]
  ds_read_b64_tr_b16 v[220:221], v170 offset:12288
  v_max_f32 v213, 0, v113
  v_mfma_f32_16x16x32_bf16 v[120:123], v[236:239], a[16:19], v[120:123]
  ds_read_b64_tr_b16 v[222:223], v170 offset:12800
  v_max_f32 v214, 0, v114
  v_mfma_f32_16x16x32_bf16 v[120:123], v[240:243], a[20:23], v[120:123]
  v_mfma_f32_16x16x32_bf16 v[124:127], v[240:243], a[92:95], v[124:127]
  ds_read_b64_tr_b16 v[224:225], v170 offset:16384
  v_max_f32 v215, 0, v115
  v_mfma_f32_16x16x32_bf16 v[124:127], v[236:239], a[88:91], v[124:127]
  ds_read_b64_tr_b16 v[226:227], v170 offset:16896
  v_max_f32 v216, 0, v116
  v_mfma_f32_16x16x32_bf16 v[124:127], v[232:235], a[84:87], v[124:127]
  s_waitcnt lgkmcnt(4)
  ds_read_b64_tr_b16 v[228:229], v170 offset:20480
  ds_read_b64_tr_b16 v[230:231], v170 offset:20992
  v_mfma_f32_16x16x32_bf16 v[132:135], v[244:247], a[84:87], v[132:135]
  ds_read_b64_tr_b16 v[232:233], v171 offset:12288
  v_max_f32 v217, 0, v117
  v_mfma_f32_16x16x32_bf16 v[132:135], v[248:251], a[88:91], v[132:135]
  s_add_u32 m0, s22, 49152
  ds_read_b64_tr_b16 v[234:235], v171 offset:12800
  v_max_f32 v218, 0, v118
  v_mfma_f32_16x16x32_bf16 v[132:135], v[252:255], a[92:95], v[132:135]
  buffer_load_dwordx4 v180, s[8:11], s23 offen lds
  v_mfma_f32_16x16x32_bf16 v[128:131], v[252:255], a[20:23], v[128:131]
  s_add_u32 s23, s23, 294912
  ds_read_b64_tr_b16 v[236:237], v171 offset:16384
  v_max_f32 v219, 0, v119
  v_mfma_f32_16x16x32_bf16 v[128:131], v[248:251], a[16:19], v[128:131]
  ds_read_b64_tr_b16 v[238:239], v171 offset:16896
  v_mfma_f32_16x16x32_bf16 v[128:131], v[244:247], a[12:15], v[128:131]
  s_waitcnt lgkmcnt(4)
  ds_read_b64_tr_b16 v[240:241], v171 offset:20480
  ds_read_b64_tr_b16 v[242:243], v171 offset:20992
  v_mfma_f32_16x16x32_bf16 v[136:139], v[220:223], a[12:15], v[136:139]
  ds_read_b64_tr_b16 v[244:245], v168 offset:24576
  v_mfma_f32_16x16x32_bf16 v[136:139], v[224:227], a[16:19], v[136:139]
  s_add_u32 m0, s22, 53248
  ds_read_b64_tr_b16 v[246:247], v168 offset:25088
  v_mfma_f32_16x16x32_bf16 v[136:139], v[228:231], a[20:23], v[136:139]
  buffer_load_dwordx4 v180, s[8:11], s23 offen lds
  v_mfma_f32_16x16x32_bf16 v[140:143], v[228:231], a[92:95], v[140:143]
  s_add_u32 s23, s23, 294912
  ds_read_b64_tr_b16 v[248:249], v168 offset:28672
  v_mfma_f32_16x16x32_bf16 v[140:143], v[224:227], a[88:91], v[140:143]
  ds_read_b64_tr_b16 v[250:251], v168 offset:29184
  v_mfma_f32_16x16x32_bf16 v[140:143], v[220:223], a[84:87], v[140:143]
  s_waitcnt lgkmcnt(4)
  ds_read_b64_tr_b16 v[252:253], v168 offset:32768
  ds_read_b64_tr_b16 v[254:255], v168 offset:33280
  v_mfma_f32_16x16x32_bf16 v[148:151], v[232:235], a[84:87], v[148:151]
  ds_read_b64_tr_b16 v[220:221], v169 offset:24576
  v_add_u32 v168, 110592, v172
  v_mfma_f32_16x16x32_bf16 v[148:151], v[236:239], a[88:91], v[148:151]
  s_add_u32 m0, s22, 57344
  ds_read_b64_tr_b16 v[222:223], v169 offset:25088
  v_mfma_f32_16x16x32_bf16 v[148:151], v[240:243], a[92:95], v[148:151]
  buffer_load_dwordx4 v180, s[8:11], s23 offen lds
  v_mfma_f32_16x16x32_bf16 v[144:147], v[240:243], a[20:23], v[144:147]
  s_add_u32 s23, s23, 294912
  ds_read_b64_tr_b16 v[224:225], v169 offset:28672
  v_mfma_f32_16x16x32_bf16 v[144:147], v[236:239], a[16:19], v[144:147]
  ds_read_b64_tr_b16 v[226:227], v169 offset:29184
  v_mfma_f32_16x16x32_bf16 v[144:147], v[232:235], a[12:15], v[144:147]
  s_waitcnt lgkmcnt(4)
  ds_read_b64_tr_b16 v[228:229], v169 offset:32768
  ds_read_b64_tr_b16 v[230:231], v169 offset:33280
  v_mfma_f32_16x16x32_bf16 v[120:123], v[244:247], a[24:27], v[120:123]
  ds_read_b64_tr_b16 v[232:233], v170 offset:24576
  v_add_u32 v169, 110592, v173
  v_mfma_f32_16x16x32_bf16 v[120:123], v[248:251], a[28:31], v[120:123]
  s_waitcnt vmcnt(9)
  ds_read_b64_tr_b16 v[234:235], v170 offset:25088
  v_mfma_f32_16x16x32_bf16 v[120:123], v[252:255], a[32:35], v[120:123]
  buffer_store_dword v14, v186, s[48:51], s34 offen offset:64 sc1
  v_mfma_f32_16x16x32_bf16 v[124:127], v[252:255], a[104:107], v[124:127]
  ds_read_b64_tr_b16 v[236:237], v170 offset:28672
  v_mfma_f32_16x16x32_bf16 v[124:127], v[248:251], a[100:103], v[124:127]
  ds_read_b64_tr_b16 v[238:239], v170 offset:29184
  v_mfma_f32_16x16x32_bf16 v[124:127], v[244:247], a[96:99], v[124:127]
  s_waitcnt lgkmcnt(4)
  ds_read_b64_tr_b16 v[240:241], v170 offset:32768
  ds_read_b64_tr_b16 v[242:243], v170 offset:33280
  v_mfma_f32_16x16x32_bf16 v[132:135], v[220:223], a[96:99], v[132:135]
  ds_read_b64_tr_b16 v[244:245], v171 offset:24576
  v_add_u32 v170, 110592, v174
  v_mfma_f32_16x16x32_bf16 v[132:135], v[224:227], a[100:103], v[132:135]
  s_add_u32 m0, s22, 61440
  ds_read_b64_tr_b16 v[246:247], v171 offset:25088
  v_mfma_f32_16x16x32_bf16 v[132:135], v[228:231], a[104:107], v[132:135]
  buffer_load_dwordx4 v180, s[8:11], s23 offen lds
  v_mfma_f32_16x16x32_bf16 v[128:131], v[228:231], a[32:35], v[128:131]
  s_add_u32 s23, s23, 294912
  ds_read_b64_tr_b16 v[248:249], v171 offset:28672
  v_mfma_f32_16x16x32_bf16 v[128:131], v[224:227], a[28:31], v[128:131]
  ds_read_b64_tr_b16 v[250:251], v171 offset:29184
  v_mfma_f32_16x16x32_bf16 v[128:131], v[220:223], a[24:27], v[128:131]
  s_waitcnt lgkmcnt(4)
  ds_read_b64_tr_b16 v[252:253], v171 offset:32768
  ds_read_b64_tr_b16 v[254:255], v171 offset:33280
  v_mfma_f32_16x16x32_bf16 v[136:139], v[232:235], a[24:27], v[136:139]
  ds_read_b64_tr_b16 v[220:221], v168 offset:0
  v_add_u32 v171, 110592, v175
  v_mfma_f32_16x16x32_bf16 v[136:139], v[236:239], a[28:31], v[136:139]
  s_add_u32 m0, s22, 65536
  ds_read_b64_tr_b16 v[222:223], v168 offset:512
  v_mfma_f32_16x16x32_bf16 v[136:139], v[240:243], a[32:35], v[136:139]
  buffer_load_dwordx4 v180, s[8:11], s23 offen lds
  v_mfma_f32_16x16x32_bf16 v[140:143], v[240:243], a[104:107], v[140:143]
  s_add_u32 s23, s23, 294912
  ds_read_b64_tr_b16 v[224:225], v168 offset:4096
  v_mfma_f32_16x16x32_bf16 v[140:143], v[236:239], a[100:103], v[140:143]
  ds_read_b64_tr_b16 v[226:227], v168 offset:4608
  v_mfma_f32_16x16x32_bf16 v[140:143], v[232:235], a[96:99], v[140:143]
  s_waitcnt lgkmcnt(4)
  ds_read_b64_tr_b16 v[228:229], v168 offset:8192
  ds_read_b64_tr_b16 v[230:231], v168 offset:8704
  v_mfma_f32_16x16x32_bf16 v[148:151], v[244:247], a[96:99], v[148:151]
  ds_read_b64_tr_b16 v[232:233], v169 offset:0
  v_mfma_f32_16x16x32_bf16 v[148:151], v[248:251], a[100:103], v[148:151]
  s_add_u32 m0, s22, 69632
  ds_read_b64_tr_b16 v[234:235], v169 offset:512
  v_mfma_f32_16x16x32_bf16 v[148:151], v[252:255], a[104:107], v[148:151]
  buffer_load_dwordx4 v180, s[8:11], s23 offen lds
  v_mfma_f32_16x16x32_bf16 v[144:147], v[252:255], a[32:35], v[144:147]
  ds_read_b64_tr_b16 v[236:237], v169 offset:4096
  v_mfma_f32_16x16x32_bf16 v[144:147], v[248:251], a[28:31], v[144:147]
  ds_read_b64_tr_b16 v[238:239], v169 offset:4608
  v_mfma_f32_16x16x32_bf16 v[144:147], v[244:247], a[24:27], v[144:147]
  s_waitcnt lgkmcnt(4)
  ds_read_b64_tr_b16 v[240:241], v169 offset:8192
  ds_read_b64_tr_b16 v[242:243], v169 offset:8704
  v_mfma_f32_16x16x32_bf16 v[120:123], v[220:223], a[36:39], v[120:123]
  ds_read_b64_tr_b16 v[244:245], v170 offset:0
  v_mfma_f32_16x16x32_bf16 v[120:123], v[224:227], a[40:43], v[120:123]
  s_waitcnt vmcnt(20)
  ds_read_b64_tr_b16 v[246:247], v170 offset:512
  v_mfma_f32_16x16x32_bf16 v[120:123], v[228:231], a[44:47], v[120:123]
  s_barrier
  v_mfma_f32_16x16x32_bf16 v[124:127], v[228:231], a[116:119], v[124:127]
  ds_read_b64_tr_b16 v[248:249], v170 offset:4096
  v_mfma_f32_16x16x32_bf16 v[124:127], v[224:227], a[112:115], v[124:127]
  ds_read_b64_tr_b16 v[250:251], v170 offset:4608
  v_mfma_f32_16x16x32_bf16 v[124:127], v[220:223], a[108:111], v[124:127]
  s_waitcnt lgkmcnt(4)
  ds_read_b64_tr_b16 v[252:253], v170 offset:8192
  ds_read_b64_tr_b16 v[254:255], v170 offset:8704
  v_mfma_f32_16x16x32_bf16 v[132:135], v[232:235], a[108:111], v[132:135]
  s_add_u32 s23, s24, 384
  ds_read_b64_tr_b16 v[220:221], v171 offset:0
  v_mfma_f32_16x16x32_bf16 v[132:135], v[236:239], a[112:115], v[132:135]
  s_add_u32 m0, s22, 73728
  ds_read_b64_tr_b16 v[222:223], v171 offset:512
  v_mfma_f32_16x16x32_bf16 v[132:135], v[240:243], a[116:119], v[132:135]
  buffer_load_dwordx4 v180, s[12:15], s23 offen lds
  v_mfma_f32_16x16x32_bf16 v[128:131], v[240:243], a[44:47], v[128:131]
  s_add_u32 s23, s23, 294912
  ds_read_b64_tr_b16 v[224:225], v171 offset:4096
  v_mfma_f32_16x16x32_bf16 v[128:131], v[236:239], a[40:43], v[128:131]
  ds_read_b64_tr_b16 v[226:227], v171 offset:4608
  v_mfma_f32_16x16x32_bf16 v[128:131], v[232:235], a[36:39], v[128:131]
  s_waitcnt lgkmcnt(4)
  ds_read_b64_tr_b16 v[228:229], v171 offset:8192
  ds_read_b64_tr_b16 v[230:231], v171 offset:8704
  v_mfma_f32_16x16x32_bf16 v[136:139], v[244:247], a[36:39], v[136:139]
  ds_read_b64_tr_b16 v[232:233], v168 offset:12288
  v_mfma_f32_16x16x32_bf16 v[136:139], v[248:251], a[40:43], v[136:139]
  s_add_u32 m0, s22, 77824
  ds_read_b64_tr_b16 v[234:235], v168 offset:12800
  v_mfma_f32_16x16x32_bf16 v[136:139], v[252:255], a[44:47], v[136:139]
  buffer_load_dwordx4 v180, s[12:15], s23 offen lds
  v_mfma_f32_16x16x32_bf16 v[140:143], v[252:255], a[116:119], v[140:143]
  s_add_u32 s23, s23, 294912
  ds_read_b64_tr_b16 v[236:237], v168 offset:16384
  v_mfma_f32_16x16x32_bf16 v[140:143], v[248:251], a[112:115], v[140:143]
  ds_read_b64_tr_b16 v[238:239], v168 offset:16896
  v_mfma_f32_16x16x32_bf16 v[140:143], v[244:247], a[108:111], v[140:143]
  s_waitcnt lgkmcnt(4)
  ds_read_b64_tr_b16 v[240:241], v168 offset:20480
  ds_read_b64_tr_b16 v[242:243], v168 offset:20992
  v_mfma_f32_16x16x32_bf16 v[148:151], v[220:223], a[108:111], v[148:151]
  ds_read_b64_tr_b16 v[244:245], v169 offset:12288
  v_mfma_f32_16x16x32_bf16 v[148:151], v[224:227], a[112:115], v[148:151]
  s_add_u32 m0, s22, 81920
  ds_read_b64_tr_b16 v[246:247], v169 offset:12800
  v_mfma_f32_16x16x32_bf16 v[148:151], v[228:231], a[116:119], v[148:151]
  buffer_load_dwordx4 v180, s[12:15], s23 offen lds
  v_mfma_f32_16x16x32_bf16 v[144:147], v[228:231], a[44:47], v[144:147]
  s_add_u32 s23, s23, 294912
  ds_read_b64_tr_b16 v[248:249], v169 offset:16384
  v_mfma_f32_16x16x32_bf16 v[144:147], v[224:227], a[40:43], v[144:147]
  ds_read_b64_tr_b16 v[250:251], v169 offset:16896
  v_mfma_f32_16x16x32_bf16 v[144:147], v[220:223], a[36:39], v[144:147]
  s_waitcnt lgkmcnt(4)
  ds_read_b64_tr_b16 v[252:253], v169 offset:20480
  ds_read_b64_tr_b16 v[254:255], v169 offset:20992
  v_mfma_f32_16x16x32_bf16 v[120:123], v[232:235], a[48:51], v[120:123]
  ds_read_b64_tr_b16 v[220:221], v170 offset:12288
  v_mfma_f32_16x16x32_bf16 v[120:123], v[236:239], a[52:55], v[120:123]
  ds_read_b64_tr_b16 v[222:223], v170 offset:12800
  v_mfma_f32_16x16x32_bf16 v[120:123], v[240:243], a[56:59], v[120:123]
  v_mfma_f32_16x16x32_bf16 v[124:127], v[240:243], a[128:131], v[124:127]
  ds_read_b64_tr_b16 v[224:225], v170 offset:16384
  v_mfma_f32_16x16x32_bf16 v[124:127], v[236:239], a[124:127], v[124:127]
  ds_read_b64_tr_b16 v[226:227], v170 offset:16896
  v_mfma_f32_16x16x32_bf16 v[124:127], v[232:235], a[120:123], v[124:127]
  s_waitcnt lgkmcnt(4)
  ds_read_b64_tr_b16 v[228:229], v170 offset:20480
  ds_read_b64_tr_b16 v[230:231], v170 offset:20992
  v_mfma_f32_16x16x32_bf16 v[132:135], v[244:247], a[120:123], v[132:135]
  ds_read_b64_tr_b16 v[232:233], v171 offset:12288
  v_mfma_f32_16x16x32_bf16 v[132:135], v[248:251], a[124:127], v[132:135]
  s_add_u32 m0, s22, 86016
  ds_read_b64_tr_b16 v[234:235], v171 offset:12800
  v_mfma_f32_16x16x32_bf16 v[132:135], v[252:255], a[128:131], v[132:135]
  buffer_load_dwordx4 v180, s[12:15], s23 offen lds
  v_mfma_f32_16x16x32_bf16 v[128:131], v[252:255], a[56:59], v[128:131]
  s_add_u32 s23, s23, 294912
  ds_read_b64_tr_b16 v[236:237], v171 offset:16384
  v_mfma_f32_16x16x32_bf16 v[128:131], v[248:251], a[52:55], v[128:131]
  ds_read_b64_tr_b16 v[238:239], v171 offset:16896
  v_mfma_f32_16x16x32_bf16 v[128:131], v[244:247], a[48:51], v[128:131]
  s_waitcnt lgkmcnt(4)
  ds_read_b64_tr_b16 v[240:241], v171 offset:20480
  ds_read_b64_tr_b16 v[242:243], v171 offset:20992
  v_mfma_f32_16x16x32_bf16 v[136:139], v[220:223], a[48:51], v[136:139]
  ds_read_b64_tr_b16 v[244:245], v168 offset:24576
  v_mfma_f32_16x16x32_bf16 v[136:139], v[224:227], a[52:55], v[136:139]
  s_add_u32 m0, s22, 90112
  ds_read_b64_tr_b16 v[246:247], v168 offset:25088
  v_mfma_f32_16x16x32_bf16 v[136:139], v[228:231], a[56:59], v[136:139]
  buffer_load_dwordx4 v180, s[12:15], s23 offen lds
  v_mfma_f32_16x16x32_bf16 v[140:143], v[228:231], a[128:131], v[140:143]
  s_add_u32 s23, s23, 294912
  ds_read_b64_tr_b16 v[248:249], v168 offset:28672
  v_mfma_f32_16x16x32_bf16 v[140:143], v[224:227], a[124:127], v[140:143]
  ds_read_b64_tr_b16 v[250:251], v168 offset:29184
  v_mfma_f32_16x16x32_bf16 v[140:143], v[220:223], a[120:123], v[140:143]
  s_waitcnt lgkmcnt(4)
  ds_read_b64_tr_b16 v[252:253], v168 offset:32768
  ds_read_b64_tr_b16 v[254:255], v168 offset:33280
  v_mfma_f32_16x16x32_bf16 v[148:151], v[232:235], a[120:123], v[148:151]
  ds_read_b64_tr_b16 v[220:221], v169 offset:24576
  v_add_u32 v168, 0, v172
  v_mfma_f32_16x16x32_bf16 v[148:151], v[236:239], a[124:127], v[148:151]
  s_add_u32 m0, s22, 94208
  ds_read_b64_tr_b16 v[222:223], v169 offset:25088
  v_mfma_f32_16x16x32_bf16 v[148:151], v[240:243], a[128:131], v[148:151]
  buffer_load_dwordx4 v180, s[12:15], s23 offen lds
  v_mfma_f32_16x16x32_bf16 v[144:147], v[240:243], a[56:59], v[144:147]
  s_add_u32 s23, s23, 294912
  ds_read_b64_tr_b16 v[224:225], v169 offset:28672
  v_mfma_f32_16x16x32_bf16 v[144:147], v[236:239], a[52:55], v[144:147]
  ds_read_b64_tr_b16 v[226:227], v169 offset:29184
  v_mfma_f32_16x16x32_bf16 v[144:147], v[232:235], a[48:51], v[144:147]
  s_waitcnt lgkmcnt(4)
  ds_read_b64_tr_b16 v[228:229], v169 offset:32768
  ds_read_b64_tr_b16 v[230:231], v169 offset:33280
  v_mfma_f32_16x16x32_bf16 v[120:123], v[244:247], a[60:63], v[120:123]
  ds_read_b64_tr_b16 v[232:233], v170 offset:24576
  v_add_u32 v169, 0, v173
  v_mfma_f32_16x16x32_bf16 v[120:123], v[248:251], a[64:67], v[120:123]
  ds_read_b64_tr_b16 v[234:235], v170 offset:25088
  v_mfma_f32_16x16x32_bf16 v[120:123], v[252:255], a[68:71], v[120:123]
  buffer_load_dword v15, v186, s[48:51], s35 offen offset:64 sc1
  v_mfma_f32_16x16x32_bf16 v[124:127], v[252:255], a[140:143], v[124:127]
  ds_read_b64_tr_b16 v[236:237], v170 offset:28672
  v_mfma_f32_16x16x32_bf16 v[124:127], v[248:251], a[136:139], v[124:127]
  ds_read_b64_tr_b16 v[238:239], v170 offset:29184
  v_mfma_f32_16x16x32_bf16 v[124:127], v[244:247], a[132:135], v[124:127]
  s_waitcnt lgkmcnt(4)
  ds_read_b64_tr_b16 v[240:241], v170 offset:32768
  ds_read_b64_tr_b16 v[242:243], v170 offset:33280
  v_mfma_f32_16x16x32_bf16 v[132:135], v[220:223], a[132:135], v[132:135]
  ds_read_b64_tr_b16 v[244:245], v171 offset:24576
  v_add_u32 v170, 0, v174
  v_mfma_f32_16x16x32_bf16 v[132:135], v[224:227], a[136:139], v[132:135]
  s_add_u32 m0, s22, 98304
  ds_read_b64_tr_b16 v[246:247], v171 offset:25088
  v_mfma_f32_16x16x32_bf16 v[132:135], v[228:231], a[140:143], v[132:135]
  buffer_load_dwordx4 v180, s[12:15], s23 offen lds
  v_mfma_f32_16x16x32_bf16 v[128:131], v[228:231], a[68:71], v[128:131]
  s_add_u32 s23, s23, 294912
  ds_read_b64_tr_b16 v[248:249], v171 offset:28672
  v_mul_f32 v120, v188, v120
  v_mfma_f32_16x16x32_bf16 v[128:131], v[224:227], a[64:67], v[128:131]
  ds_read_b64_tr_b16 v[250:251], v171 offset:29184
  v_mul_f32 v121, v189, v121
  v_mfma_f32_16x16x32_bf16 v[128:131], v[220:223], a[60:63], v[128:131]
  s_waitcnt lgkmcnt(4)
  ds_read_b64_tr_b16 v[252:253], v171 offset:32768
  ds_read_b64_tr_b16 v[254:255], v171 offset:33280
  v_mfma_f32_16x16x32_bf16 v[136:139], v[232:235], a[60:63], v[136:139]
  ds_read_b64_tr_b16 v[220:221], v168 offset:0
  v_add_u32 v171, 0, v175
  v_mfma_f32_16x16x32_bf16 v[136:139], v[236:239], a[64:67], v[136:139]
  s_add_u32 m0, s22, 102400
  ds_read_b64_tr_b16 v[222:223], v168 offset:512
  v_mul_f32 v122, v190, v122
  v_mfma_f32_16x16x32_bf16 v[136:139], v[240:243], a[68:71], v[136:139]
  buffer_load_dwordx4 v180, s[12:15], s23 offen lds
  v_mfma_f32_16x16x32_bf16 v[140:143], v[240:243], a[140:143], v[140:143]
  s_add_u32 s23, s23, 294912
  ds_read_b64_tr_b16 v[224:225], v168 offset:4096
  v_mul_f32 v123, v191, v123
  v_mfma_f32_16x16x32_bf16 v[140:143], v[236:239], a[136:139], v[140:143]
  ds_read_b64_tr_b16 v[226:227], v168 offset:4608
  v_mul_f32 v124, v192, v124
  v_mfma_f32_16x16x32_bf16 v[140:143], v[232:235], a[132:135], v[140:143]
  s_waitcnt lgkmcnt(4)
  ds_read_b64_tr_b16 v[228:229], v168 offset:8192
  ds_read_b64_tr_b16 v[230:231], v168 offset:8704
  v_mfma_f32_16x16x32_bf16 v[148:151], v[244:247], a[132:135], v[148:151]
  ds_read_b64_tr_b16 v[232:233], v169 offset:0
  v_mul_f32 v125, v193, v125
  v_mfma_f32_16x16x32_bf16 v[148:151], v[248:251], a[136:139], v[148:151]
  s_add_u32 m0, s22, 106496
  ds_read_b64_tr_b16 v[234:235], v169 offset:512
  v_mul_f32 v126, v194, v126
  v_mfma_f32_16x16x32_bf16 v[148:151], v[252:255], a[140:143], v[148:151]
  buffer_load_dwordx4 v180, s[12:15], s23 offen lds
  v_mfma_f32_16x16x32_bf16 v[144:147], v[252:255], a[68:71], v[144:147]
  s_add_u32 s23, s23, 294912
  ds_read_b64_tr_b16 v[236:237], v169 offset:4096
  v_mul_f32 v127, v195, v127
  v_mfma_f32_16x16x32_bf16 v[144:147], v[248:251], a[64:67], v[144:147]
  ds_read_b64_tr_b16 v[238:239], v169 offset:4608
  v_cvt_pk_bf16_f32 v48, v120, v121
  v_mfma_f32_16x16x32_bf16 v[144:147], v[244:247], a[60:63], v[144:147]
  s_waitcnt lgkmcnt(4)
  ds_read_b64_tr_b16 v[240:241], v169 offset:8192
  ds_read_b64_tr_b16 v[242:243], v169 offset:8704
  v_mfma_f32_16x16x32_bf16 v[88:91], v[220:223], a[0:3], 0
  ds_read_b64_tr_b16 v[244:245], v170 offset:0
  v_cvt_pk_bf16_f32 v49, v122, v123
  v_mfma_f32_16x16x32_bf16 v[88:91], v[224:227], a[4:7], v[88:91]
  s_waitcnt vmcnt(17)
  ds_read_b64_tr_b16 v[246:247], v170 offset:512
  v_cvt_pk_bf16_f32 v52, v124, v125
  v_mfma_f32_16x16x32_bf16 v[88:91], v[228:231], a[8:11], v[88:91]
  s_barrier
  v_mfma_f32_16x16x32_bf16 v[92:95], v[228:231], a[80:83], 0
  ds_read_b64_tr_b16 v[248:249], v170 offset:4096
  v_cvt_pk_bf16_f32 v53, v126, v127
  v_mfma_f32_16x16x32_bf16 v[92:95], v[224:227], a[76:79], v[92:95]
  ds_read_b64_tr_b16 v[250:251], v170 offset:4608
  v_mul_f32 v128, v196, v128
  v_mfma_f32_16x16x32_bf16 v[92:95], v[220:223], a[72:75], v[92:95]
  s_waitcnt lgkmcnt(4)
  ds_read_b64_tr_b16 v[252:253], v170 offset:8192
  ds_read_b64_tr_b16 v[254:255], v170 offset:8704
  v_mfma_f32_16x16x32_bf16 v[100:103], v[232:235], a[72:75], 0
  ds_read_b64_tr_b16 v[220:221], v171 offset:0
  v_mul_f32 v129, v197, v129
  v_mfma_f32_16x16x32_bf16 v[100:103], v[236:239], a[76:79], v[100:103]
  s_add_u32 m0, s22, 110592
  ds_read_b64_tr_b16 v[222:223], v171 offset:512
  v_mul_f32 v130, v198, v130
  v_mfma_f32_16x16x32_bf16 v[100:103], v[240:243], a[80:83], v[100:103]
  buffer_load_dwordx4 v180, s[12:15], s23 offen lds
  v_mfma_f32_16x16x32_bf16 v[96:99], v[240:243], a[8:11], 0
  s_add_u32 s23, s23, 294912
  ds_read_b64_tr_b16 v[224:225], v171 offset:4096
  v_mul_f32 v131, v199, v131
  v_mfma_f32_16x16x32_bf16 v[96:99], v[236:239], a[4:7], v[96:99]
  ds_read_b64_tr_b16 v[226:227], v171 offset:4608
  v_mul_f32 v132, v200, v132
  v_mfma_f32_16x16x32_bf16 v[96:99], v[232:235], a[0:3], v[96:99]
  s_waitcnt lgkmcnt(4)
  ds_read_b64_tr_b16 v[228:229], v171 offset:8192
  ds_read_b64_tr_b16 v[230:231], v171 offset:8704
  v_mfma_f32_16x16x32_bf16 v[104:107], v[244:247], a[0:3], 0
  ds_read_b64_tr_b16 v[232:233], v168 offset:12288
  v_mul_f32 v133, v201, v133
  v_mfma_f32_16x16x32_bf16 v[104:107], v[248:251], a[4:7], v[104:107]
  s_add_u32 m0, s22, 114688
  ds_read_b64_tr_b16 v[234:235], v168 offset:12800
  v_mul_f32 v134, v202, v134
  v_mfma_f32_16x16x32_bf16 v[104:107], v[252:255], a[8:11], v[104:107]
  buffer_load_dwordx4 v180, s[12:15], s23 offen lds
  v_mfma_f32_16x16x32_bf16 v[108:111], v[252:255], a[80:83], 0
  s_add_u32 s23, s23, 294912
  ds_read_b64_tr_b16 v[236:237], v168 offset:16384
  v_mul_f32 v135, v203, v135
  v_mfma_f32_16x16x32_bf16 v[108:111], v[248:251], a[76:79], v[108:111]
  ds_read_b64_tr_b16 v[238:239], v168 offset:16896
  v_cvt_pk_bf16_f32 v50, v128, v129
  v_mfma_f32_16x16x32_bf16 v[108:111], v[244:247], a[72:75], v[108:111]
  s_waitcnt lgkmcnt(4)
  ds_read_b64_tr_b16 v[240:241], v168 offset:20480
  ds_read_b64_tr_b16 v[242:243], v168 offset:20992
  v_mfma_f32_16x16x32_bf16 v[116:119], v[220:223], a[72:75], 0
  ds_read_b64_tr_b16 v[244:245], v169 offset:12288
  v_cvt_pk_bf16_f32 v51, v130, v131
  v_mfma_f32_16x16x32_bf16 v[116:119], v[224:227], a[76:79], v[116:119]
  s_add_u32 m0, s22, 118784
  ds_read_b64_tr_b16 v[246:247], v169 offset:12800
  v_cvt_pk_bf16_f32 v54, v132, v133
  v_mfma_f32_16x16x32_bf16 v[116:119], v[228:231], a[80:83], v[116:119]
  buffer_load_dwordx4 v180, s[12:15], s23 offen lds
  v_mfma_f32_16x16x32_bf16 v[112:115], v[228:231], a[8:11], 0
  s_add_u32 s23, s23, 294912
  ds_read_b64_tr_b16 v[248:249], v169 offset:16384
  v_cvt_pk_bf16_f32 v55, v134, v135
  v_mfma_f32_16x16x32_bf16 v[112:115], v[224:227], a[4:7], v[112:115]
  ds_read_b64_tr_b16 v[250:251], v169 offset:16896
  v_mul_f32 v136, v204, v136
  v_mfma_f32_16x16x32_bf16 v[112:115], v[220:223], a[0:3], v[112:115]
  s_waitcnt lgkmcnt(4)
  ds_read_b64_tr_b16 v[252:253], v169 offset:20480
  ds_read_b64_tr_b16 v[254:255], v169 offset:20992
  v_mfma_f32_16x16x32_bf16 v[88:91], v[232:235], a[12:15], v[88:91]
  s_waitcnt vmcnt(6)
  ds_read_b64_tr_b16 v[220:221], v170 offset:12288
  v_mul_f32 v137, v205, v137
  v_mfma_f32_16x16x32_bf16 v[88:91], v[236:239], a[16:19], v[88:91]
  ds_read_b64_tr_b16 v[222:223], v170 offset:12800
  v_readfirstlane_b32 s53, v15
  v_mfma_f32_16x16x32_bf16 v[88:91], v[240:243], a[20:23], v[88:91]
  v_mfma_f32_16x16x32_bf16 v[92:95], v[240:243], a[92:95], v[92:95]
  s_cmp_eq_u32 s53, 1
  s_cbranch_scc0 KB_SLOW1
KB_RES1:
  ds_read_b64_tr_b16 v[224:225], v170 offset:16384
  v_mfma_f32_16x16x32_bf16 v[92:95], v[236:239], a[88:91], v[92:95]
  ds_read_b64_tr_b16 v[226:227], v170 offset:16896
  v_mul_f32 v138, v206, v138
  v_mfma_f32_16x16x32_bf16 v[92:95], v[232:235], a[84:87], v[92:95]
  s_waitcnt lgkmcnt(4)
  ds_read_b64_tr_b16 v[228:229], v170 offset:20480
  ds_read_b64_tr_b16 v[230:231], v170 offset:20992
  v_mfma_f32_16x16x32_bf16 v[100:103], v[244:247], a[84:87], v[100:103]
  s_nop 0
  ds_read_b64_tr_b16 v[232:233], v171 offset:12288
  ds_read_b64_tr_b16 v[234:235], v171 offset:12800
  v_mfma_f32_16x16x32_bf16 v[100:103], v[248:251], a[88:91], v[100:103]
  s_add_u32 m0, s22, 122880
  ds_read_b64_tr_b16 v[236:237], v171 offset:16384
  v_mul_f32 v139, v207, v139
  v_mfma_f32_16x16x32_bf16 v[100:103], v[252:255], a[92:95], v[100:103]
  buffer_load_dwordx4 v180, s[12:15], s23 offen lds
  v_mfma_f32_16x16x32_bf16 v[96:99], v[252:255], a[20:23], v[96:99]
  s_add_u32 s23, s23, 294912
  ds_read_b64_tr_b16 v[238:239], v171 offset:16896
  v_mul_f32 v140, v208, v140
  v_mfma_f32_16x16x32_bf16 v[96:99], v[248:251], a[16:19], v[96:99]
  buffer_load_dwordx4 a[160:163], v185, s[48:51], s32 offen offset:0 sc1
  v_mfma_f32_16x16x32_bf16 v[96:99], v[244:247], a[12:15], v[96:99]
  s_waitcnt lgkmcnt(4)
  ds_read_b64_tr_b16 v[240:241], v171 offset:20480
  ds_read_b64_tr_b16 v[242:243], v171 offset:20992
  v_mfma_f32_16x16x32_bf16 v[104:107], v[220:223], a[12:15], v[104:107]
  s_nop 0
  ds_read_b64_tr_b16 v[244:245], v168 offset:24576
  ds_read_b64_tr_b16 v[246:247], v168 offset:25088
  v_mfma_f32_16x16x32_bf16 v[104:107], v[224:227], a[16:19], v[104:107]
  s_add_u32 m0, s22, 126976
  ds_read_b64_tr_b16 v[248:249], v168 offset:28672
  v_mul_f32 v141, v209, v141
  v_mfma_f32_16x16x32_bf16 v[104:107], v[228:231], a[20:23], v[104:107]
  buffer_load_dwordx4 v180, s[12:15], s23 offen lds
  v_mfma_f32_16x16x32_bf16 v[108:111], v[228:231], a[92:95], v[108:111]
  s_add_u32 s23, s23, 294912
  ds_read_b64_tr_b16 v[250:251], v168 offset:29184
  v_mul_f32 v142, v210, v142
  v_mfma_f32_16x16x32_bf16 v[108:111], v[224:227], a[88:91], v[108:111]
  buffer_load_dwordx4 a[164:167], v185, s[48:51], s32 offen offset:1024 sc1
  v_mfma_f32_16x16x32_bf16 v[108:111], v[220:223], a[84:87], v[108:111]
  s_waitcnt lgkmcnt(4)
  ds_read_b64_tr_b16 v[252:253], v168 offset:32768
  ds_read_b64_tr_b16 v[254:255], v168 offset:33280
  v_mfma_f32_16x16x32_bf16 v[116:119], v[232:235], a[84:87], v[116:119]
  ds_read_b64_tr_b16 v[220:221], v169 offset:24576
  v_add_u32 v168, 36864, v172
  v_mfma_f32_16x16x32_bf16 v[116:119], v[236:239], a[88:91], v[116:119]
  s_add_u32 m0, s22, 131072
  ds_read_b64_tr_b16 v[222:223], v169 offset:25088
  v_mul_f32 v143, v211, v143
  v_mfma_f32_16x16x32_bf16 v[116:119], v[240:243], a[92:95], v[116:119]
  buffer_load_dwordx4 v180, s[12:15], s23 offen lds
  v_mfma_f32_16x16x32_bf16 v[112:115], v[240:243], a[20:23], v[112:115]
  s_add_u32 s23, s23, 294912
  ds_read_b64_tr_b16 v[224:225], v169 offset:28672
  v_cvt_pk_bf16_f32 v56, v136, v137
  v_mfma_f32_16x16x32_bf16 v[112:115], v[236:239], a[16:19], v[112:115]
  ds_read_b64_tr_b16 v[226:227], v169 offset:29184
  v_cvt_pk_bf16_f32 v57, v138, v139
  v_mfma_f32_16x16x32_bf16 v[112:115], v[232:235], a[12:15], v[112:115]
KB_I5:
  s_cbranch_execz KB_I8
  s_waitcnt lgkmcnt(4)
  ds_read_b64_tr_b16 v[228:229], v169 offset:32768
  ds_read_b64_tr_b16 v[230:231], v169 offset:33280
  v_mfma_f32_16x16x32_bf16 v[88:91], v[244:247], a[24:27], v[88:91]
  ds_read_b64_tr_b16 v[232:233], v170 offset:24576
  v_add_u32 v169, 36864, v173
  v_mfma_f32_16x16x32_bf16 v[88:91], v[248:251], a[28:31], v[88:91]
  ds_read_b64_tr_b16 v[234:235], v170 offset:25088
  v_cvt_pk_bf16_f32 v60, v140, v141
  v_mfma_f32_16x16x32_bf16 v[88:91], v[252:255], a[32:35], v[88:91]
  buffer_load_dwordx4 a[168:171], v185, s[48:51], s32 offen offset:2048 sc1
  v_mfma_f32_16x16x32_bf16 v[92:95], v[252:255], a[104:107], v[92:95]
  ds_read_b64_tr_b16 v[236:237], v170 offset:28672
  v_cvt_pk_bf16_f32 v61, v142, v143
  v_mfma_f32_16x16x32_bf16 v[92:95], v[248:251], a[100:103], v[92:95]
  ds_read_b64_tr_b16 v[238:239], v170 offset:29184
  v_mul_f32 v144, v212, v144
  v_mfma_f32_16x16x32_bf16 v[92:95], v[244:247], a[96:99], v[92:95]
  s_waitcnt lgkmcnt(4)
  ds_read_b64_tr_b16 v[240:241], v170 offset:32768
  ds_read_b64_tr_b16 v[242:243], v170 offset:33280
  v_mfma_f32_16x16x32_bf16 v[100:103], v[220:223], a[96:99], v[100:103]
  s_nop 0
  ds_read_b64_tr_b16 v[244:245], v171 offset:24576
  ds_read_b64_tr_b16 v[246:247], v171 offset:25088
  v_mfma_f32_16x16x32_bf16 v[100:103], v[224:227], a[100:103], v[100:103]
  s_add_u32 m0, s22, 135168
  ds_read_b64_tr_b16 v[248:249], v171 offset:28672
  v_add_u32 v170, 36864, v174
  v_mfma_f32_16x16x32_bf16 v[100:103], v[228:231], a[104:107], v[100:103]
  buffer_load_dwordx4 v180, s[12:15], s23 offen lds
  v_mfma_f32_16x16x32_bf16 v[96:99], v[228:231], a[32:35], v[96:99]
  s_add_u32 s23, s23, 294912
  ds_read_b64_tr_b16 v[250:251], v171 offset:29184
  v_mul_f32 v145, v213, v145
  v_mfma_f32_16x16x32_bf16 v[96:99], v[224:227], a[28:31], v[96:99]
  buffer_load_dwordx4 a[172:175], v185, s[48:51], s32 offen offset:3072 sc1
  v_mfma_f32_16x16x32_bf16 v[96:99], v[220:223], a[24:27], v[96:99]
  s_waitcnt lgkmcnt(4)
  ds_read_b64_tr_b16 v[252:253], v171 offset:32768
  ds_read_b64_tr_b16 v[254:255], v171 offset:33280
  v_mfma_f32_16x16x32_bf16 v[104:107], v[232:235], a[24:27], v[104:107]
  s_add_u32 s32, s32, 4096
  ds_read_b64_tr_b16 v[220:221], v168 offset:0
  v_add_u32 v171, 36864, v175
  v_mfma_f32_16x16x32_bf16 v[104:107], v[236:239], a[28:31], v[104:107]
  s_add_u32 m0, s22, 139264
  ds_read_b64_tr_b16 v[222:223], v168 offset:512
  v_mul_f32 v146, v214, v146
  v_mfma_f32_16x16x32_bf16 v[104:107], v[240:243], a[32:35], v[104:107]
  buffer_load_dwordx4 v180, s[12:15], s23 offen lds
  v_mfma_f32_16x16x32_bf16 v[108:111], v[240:243], a[104:107], v[108:111]
  s_add_u32 s23, s23, 294912
  ds_read_b64_tr_b16 v[224:225], v168 offset:4096
  v_mul_f32 v147, v215, v147
  v_mfma_f32_16x16x32_bf16 v[108:111], v[236:239], a[100:103], v[108:111]
  ds_read_b64_tr_b16 v[226:227], v168 offset:4608
  v_mul_f32 v148, v216, v148
  v_mfma_f32_16x16x32_bf16 v[108:111], v[232:235], a[96:99], v[108:111]
  s_waitcnt lgkmcnt(4)
  ds_read_b64_tr_b16 v[228:229], v168 offset:8192
  ds_read_b64_tr_b16 v[230:231], v168 offset:8704
  v_mfma_f32_16x16x32_bf16 v[116:119], v[244:247], a[96:99], v[116:119]
  ds_read_b64_tr_b16 v[232:233], v169 offset:0
  v_mul_f32 v149, v217, v149
  v_mfma_f32_16x16x32_bf16 v[116:119], v[248:251], a[100:103], v[116:119]
  s_add_u32 m0, s22, 143360
  ds_read_b64_tr_b16 v[234:235], v169 offset:512
  v_mul_f32 v150, v218, v150
  v_mfma_f32_16x16x32_bf16 v[116:119], v[252:255], a[104:107], v[116:119]
  buffer_load_dwordx4 v180, s[12:15], s23 offen lds
  v_mfma_f32_16x16x32_bf16 v[112:115], v[252:255], a[32:35], v[112:115]
  ds_read_b64_tr_b16 v[236:237], v169 offset:4096
  v_mul_f32 v151, v219, v151
  v_mfma_f32_16x16x32_bf16 v[112:115], v[248:251], a[28:31], v[112:115]
  ds_read_b64_tr_b16 v[238:239], v169 offset:4608
  v_cvt_pk_bf16_f32 v58, v144, v145
  v_mfma_f32_16x16x32_bf16 v[112:115], v[244:247], a[24:27], v[112:115]
  s_waitcnt lgkmcnt(4)
  ds_read_b64_tr_b16 v[240:241], v169 offset:8192
  ds_read_b64_tr_b16 v[242:243], v169 offset:8704
  v_mfma_f32_16x16x32_bf16 v[88:91], v[220:223], a[36:39], v[88:91]
  ds_read_b64_tr_b16 v[244:245], v170 offset:0
  v_cvt_pk_bf16_f32 v59, v146, v147
  v_mfma_f32_16x16x32_bf16 v[88:91], v[224:227], a[40:43], v[88:91]
  s_waitcnt vmcnt(20)
  ds_read_b64_tr_b16 v[246:247], v170 offset:512
  v_cvt_pk_bf16_f32 v62, v148, v149
  v_mfma_f32_16x16x32_bf16 v[88:91], v[228:231], a[44:47], v[88:91]
  s_barrier
  v_mfma_f32_16x16x32_bf16 v[92:95], v[228:231], a[116:119], v[92:95]
  ds_read_b64_tr_b16 v[248:249], v170 offset:4096
  v_cvt_pk_bf16_f32 v63, v150, v151
  v_mfma_f32_16x16x32_bf16 v[92:95], v[224:227], a[112:115], v[92:95]
  ds_read_b64_tr_b16 v[250:251], v170 offset:4608
  v_mfma_f32_16x16x32_bf16 v[92:95], v[220:223], a[108:111], v[92:95]
  s_waitcnt lgkmcnt(4)
  ds_read_b64_tr_b16 v[252:253], v170 offset:8192
  ds_read_b64_tr_b16 v[254:255], v170 offset:8704
  v_mfma_f32_16x16x32_bf16 v[100:103], v[232:235], a[108:111], v[100:103]
  s_mov_b32 s23, s25
  ds_read_b64_tr_b16 v[220:221], v171 offset:0
  v_mfma_f32_16x16x32_bf16 v[100:103], v[236:239], a[112:115], v[100:103]
  s_add_u32 m0, s22, 0
  ds_read_b64_tr_b16 v[222:223], v171 offset:512
  v_mfma_f32_16x16x32_bf16 v[100:103], v[240:243], a[116:119], v[100:103]
  buffer_load_dwordx4 v181, s[48:51], s23 offen sc1 lds
  v_mfma_f32_16x16x32_bf16 v[96:99], v[240:243], a[44:47], v[96:99]
  s_add_u32 s23, s23, 4096
  ds_read_b64_tr_b16 v[224:225], v171 offset:4096
  v_mfma_f32_16x16x32_bf16 v[96:99], v[236:239], a[40:43], v[96:99]
  ds_read_b64_tr_b16 v[226:227], v171 offset:4608
  v_mfma_f32_16x16x32_bf16 v[96:99], v[232:235], a[36:39], v[96:99]
  s_waitcnt lgkmcnt(4)
  ds_read_b64_tr_b16 v[228:229], v171 offset:8192
  ds_read_b64_tr_b16 v[230:231], v171 offset:8704
  v_mfma_f32_16x16x32_bf16 v[104:107], v[244:247], a[36:39], v[104:107]
  ds_read_b64_tr_b16 v[232:233], v168 offset:12288
  v_mfma_f32_16x16x32_bf16 v[104:107], v[248:251], a[40:43], v[104:107]
  s_add_u32 m0, s22, 4096
  ds_read_b64_tr_b16 v[234:235], v168 offset:12800
  v_mfma_f32_16x16x32_bf16 v[104:107], v[252:255], a[44:47], v[104:107]
  buffer_load_dwordx4 v181, s[48:51], s23 offen sc1 lds
  v_mfma_f32_16x16x32_bf16 v[108:111], v[252:255], a[116:119], v[108:111]
  s_add_u32 s23, s23, 4096
  ds_read_b64_tr_b16 v[236:237], v168 offset:16384
  v_mfma_f32_16x16x32_bf16 v[108:111], v[248:251], a[112:115], v[108:111]
  ds_read_b64_tr_b16 v[238:239], v168 offset:16896
  v_mfma_f32_16x16x32_bf16 v[108:111], v[244:247], a[108:111], v[108:111]
  s_waitcnt lgkmcnt(4)
  ds_read_b64_tr_b16 v[240:241], v168 offset:20480
  ds_read_b64_tr_b16 v[242:243], v168 offset:20992
  v_mfma_f32_16x16x32_bf16 v[116:119], v[220:223], a[108:111], v[116:119]
  ds_read_b64_tr_b16 v[244:245], v169 offset:12288
  v_mfma_f32_16x16x32_bf16 v[116:119], v[224:227], a[112:115], v[116:119]
  s_add_u32 m0, s22, 8192
  ds_read_b64_tr_b16 v[246:247], v169 offset:12800
  v_mfma_f32_16x16x32_bf16 v[116:119], v[228:231], a[116:119], v[116:119]
  buffer_load_dwordx4 v181, s[48:51], s23 offen sc1 lds
  v_mfma_f32_16x16x32_bf16 v[112:115], v[228:231], a[44:47], v[112:115]
  s_add_u32 s23, s23, 4096
  ds_read_b64_tr_b16 v[248:249], v169 offset:16384
  v_mfma_f32_16x16x32_bf16 v[112:115], v[224:227], a[40:43], v[112:115]
  ds_read_b64_tr_b16 v[250:251], v169 offset:16896
  v_mfma_f32_16x16x32_bf16 v[112:115], v[220:223], a[36:39], v[112:115]
  s_waitcnt lgkmcnt(4)
  ds_read_b64_tr_b16 v[252:253], v169 offset:20480
  ds_read_b64_tr_b16 v[254:255], v169 offset:20992
  v_mfma_f32_16x16x32_bf16 v[88:91], v[232:235], a[48:51], v[88:91]
  ds_read_b64_tr_b16 v[220:221], v170 offset:12288
  v_mfma_f32_16x16x32_bf16 v[88:91], v[236:239], a[52:55], v[88:91]
  ds_read_b64_tr_b16 v[222:223], v170 offset:12800
  v_mfma_f32_16x16x32_bf16 v[88:91], v[240:243], a[56:59], v[88:91]
  buffer_store_dwordx4 v[48:51], v185, s[48:51], s31 offen offset:0 sc1
  v_mfma_f32_16x16x32_bf16 v[92:95], v[240:243], a[128:131], v[92:95]
  ds_read_b64_tr_b16 v[224:225], v170 offset:16384
  v_mfma_f32_16x16x32_bf16 v[92:95], v[236:239], a[124:127], v[92:95]
  ds_read_b64_tr_b16 v[226:227], v170 offset:16896
  v_mfma_f32_16x16x32_bf16 v[92:95], v[232:235], a[120:123], v[92:95]
  s_waitcnt lgkmcnt(4)
  ds_read_b64_tr_b16 v[228:229], v170 offset:20480
  ds_read_b64_tr_b16 v[230:231], v170 offset:20992
  v_mfma_f32_16x16x32_bf16 v[100:103], v[244:247], a[120:123], v[100:103]
  s_nop 0
  ds_read_b64_tr_b16 v[232:233], v171 offset:12288
  ds_read_b64_tr_b16 v[234:235], v171 offset:12800
  v_mfma_f32_16x16x32_bf16 v[100:103], v[248:251], a[124:127], v[100:103]
  s_add_u32 m0, s22, 12288
  ds_read_b64_tr_b16 v[236:237], v171 offset:16384
  v_mfma_f32_16x16x32_bf16 v[100:103], v[252:255], a[128:131], v[100:103]
  buffer_load_dwordx4 v181, s[48:51], s23 offen sc1 lds
  v_mfma_f32_16x16x32_bf16 v[96:99], v[252:255], a[56:59], v[96:99]
  s_add_u32 s23, s23, 4096
  ds_read_b64_tr_b16 v[238:239], v171 offset:16896
  v_mfma_f32_16x16x32_bf16 v[96:99], v[248:251], a[52:55], v[96:99]
  buffer_store_dwordx4 v[52:55], v185, s[48:51], s31 offen offset:1024 sc1
  v_mfma_f32_16x16x32_bf16 v[96:99], v[244:247], a[48:51], v[96:99]
  s_waitcnt lgkmcnt(4)
  ds_read_b64_tr_b16 v[240:241], v171 offset:20480
  ds_read_b64_tr_b16 v[242:243], v171 offset:20992
  v_mfma_f32_16x16x32_bf16 v[104:107], v[220:223], a[48:51], v[104:107]
  s_nop 0
  ds_read_b64_tr_b16 v[244:245], v168 offset:24576
  ds_read_b64_tr_b16 v[246:247], v168 offset:25088
  v_mfma_f32_16x16x32_bf16 v[104:107], v[224:227], a[52:55], v[104:107]
  s_add_u32 m0, s22, 16384
  ds_read_b64_tr_b16 v[248:249], v168 offset:28672
  v_mfma_f32_16x16x32_bf16 v[104:107], v[228:231], a[56:59], v[104:107]
  buffer_load_dwordx4 v181, s[48:51], s23 offen sc1 lds
  v_mfma_f32_16x16x32_bf16 v[108:111], v[228:231], a[128:131], v[108:111]
  s_add_u32 s23, s23, 4096
  ds_read_b64_tr_b16 v[250:251], v168 offset:29184
  v_mfma_f32_16x16x32_bf16 v[108:111], v[224:227], a[124:127], v[108:111]
  buffer_store_dwordx4 v[56:59], v185, s[48:51], s31 offen offset:2048 sc1
  v_mfma_f32_16x16x32_bf16 v[108:111], v[220:223], a[120:123], v[108:111]
  s_waitcnt lgkmcnt(4)
  ds_read_b64_tr_b16 v[252:253], v168 offset:32768
  ds_read_b64_tr_b16 v[254:255], v168 offset:33280
  v_mfma_f32_16x16x32_bf16 v[116:119], v[232:235], a[120:123], v[116:119]
  ds_read_b64_tr_b16 v[220:221], v169 offset:24576
  v_add_u32 v168, 73728, v172
  v_mfma_f32_16x16x32_bf16 v[116:119], v[236:239], a[124:127], v[116:119]
  s_add_u32 m0, s22, 20480
  ds_read_b64_tr_b16 v[222:223], v169 offset:25088
  v_mfma_f32_16x16x32_bf16 v[116:119], v[240:243], a[128:131], v[116:119]
  buffer_load_dwordx4 v181, s[48:51], s23 offen sc1 lds
  v_mfma_f32_16x16x32_bf16 v[112:115], v[240:243], a[56:59], v[112:115]
  s_add_u32 s23, s23, 4096
  ds_read_b64_tr_b16 v[224:225], v169 offset:28672
  v_mfma_f32_16x16x32_bf16 v[112:115], v[236:239], a[52:55], v[112:115]
  ds_read_b64_tr_b16 v[226:227], v169 offset:29184
  v_mfma_f32_16x16x32_bf16 v[112:115], v[232:235], a[48:51], v[112:115]
  s_waitcnt lgkmcnt(4)
  ds_read_b64_tr_b16 v[228:229], v169 offset:32768
  ds_read_b64_tr_b16 v[230:231], v169 offset:33280
  v_mfma_f32_16x16x32_bf16 v[88:91], v[244:247], a[60:63], v[88:91]
  ds_read_b64_tr_b16 v[232:233], v170 offset:24576
  v_add_u32 v169, 73728, v173
  v_mfma_f32_16x16x32_bf16 v[88:91], v[248:251], a[64:67], v[88:91]
  ds_read_b64_tr_b16 v[234:235], v170 offset:25088
  v_mfma_f32_16x16x32_bf16 v[88:91], v[252:255], a[68:71], v[88:91]
  buffer_store_dwordx4 v[60:63], v185, s[48:51], s31 offen offset:3072 sc1
  v_mfma_f32_16x16x32_bf16 v[92:95], v[252:255], a[140:143], v[92:95]
  s_add_u32 s31, s31, 4096
  ds_read_b64_tr_b16 v[236:237], v170 offset:28672
  v_mfma_f32_16x16x32_bf16 v[92:95], v[248:251], a[136:139], v[92:95]
  ds_read_b64_tr_b16 v[238:239], v170 offset:29184
  v_mfma_f32_16x16x32_bf16 v[92:95], v[244:247], a[132:135], v[92:95]
  s_waitcnt lgkmcnt(4)
  ds_read_b64_tr_b16 v[240:241], v170 offset:32768
  ds_read_b64_tr_b16 v[242:243], v170 offset:33280
  v_mfma_f32_16x16x32_bf16 v[100:103], v[220:223], a[132:135], v[100:103]
  ds_read_b64_tr_b16 v[244:245], v171 offset:24576
  v_add_u32 v170, 73728, v174
  v_mfma_f32_16x16x32_bf16 v[100:103], v[224:227], a[136:139], v[100:103]
  s_add_u32 m0, s22, 24576
  ds_read_b64_tr_b16 v[246:247], v171 offset:25088
  v_mfma_f32_16x16x32_bf16 v[100:103], v[228:231], a[140:143], v[100:103]
  buffer_load_dwordx4 v181, s[48:51], s23 offen sc1 lds
  v_mfma_f32_16x16x32_bf16 v[96:99], v[228:231], a[68:71], v[96:99]
  s_add_u32 s23, s23, 4096
  ds_read_b64_tr_b16 v[248:249], v171 offset:28672
  v_max_f32 v188, 0, v88
  v_mfma_f32_16x16x32_bf16 v[96:99], v[224:227], a[64:67], v[96:99]
  ds_read_b64_tr_b16 v[250:251], v171 offset:29184
  v_max_f32 v189, 0, v89
  v_mfma_f32_16x16x32_bf16 v[96:99], v[220:223], a[60:63], v[96:99]
  s_waitcnt lgkmcnt(4)
  ds_read_b64_tr_b16 v[252:253], v171 offset:32768
  ds_read_b64_tr_b16 v[254:255], v171 offset:33280
  v_mfma_f32_16x16x32_bf16 v[104:107], v[232:235], a[60:63], v[104:107]
  ds_read_b64_tr_b16 v[220:221], v168 offset:0
  v_add_u32 v171, 73728, v175
  v_mfma_f32_16x16x32_bf16 v[104:107], v[236:239], a[64:67], v[104:107]
  s_add_u32 m0, s22, 28672
  ds_read_b64_tr_b16 v[222:223], v168 offset:512
  v_max_f32 v190, 0, v90
  v_mfma_f32_16x16x32_bf16 v[104:107], v[240:243], a[68:71], v[104:107]
  buffer_load_dwordx4 v181, s[48:51], s23 offen sc1 lds
  v_mfma_f32_16x16x32_bf16 v[108:111], v[240:243], a[140:143], v[108:111]
  s_add_u32 s23, s23, 4096
  ds_read_b64_tr_b16 v[224:225], v168 offset:4096
  v_max_f32 v191, 0, v91
  v_mfma_f32_16x16x32_bf16 v[108:111], v[236:239], a[136:139], v[108:111]
  ds_read_b64_tr_b16 v[226:227], v168 offset:4608
  v_max_f32 v192, 0, v92
  v_mfma_f32_16x16x32_bf16 v[108:111], v[232:235], a[132:135], v[108:111]
  s_waitcnt lgkmcnt(4)
  ds_read_b64_tr_b16 v[228:229], v168 offset:8192
  ds_read_b64_tr_b16 v[230:231], v168 offset:8704
  v_mfma_f32_16x16x32_bf16 v[116:119], v[244:247], a[132:135], v[116:119]
  ds_read_b64_tr_b16 v[232:233], v169 offset:0
  v_max_f32 v193, 0, v93
  v_mfma_f32_16x16x32_bf16 v[116:119], v[248:251], a[136:139], v[116:119]
  s_add_u32 m0, s22, 32768
  ds_read_b64_tr_b16 v[234:235], v169 offset:512
  v_max_f32 v194, 0, v94
  v_mfma_f32_16x16x32_bf16 v[116:119], v[252:255], a[140:143], v[116:119]
  buffer_load_dwordx4 v181, s[48:51], s23 offen sc1 lds
  v_mfma_f32_16x16x32_bf16 v[112:115], v[252:255], a[68:71], v[112:115]
  s_add_u32 s23, s23, 4096
  ds_read_b64_tr_b16 v[236:237], v169 offset:4096
  v_max_f32 v195, 0, v95
  v_mfma_f32_16x16x32_bf16 v[112:115], v[248:251], a[64:67], v[112:115]
  ds_read_b64_tr_b16 v[238:239], v169 offset:4608
  v_max_f32 v196, 0, v96
  v_mfma_f32_16x16x32_bf16 v[112:115], v[244:247], a[60:63], v[112:115]
  s_waitcnt lgkmcnt(4)
  ds_read_b64_tr_b16 v[240:241], v169 offset:8192
  ds_read_b64_tr_b16 v[242:243], v169 offset:8704
  v_mfma_f32_16x16x32_bf16 v[120:123], v[220:223], a[0:3], 0
  ds_read_b64_tr_b16 v[244:245], v170 offset:0
  v_max_f32 v197, 0, v97
  v_mfma_f32_16x16x32_bf16 v[120:123], v[224:227], a[4:7], v[120:123]
  s_waitcnt vmcnt(23)
  ds_read_b64_tr_b16 v[246:247], v170 offset:512
  v_max_f32 v198, 0, v98
  v_mfma_f32_16x16x32_bf16 v[120:123], v[228:231], a[8:11], v[120:123]
  s_barrier
  v_mfma_f32_16x16x32_bf16 v[124:127], v[228:231], a[80:83], 0
  ds_read_b64_tr_b16 v[248:249], v170 offset:4096
  v_max_f32 v199, 0, v99
  v_mfma_f32_16x16x32_bf16 v[124:127], v[224:227], a[76:79], v[124:127]
  ds_read_b64_tr_b16 v[250:251], v170 offset:4608
  v_max_f32 v200, 0, v100
  v_mfma_f32_16x16x32_bf16 v[124:127], v[220:223], a[72:75], v[124:127]
  s_waitcnt lgkmcnt(4)
  ds_read_b64_tr_b16 v[252:253], v170 offset:8192
  ds_read_b64_tr_b16 v[254:255], v170 offset:8704
  v_mfma_f32_16x16x32_bf16 v[132:135], v[232:235], a[72:75], 0
  ds_read_b64_tr_b16 v[220:221], v171 offset:0
  v_max_f32 v201, 0, v101
  v_mfma_f32_16x16x32_bf16 v[132:135], v[236:239], a[76:79], v[132:135]
  s_add_u32 m0, s22, 36864
  ds_read_b64_tr_b16 v[222:223], v171 offset:512
  v_max_f32 v202, 0, v102
  v_mfma_f32_16x16x32_bf16 v[132:135], v[240:243], a[80:83], v[132:135]
  buffer_load_dwordx4 v181, s[48:51], s23 offen sc1 lds
  v_mfma_f32_16x16x32_bf16 v[128:131], v[240:243], a[8:11], 0
  s_add_u32 s23, s23, 4096
  ds_read_b64_tr_b16 v[224:225], v171 offset:4096
  v_max_f32 v203, 0, v103
  v_mfma_f32_16x16x32_bf16 v[128:131], v[236:239], a[4:7], v[128:131]
  ds_read_b64_tr_b16 v[226:227], v171 offset:4608
  v_max_f32 v204, 0, v104
  v_mfma_f32_16x16x32_bf16 v[128:131], v[232:235], a[0:3], v[128:131]
  s_waitcnt lgkmcnt(4)
  ds_read_b64_tr_b16 v[228:229], v171 offset:8192
  ds_read_b64_tr_b16 v[230:231], v171 offset:8704
  v_mfma_f32_16x16x32_bf16 v[136:139], v[244:247], a[0:3], 0
  ds_read_b64_tr_b16 v[232:233], v168 offset:12288
  v_max_f32 v205, 0, v105
  v_mfma_f32_16x16x32_bf16 v[136:139], v[248:251], a[4:7], v[136:139]
  s_add_u32 m0, s22, 40960
  ds_read_b64_tr_b16 v[234:235], v168 offset:12800
  v_max_f32 v206, 0, v106
  v_mfma_f32_16x16x32_bf16 v[136:139], v[252:255], a[8:11], v[136:139]
  buffer_load_dwordx4 v181, s[48:51], s23 offen sc1 lds
  v_mfma_f32_16x16x32_bf16 v[140:143], v[252:255], a[80:83], 0
  s_add_u32 s23, s23, 4096
  ds_read_b64_tr_b16 v[236:237], v168 offset:16384
  v_max_f32 v207, 0, v107
  v_mfma_f32_16x16x32_bf16 v[140:143], v[248:251], a[76:79], v[140:143]
  ds_read_b64_tr_b16 v[238:239], v168 offset:16896
  v_max_f32 v208, 0, v108
  v_mfma_f32_16x16x32_bf16 v[140:143], v[244:247], a[72:75], v[140:143]
  s_waitcnt lgkmcnt(4)
  ds_read_b64_tr_b16 v[240:241], v168 offset:20480
  ds_read_b64_tr_b16 v[242:243], v168 offset:20992
  v_mfma_f32_16x16x32_bf16 v[148:151], v[220:223], a[72:75], 0
  ds_read_b64_tr_b16 v[244:245], v169 offset:12288
  v_max_f32 v209, 0, v109
  v_mfma_f32_16x16x32_bf16 v[148:151], v[224:227], a[76:79], v[148:151]
  s_add_u32 m0, s22, 45056
  ds_read_b64_tr_b16 v[246:247], v169 offset:12800
  v_max_f32 v210, 0, v110
  v_mfma_f32_16x16x32_bf16 v[148:151], v[228:231], a[80:83], v[148:151]
  buffer_load_dwordx4 v181, s[48:51], s23 offen sc1 lds
  v_mfma_f32_16x16x32_bf16 v[144:147], v[228:231], a[8:11], 0
  s_add_u32 s23, s23, 4096
  ds_read_b64_tr_b16 v[248:249], v169 offset:16384
  v_max_f32 v211, 0, v111
  v_mfma_f32_16x16x32_bf16 v[144:147], v[224:227], a[4:7], v[144:147]
  ds_read_b64_tr_b16 v[250:251], v169 offset:16896
  v_max_f32 v212, 0, v112
  v_mfma_f32_16x16x32_bf16 v[144:147], v[220:223], a[0:3], v[144:147]
  s_waitcnt lgkmcnt(4)
  ds_read_b64_tr_b16 v[252:253], v169 offset:20480
  ds_read_b64_tr_b16 v[254:255], v169 offset:20992
  v_mfma_f32_16x16x32_bf16 v[120:123], v[232:235], a[12:15], v[120:123]
  ds_read_b64_tr_b16 v[220:221], v170 offset:12288
  v_max_f32 v213, 0, v113
  v_mfma_f32_16x16x32_bf16 v[120:123], v[236:239], a[16:19], v[120:123]
  ds_read_b64_tr_b16 v[222:223], v170 offset:12800
  v_max_f32 v214, 0, v114
  v_mfma_f32_16x16x32_bf16 v[120:123], v[240:243], a[20:23], v[120:123]
  v_mfma_f32_16x16x32_bf16 v[124:127], v[240:243], a[92:95], v[124:127]
  ds_read_b64_tr_b16 v[224:225], v170 offset:16384
  v_max_f32 v215, 0, v115
  v_mfma_f32_16x16x32_bf16 v[124:127], v[236:239], a[88:91], v[124:127]
  ds_read_b64_tr_b16 v[226:227], v170 offset:16896
  v_max_f32 v216, 0, v116
  v_mfma_f32_16x16x32_bf16 v[124:127], v[232:235], a[84:87], v[124:127]
  s_waitcnt lgkmcnt(4)
  ds_read_b64_tr_b16 v[228:229], v170 offset:20480
  ds_read_b64_tr_b16 v[230:231], v170 offset:20992
  v_mfma_f32_16x16x32_bf16 v[132:135], v[244:247], a[84:87], v[132:135]
  ds_read_b64_tr_b16 v[232:233], v171 offset:12288
  v_max_f32 v217, 0, v117
  v_mfma_f32_16x16x32_bf16 v[132:135], v[248:251], a[88:91], v[132:135]
  s_add_u32 m0, s22, 49152
  ds_read_b64_tr_b16 v[234:235], v171 offset:12800
  v_max_f32 v218, 0, v118
  v_mfma_f32_16x16x32_bf16 v[132:135], v[252:255], a[92:95], v[132:135]
  buffer_load_dwordx4 v181, s[48:51], s23 offen sc1 lds
  v_mfma_f32_16x16x32_bf16 v[128:131], v[252:255], a[20:23], v[128:131]
  s_add_u32 s23, s23, 4096
  ds_read_b64_tr_b16 v[236:237], v171 offset:16384
  v_max_f32 v219, 0, v119
  v_mfma_f32_16x16x32_bf16 v[128:131], v[248:251], a[16:19], v[128:131]
  ds_read_b64_tr_b16 v[238:239], v171 offset:16896
  v_mfma_f32_16x16x32_bf16 v[128:131], v[244:247], a[12:15], v[128:131]
  s_waitcnt lgkmcnt(4)
  ds_read_b64_tr_b16 v[240:241], v171 offset:20480
  ds_read_b64_tr_b16 v[242:243], v171 offset:20992
  v_mfma_f32_16x16x32_bf16 v[136:139], v[220:223], a[12:15], v[136:139]
  ds_read_b64_tr_b16 v[244:245], v168 offset:24576
  v_mfma_f32_16x16x32_bf16 v[136:139], v[224:227], a[16:19], v[136:139]
  s_add_u32 m0, s22, 53248
  ds_read_b64_tr_b16 v[246:247], v168 offset:25088
  v_mfma_f32_16x16x32_bf16 v[136:139], v[228:231], a[20:23], v[136:139]
  buffer_load_dwordx4 v181, s[48:51], s23 offen sc1 lds
  v_mfma_f32_16x16x32_bf16 v[140:143], v[228:231], a[92:95], v[140:143]
  s_add_u32 s23, s23, 4096
  ds_read_b64_tr_b16 v[248:249], v168 offset:28672
  v_mfma_f32_16x16x32_bf16 v[140:143], v[224:227], a[88:91], v[140:143]
  ds_read_b64_tr_b16 v[250:251], v168 offset:29184
  v_mfma_f32_16x16x32_bf16 v[140:143], v[220:223], a[84:87], v[140:143]
  s_waitcnt lgkmcnt(4)
  ds_read_b64_tr_b16 v[252:253], v168 offset:32768
  ds_read_b64_tr_b16 v[254:255], v168 offset:33280
  v_mfma_f32_16x16x32_bf16 v[148:151], v[232:235], a[84:87], v[148:151]
  ds_read_b64_tr_b16 v[220:221], v169 offset:24576
  v_add_u32 v168, 110592, v172
  v_mfma_f32_16x16x32_bf16 v[148:151], v[236:239], a[88:91], v[148:151]
  s_add_u32 m0, s22, 57344
  ds_read_b64_tr_b16 v[222:223], v169 offset:25088
  v_mfma_f32_16x16x32_bf16 v[148:151], v[240:243], a[92:95], v[148:151]
  buffer_load_dwordx4 v181, s[48:51], s23 offen sc1 lds
  v_mfma_f32_16x16x32_bf16 v[144:147], v[240:243], a[20:23], v[144:147]
  s_add_u32 s23, s23, 4096
  ds_read_b64_tr_b16 v[224:225], v169 offset:28672
  v_mfma_f32_16x16x32_bf16 v[144:147], v[236:239], a[16:19], v[144:147]
  ds_read_b64_tr_b16 v[226:227], v169 offset:29184
  v_mfma_f32_16x16x32_bf16 v[144:147], v[232:235], a[12:15], v[144:147]
  s_waitcnt lgkmcnt(4)
  ds_read_b64_tr_b16 v[228:229], v169 offset:32768
  ds_read_b64_tr_b16 v[230:231], v169 offset:33280
  v_mfma_f32_16x16x32_bf16 v[120:123], v[244:247], a[24:27], v[120:123]
  ds_read_b64_tr_b16 v[232:233], v170 offset:24576
  v_add_u32 v169, 110592, v173
  v_mfma_f32_16x16x32_bf16 v[120:123], v[248:251], a[28:31], v[120:123]
  s_waitcnt vmcnt(9)
  ds_read_b64_tr_b16 v[234:235], v170 offset:25088
  v_mfma_f32_16x16x32_bf16 v[120:123], v[252:255], a[32:35], v[120:123]
  buffer_store_dword v14, v186, s[48:51], s34 offen offset:128 sc1
  v_mfma_f32_16x16x32_bf16 v[124:127], v[252:255], a[104:107], v[124:127]
  ds_read_b64_tr_b16 v[236:237], v170 offset:28672
  v_mfma_f32_16x16x32_bf16 v[124:127], v[248:251], a[100:103], v[124:127]
  ds_read_b64_tr_b16 v[238:239], v170 offset:29184
  v_mfma_f32_16x16x32_bf16 v[124:127], v[244:247], a[96:99], v[124:127]
  s_waitcnt lgkmcnt(4)
  ds_read_b64_tr_b16 v[240:241], v170 offset:32768
  ds_read_b64_tr_b16 v[242:243], v170 offset:33280
  v_mfma_f32_16x16x32_bf16 v[132:135], v[220:223], a[96:99], v[132:135]
  ds_read_b64_tr_b16 v[244:245], v171 offset:24576
  v_add_u32 v170, 110592, v174
  v_mfma_f32_16x16x32_bf16 v[132:135], v[224:227], a[100:103], v[132:135]
  s_add_u32 m0, s22, 61440
  ds_read_b64_tr_b16 v[246:247], v171 offset:25088
  v_mfma_f32_16x16x32_bf16 v[132:135], v[228:231], a[104:107], v[132:135]
  buffer_load_dwordx4 v181, s[48:51], s23 offen sc1 lds
  v_mfma_f32_16x16x32_bf16 v[128:131], v[228:231], a[32:35], v[128:131]
  s_add_u32 s23, s23, 4096
  ds_read_b64_tr_b16 v[248:249], v171 offset:28672
  v_mfma_f32_16x16x32_bf16 v[128:131], v[224:227], a[28:31], v[128:131]
  ds_read_b64_tr_b16 v[250:251], v171 offset:29184
  v_mfma_f32_16x16x32_bf16 v[128:131], v[220:223], a[24:27], v[128:131]
  s_waitcnt lgkmcnt(4)
  ds_read_b64_tr_b16 v[252:253], v171 offset:32768
  ds_read_b64_tr_b16 v[254:255], v171 offset:33280
  v_mfma_f32_16x16x32_bf16 v[136:139], v[232:235], a[24:27], v[136:139]
  ds_read_b64_tr_b16 v[220:221], v168 offset:0
  v_add_u32 v171, 110592, v175
  v_mfma_f32_16x16x32_bf16 v[136:139], v[236:239], a[28:31], v[136:139]
  s_add_u32 m0, s22, 65536
  ds_read_b64_tr_b16 v[222:223], v168 offset:512
  v_mfma_f32_16x16x32_bf16 v[136:139], v[240:243], a[32:35], v[136:139]
  buffer_load_dwordx4 v181, s[48:51], s23 offen sc1 lds
  v_mfma_f32_16x16x32_bf16 v[140:143], v[240:243], a[104:107], v[140:143]
  s_add_u32 s23, s23, 4096
  ds_read_b64_tr_b16 v[224:225], v168 offset:4096
  v_mfma_f32_16x16x32_bf16 v[140:143], v[236:239], a[100:103], v[140:143]
  ds_read_b64_tr_b16 v[226:227], v168 offset:4608
  v_mfma_f32_16x16x32_bf16 v[140:143], v[232:235], a[96:99], v[140:143]
  s_waitcnt lgkmcnt(4)
  ds_read_b64_tr_b16 v[228:229], v168 offset:8192
  ds_read_b64_tr_b16 v[230:231], v168 offset:8704
  v_mfma_f32_16x16x32_bf16 v[148:151], v[244:247], a[96:99], v[148:151]
  ds_read_b64_tr_b16 v[232:233], v169 offset:0
  v_mfma_f32_16x16x32_bf16 v[148:151], v[248:251], a[100:103], v[148:151]
  s_add_u32 m0, s22, 69632
  ds_read_b64_tr_b16 v[234:235], v169 offset:512
  v_mfma_f32_16x16x32_bf16 v[148:151], v[252:255], a[104:107], v[148:151]
  buffer_load_dwordx4 v181, s[48:51], s23 offen sc1 lds
  v_mfma_f32_16x16x32_bf16 v[144:147], v[252:255], a[32:35], v[144:147]
  ds_read_b64_tr_b16 v[236:237], v169 offset:4096
  v_mfma_f32_16x16x32_bf16 v[144:147], v[248:251], a[28:31], v[144:147]
  ds_read_b64_tr_b16 v[238:239], v169 offset:4608
  v_mfma_f32_16x16x32_bf16 v[144:147], v[244:247], a[24:27], v[144:147]
  s_waitcnt lgkmcnt(4)
  ds_read_b64_tr_b16 v[240:241], v169 offset:8192
  ds_read_b64_tr_b16 v[242:243], v169 offset:8704
  v_mfma_f32_16x16x32_bf16 v[120:123], v[220:223], a[36:39], v[120:123]
  ds_read_b64_tr_b16 v[244:245], v170 offset:0
  v_mfma_f32_16x16x32_bf16 v[120:123], v[224:227], a[40:43], v[120:123]
  s_waitcnt vmcnt(20)
  ds_read_b64_tr_b16 v[246:247], v170 offset:512
  v_mfma_f32_16x16x32_bf16 v[120:123], v[228:231], a[44:47], v[120:123]
  s_barrier
  v_mfma_f32_16x16x32_bf16 v[124:127], v[228:231], a[116:119], v[124:127]
  ds_read_b64_tr_b16 v[248:249], v170 offset:4096
  v_mfma_f32_16x16x32_bf16 v[124:127], v[224:227], a[112:115], v[124:127]
  ds_read_b64_tr_b16 v[250:251], v170 offset:4608
  v_mfma_f32_16x16x32_bf16 v[124:127], v[220:223], a[108:111], v[124:127]
  s_waitcnt lgkmcnt(4)
  ds_read_b64_tr_b16 v[252:253], v170 offset:8192
  ds_read_b64_tr_b16 v[254:255], v170 offset:8704
  v_mfma_f32_16x16x32_bf16 v[132:135], v[232:235], a[108:111], v[132:135]
  s_add_u32 s23, s52, 512
  ds_read_b64_tr_b16 v[220:221], v171 offset:0
  v_mfma_f32_16x16x32_bf16 v[132:135], v[236:239], a[112:115], v[132:135]
  s_add_u32 m0, s22, 73728
  ds_read_b64_tr_b16 v[222:223], v171 offset:512
  v_mfma_f32_16x16x32_bf16 v[132:135], v[240:243], a[116:119], v[132:135]
  buffer_load_dwordx4 v182, s[44:47], s23 offen lds
  v_mfma_f32_16x16x32_bf16 v[128:131], v[240:243], a[44:47], v[128:131]
  s_add_u32 s23, s23, 36864
  ds_read_b64_tr_b16 v[224:225], v171 offset:4096
  v_mfma_f32_16x16x32_bf16 v[128:131], v[236:239], a[40:43], v[128:131]
  ds_read_b64_tr_b16 v[226:227], v171 offset:4608
  v_mfma_f32_16x16x32_bf16 v[128:131], v[232:235], a[36:39], v[128:131]
  s_waitcnt lgkmcnt(4)
  ds_read_b64_tr_b16 v[228:229], v171 offset:8192
  ds_read_b64_tr_b16 v[230:231], v171 offset:8704
  v_mfma_f32_16x16x32_bf16 v[136:139], v[244:247], a[36:39], v[136:139]
  ds_read_b64_tr_b16 v[232:233], v168 offset:12288
  v_mfma_f32_16x16x32_bf16 v[136:139], v[248:251], a[40:43], v[136:139]
  s_add_u32 m0, s22, 77824
  ds_read_b64_tr_b16 v[234:235], v168 offset:12800
  v_mfma_f32_16x16x32_bf16 v[136:139], v[252:255], a[44:47], v[136:139]
  buffer_load_dwordx4 v182, s[44:47], s23 offen lds
  v_mfma_f32_16x16x32_bf16 v[140:143], v[252:255], a[116:119], v[140:143]
  s_add_u32 s23, s23, 36864
  ds_read_b64_tr_b16 v[236:237], v168 offset:16384
  v_mfma_f32_16x16x32_bf16 v[140:143], v[248:251], a[112:115], v[140:143]
  ds_read_b64_tr_b16 v[238:239], v168 offset:16896
  v_mfma_f32_16x16x32_bf16 v[140:143], v[244:247], a[108:111], v[140:143]
  s_waitcnt lgkmcnt(4)
  ds_read_b64_tr_b16 v[240:241], v168 offset:20480
  ds_read_b64_tr_b16 v[242:243], v168 offset:20992
  v_mfma_f32_16x16x32_bf16 v[148:151], v[220:223], a[108:111], v[148:151]
  ds_read_b64_tr_b16 v[244:245], v169 offset:12288
  v_mfma_f32_16x16x32_bf16 v[148:151], v[224:227], a[112:115], v[148:151]
KB_I6:
  s_cbranch_execz KB_I9
  s_add_u32 m0, s22, 81920
  ds_read_b64_tr_b16 v[246:247], v169 offset:12800
  v_mfma_f32_16x16x32_bf16 v[148:151], v[228:231], a[116:119], v[148:151]
  buffer_load_dwordx4 v182, s[44:47], s23 offen lds
  v_mfma_f32_16x16x32_bf16 v[144:147], v[228:231], a[44:47], v[144:147]
  s_add_u32 s23, s23, 36864
  ds_read_b64_tr_b16 v[248:249], v169 offset:16384
  v_mfma_f32_16x16x32_bf16 v[144:147], v[224:227], a[40:43], v[144:147]
  ds_read_b64_tr_b16 v[250:251], v169 offset:16896
  v_mfma_f32_16x16x32_bf16 v[144:147], v[220:223], a[36:39], v[144:147]
  s_waitcnt lgkmcnt(4)
  ds_read_b64_tr_b16 v[252:253], v169 offset:20480
  ds_read_b64_tr_b16 v[254:255], v169 offset:20992
  v_mfma_f32_16x16x32_bf16 v[120:123], v[232:235], a[48:51], v[120:123]
  ds_read_b64_tr_b16 v[220:221], v170 offset:12288
  v_mfma_f32_16x16x32_bf16 v[120:123], v[236:239], a[52:55], v[120:123]
  ds_read_b64_tr_b16 v[222:223], v170 offset:12800
  v_mfma_f32_16x16x32_bf16 v[120:123], v[240:243], a[56:59], v[120:123]
  v_mfma_f32_16x16x32_bf16 v[124:127], v[240:243], a[128:131], v[124:127]
  ds_read_b64_tr_b16 v[224:225], v170 offset:16384
  v_mfma_f32_16x16x32_bf16 v[124:127], v[236:239], a[124:127], v[124:127]
  ds_read_b64_tr_b16 v[226:227], v170 offset:16896
  v_mfma_f32_16x16x32_bf16 v[124:127], v[232:235], a[120:123], v[124:127]
  s_waitcnt lgkmcnt(4)
  ds_read_b64_tr_b16 v[228:229], v170 offset:20480
  ds_read_b64_tr_b16 v[230:231], v170 offset:20992
  v_mfma_f32_16x16x32_bf16 v[132:135], v[244:247], a[120:123], v[132:135]
  ds_read_b64_tr_b16 v[232:233], v171 offset:12288
  v_mfma_f32_16x16x32_bf16 v[132:135], v[248:251], a[124:127], v[132:135]
  s_add_u32 m0, s22, 86016
  ds_read_b64_tr_b16 v[234:235], v171 offset:12800
  v_mfma_f32_16x16x32_bf16 v[132:135], v[252:255], a[128:131], v[132:135]
  buffer_load_dwordx4 v182, s[44:47], s23 offen lds
  v_mfma_f32_16x16x32_bf16 v[128:131], v[252:255], a[56:59], v[128:131]
  s_add_u32 s23, s23, 36864
  ds_read_b64_tr_b16 v[236:237], v171 offset:16384
  v_mfma_f32_16x16x32_bf16 v[128:131], v[248:251], a[52:55], v[128:131]
  ds_read_b64_tr_b16 v[238:239], v171 offset:16896
  v_mfma_f32_16x16x32_bf16 v[128:131], v[244:247], a[48:51], v[128:131]
  s_waitcnt lgkmcnt(4)
  ds_read_b64_tr_b16 v[240:241], v171 offset:20480
  ds_read_b64_tr_b16 v[242:243], v171 offset:20992
  v_mfma_f32_16x16x32_bf16 v[136:139], v[220:223], a[48:51], v[136:139]
  ds_read_b64_tr_b16 v[244:245], v168 offset:24576
  v_mfma_f32_16x16x32_bf16 v[136:139], v[224:227], a[52:55], v[136:139]
  s_add_u32 m0, s22, 90112
  ds_read_b64_tr_b16 v[246:247], v168 offset:25088
  v_mfma_f32_16x16x32_bf16 v[136:139], v[228:231], a[56:59], v[136:139]
  buffer_load_dwordx4 v182, s[44:47], s23 offen lds
  v_mfma_f32_16x16x32_bf16 v[140:143], v[228:231], a[128:131], v[140:143]
  s_add_u32 s23, s23, 36864
  ds_read_b64_tr_b16 v[248:249], v168 offset:28672
  v_mfma_f32_16x16x32_bf16 v[140:143], v[224:227], a[124:127], v[140:143]
  ds_read_b64_tr_b16 v[250:251], v168 offset:29184
  v_mfma_f32_16x16x32_bf16 v[140:143], v[220:223], a[120:123], v[140:143]
  s_waitcnt lgkmcnt(4)
  ds_read_b64_tr_b16 v[252:253], v168 offset:32768
  ds_read_b64_tr_b16 v[254:255], v168 offset:33280
  v_mfma_f32_16x16x32_bf16 v[148:151], v[232:235], a[120:123], v[148:151]
  ds_read_b64_tr_b16 v[220:221], v169 offset:24576
  v_add_u32 v168, 0, v172
  v_mfma_f32_16x16x32_bf16 v[148:151], v[236:239], a[124:127], v[148:151]
  s_add_u32 m0, s22, 94208
  ds_read_b64_tr_b16 v[222:223], v169 offset:25088
  v_mfma_f32_16x16x32_bf16 v[148:151], v[240:243], a[128:131], v[148:151]
  buffer_load_dwordx4 v182, s[44:47], s23 offen lds
  v_mfma_f32_16x16x32_bf16 v[144:147], v[240:243], a[56:59], v[144:147]
  s_add_u32 s23, s23, 36864
  ds_read_b64_tr_b16 v[224:225], v169 offset:28672
  v_mfma_f32_16x16x32_bf16 v[144:147], v[236:239], a[52:55], v[144:147]
  ds_read_b64_tr_b16 v[226:227], v169 offset:29184
  v_mfma_f32_16x16x32_bf16 v[144:147], v[232:235], a[48:51], v[144:147]
  s_waitcnt lgkmcnt(4)
  ds_read_b64_tr_b16 v[228:229], v169 offset:32768
  ds_read_b64_tr_b16 v[230:231], v169 offset:33280
  v_mfma_f32_16x16x32_bf16 v[120:123], v[244:247], a[60:63], v[120:123]
  ds_read_b64_tr_b16 v[232:233], v170 offset:24576
  v_add_u32 v169, 0, v173
  v_mfma_f32_16x16x32_bf16 v[120:123], v[248:251], a[64:67], v[120:123]
  ds_read_b64_tr_b16 v[234:235], v170 offset:25088
  v_mfma_f32_16x16x32_bf16 v[120:123], v[252:255], a[68:71], v[120:123]
  buffer_load_dword v15, v186, s[48:51], s35 offen offset:128 sc1
  v_mfma_f32_16x16x32_bf16 v[124:127], v[252:255], a[140:143], v[124:127]
  ds_read_b64_tr_b16 v[236:237], v170 offset:28672
  v_mfma_f32_16x16x32_bf16 v[124:127], v[248:251], a[136:139], v[124:127]
  ds_read_b64_tr_b16 v[238:239], v170 offset:29184
  v_mfma_f32_16x16x32_bf16 v[124:127], v[244:247], a[132:135], v[124:127]
  s_waitcnt lgkmcnt(4)
  ds_read_b64_tr_b16 v[240:241], v170 offset:32768
  ds_read_b64_tr_b16 v[242:243], v170 offset:33280
  v_mfma_f32_16x16x32_bf16 v[132:135], v[220:223], a[132:135], v[132:135]
  ds_read_b64_tr_b16 v[244:245], v171 offset:24576
  v_add_u32 v170, 0, v174
  v_mfma_f32_16x16x32_bf16 v[132:135], v[224:227], a[136:139], v[132:135]
  s_add_u32 m0, s22, 98304
  ds_read_b64_tr_b16 v[246:247], v171 offset:25088
  v_mfma_f32_16x16x32_bf16 v[132:135], v[228:231], a[140:143], v[132:135]
  buffer_load_dwordx4 v182, s[44:47], s23 offen lds
  v_mfma_f32_16x16x32_bf16 v[128:131], v[228:231], a[68:71], v[128:131]
  s_add_u32 s23, s23, 36864
  ds_read_b64_tr_b16 v[248:249], v171 offset:28672
  v_mul_f32 v120, v188, v120
  v_mfma_f32_16x16x32_bf16 v[128:131], v[224:227], a[64:67], v[128:131]
  ds_read_b64_tr_b16 v[250:251], v171 offset:29184
  v_mul_f32 v121, v189, v121
  v_mfma_f32_16x16x32_bf16 v[128:131], v[220:223], a[60:63], v[128:131]
  s_waitcnt lgkmcnt(4)
  ds_read_b64_tr_b16 v[252:253], v171 offset:32768
  ds_read_b64_tr_b16 v[254:255], v171 offset:33280
  v_mfma_f32_16x16x32_bf16 v[136:139], v[232:235], a[60:63], v[136:139]
  ds_read_b64_tr_b16 v[220:221], v168 offset:0
  v_add_u32 v171, 0, v175
  v_mfma_f32_16x16x32_bf16 v[136:139], v[236:239], a[64:67], v[136:139]
  s_add_u32 m0, s22, 102400
  ds_read_b64_tr_b16 v[222:223], v168 offset:512
  v_mul_f32 v122, v190, v122
  v_mfma_f32_16x16x32_bf16 v[136:139], v[240:243], a[68:71], v[136:139]
  buffer_load_dwordx4 v182, s[44:47], s23 offen lds
  v_mfma_f32_16x16x32_bf16 v[140:143], v[240:243], a[140:143], v[140:143]
  s_add_u32 s23, s23, s27
  ds_read_b64_tr_b16 v[224:225], v168 offset:4096
  v_mul_f32 v123, v191, v123
  v_mfma_f32_16x16x32_bf16 v[140:143], v[236:239], a[136:139], v[140:143]
  ds_read_b64_tr_b16 v[226:227], v168 offset:4608
  v_mul_f32 v124, v192, v124
  v_mfma_f32_16x16x32_bf16 v[140:143], v[232:235], a[132:135], v[140:143]
  s_waitcnt lgkmcnt(4)
  ds_read_b64_tr_b16 v[228:229], v168 offset:8192
  ds_read_b64_tr_b16 v[230:231], v168 offset:8704
  v_mfma_f32_16x16x32_bf16 v[148:151], v[244:247], a[132:135], v[148:151]
  ds_read_b64_tr_b16 v[232:233], v169 offset:0
  v_mul_f32 v125, v193, v125
  v_mfma_f32_16x16x32_bf16 v[148:151], v[248:251], a[136:139], v[148:151]
  s_add_u32 m0, s22, 106496
  ds_read_b64_tr_b16 v[234:235], v169 offset:512
  v_mul_f32 v126, v194, v126
  v_mfma_f32_16x16x32_bf16 v[148:151], v[252:255], a[140:143], v[148:151]
  buffer_load_dwordx4 v182, s[44:47], s23 offen lds
  v_mfma_f32_16x16x32_bf16 v[144:147], v[252:255], a[68:71], v[144:147]
  ds_read_b64_tr_b16 v[236:237], v169 offset:4096
  v_mul_f32 v127, v195, v127
  v_mfma_f32_16x16x32_bf16 v[144:147], v[248:251], a[64:67], v[144:147]
  ds_read_b64_tr_b16 v[238:239], v169 offset:4608
  v_cvt_pk_bf16_f32 v64, v120, v121
  v_mfma_f32_16x16x32_bf16 v[144:147], v[244:247], a[60:63], v[144:147]
  s_waitcnt lgkmcnt(4)
  ds_read_b64_tr_b16 v[240:241], v169 offset:8192
  ds_read_b64_tr_b16 v[242:243], v169 offset:8704
  v_mfma_f32_16x16x32_bf16 v[88:91], v[220:223], a[0:3], 0
  ds_read_b64_tr_b16 v[244:245], v170 offset:0
  v_accvgpr_read_b32 v180, a240
  v_mfma_f32_16x16x32_bf16 v[88:91], v[224:227], a[4:7], v[88:91]
  s_waitcnt vmcnt(17)
  ds_read_b64_tr_b16 v[246:247], v170 offset:512
  v_accvgpr_read_b32 v181, a241
  v_mfma_f32_16x16x32_bf16 v[88:91], v[228:231], a[8:11], v[88:91]
  s_barrier
  v_mfma_f32_16x16x32_bf16 v[92:95], v[228:231], a[80:83], 0
  ds_read_b64_tr_b16 v[248:249], v170 offset:4096
  v_accvgpr_read_b32 v187, a242
  v_mfma_f32_16x16x32_bf16 v[92:95], v[224:227], a[76:79], v[92:95]
  ds_read_b64_tr_b16 v[250:251], v170 offset:4608
  v_cvt_pk_bf16_f32 v65, v122, v123
  v_mfma_f32_16x16x32_bf16 v[92:95], v[220:223], a[72:75], v[92:95]
  s_waitcnt lgkmcnt(4)
  ds_read_b64_tr_b16 v[252:253], v170 offset:8192
  ds_read_b64_tr_b16 v[254:255], v170 offset:8704
  v_mfma_f32_16x16x32_bf16 v[100:103], v[232:235], a[72:75], 0
  s_add_u32 s23, s26, 0
  ds_read_b64_tr_b16 v[220:221], v171 offset:0
  v_cvt_pk_bf16_f32 v68, v124, v125
  v_mfma_f32_16x16x32_bf16 v[100:103], v[236:239], a[76:79], v[100:103]
  s_add_u32 m0, s22, 110592
  ds_read_b64_tr_b16 v[222:223], v171 offset:512
  v_cvt_pk_bf16_f32 v69, v126, v127
  v_mfma_f32_16x16x32_bf16 v[100:103], v[240:243], a[80:83], v[100:103]
  buffer_load_dwordx4 v182, s[44:47], s23 offen lds
  v_mfma_f32_16x16x32_bf16 v[96:99], v[240:243], a[8:11], 0
  s_add_u32 s23, s23, 36864
  ds_read_b64_tr_b16 v[224:225], v171 offset:4096
  v_mul_f32 v128, v196, v128
  v_mfma_f32_16x16x32_bf16 v[96:99], v[236:239], a[4:7], v[96:99]
  ds_read_b64_tr_b16 v[226:227], v171 offset:4608
  v_mul_f32 v129, v197, v129
  v_mfma_f32_16x16x32_bf16 v[96:99], v[232:235], a[0:3], v[96:99]
  s_waitcnt lgkmcnt(4)
  ds_read_b64_tr_b16 v[228:229], v171 offset:8192
  ds_read_b64_tr_b16 v[230:231], v171 offset:8704
  v_mfma_f32_16x16x32_bf16 v[104:107], v[244:247], a[0:3], 0
  ds_read_b64_tr_b16 v[232:233], v168 offset:12288
  v_mul_f32 v130, v198, v130
  v_mfma_f32_16x16x32_bf16 v[104:107], v[248:251], a[4:7], v[104:107]
  s_add_u32 m0, s22, 114688
  ds_read_b64_tr_b16 v[234:235], v168 offset:12800
  v_mul_f32 v131, v199, v131
  v_mfma_f32_16x16x32_bf16 v[104:107], v[252:255], a[8:11], v[104:107]
  buffer_load_dwordx4 v182, s[44:47], s23 offen lds
  v_mfma_f32_16x16x32_bf16 v[108:111], v[252:255], a[80:83], 0
  s_add_u32 s23, s23, 36864
  ds_read_b64_tr_b16 v[236:237], v168 offset:16384
  v_mul_f32 v132, v200, v132
  v_mfma_f32_16x16x32_bf16 v[108:111], v[248:251], a[76:79], v[108:111]
  ds_read_b64_tr_b16 v[238:239], v168 offset:16896
  v_mul_f32 v133, v201, v133
  v_mfma_f32_16x16x32_bf16 v[108:111], v[244:247], a[72:75], v[108:111]
  s_waitcnt lgkmcnt(4)
  ds_read_b64_tr_b16 v[240:241], v168 offset:20480
  ds_read_b64_tr_b16 v[242:243], v168 offset:20992
  v_mfma_f32_16x16x32_bf16 v[116:119], v[220:223], a[72:75], 0
  ds_read_b64_tr_b16 v[244:245], v169 offset:12288
  v_mul_f32 v134, v202, v134
  v_mfma_f32_16x16x32_bf16 v[116:119], v[224:227], a[76:79], v[116:119]
  s_add_u32 m0, s22, 118784
  ds_read_b64_tr_b16 v[246:247], v169 offset:12800
  v_mul_f32 v135, v203, v135
  v_mfma_f32_16x16x32_bf16 v[116:119], v[228:231], a[80:83], v[116:119]
  buffer_load_dwordx4 v182, s[44:47], s23 offen lds
  v_mfma_f32_16x16x32_bf16 v[112:115], v[228:231], a[8:11], 0
  s_add_u32 s23, s23, 36864
  ds_read_b64_tr_b16 v[248:249], v169 offset:16384
  v_cvt_pk_bf16_f32 v66, v128, v129
  v_mfma_f32_16x16x32_bf16 v[112:115], v[224:227], a[4:7], v[112:115]
  ds_read_b64_tr_b16 v[250:251], v169 offset:16896
  v_cvt_pk_bf16_f32 v67, v130, v131
  v_mfma_f32_16x16x32_bf16 v[112:115], v[220:223], a[0:3], v[112:115]
  s_waitcnt lgkmcnt(4)
  ds_read_b64_tr_b16 v[252:253], v169 offset:20480
  ds_read_b64_tr_b16 v[254:255], v169 offset:20992
  v_mfma_f32_16x16x32_bf16 v[88:91], v[232:235], a[12:15], v[88:91]
  s_waitcnt vmcnt(6)
  ds_read_b64_tr_b16 v[220:221], v170 offset:12288
  v_cvt_pk_bf16_f32 v70, v132, v133
  v_mfma_f32_16x16x32_bf16 v[88:91], v[236:239], a[16:19], v[88:91]
  ds_read_b64_tr_b16 v[222:223], v170 offset:12800
  v_readfirstlane_b32 s53, v15
  v_mfma_f32_16x16x32_bf16 v[88:91], v[240:243], a[20:23], v[88:91]
  v_mfma_f32_16x16x32_bf16 v[92:95], v[240:243], a[92:95], v[92:95]
  s_cmp_eq_u32 s53, 1
  s_cbranch_scc0 KB_SLOW2
KB_RES2:
  ds_read_b64_tr_b16 v[224:225], v170 offset:16384
  v_mfma_f32_16x16x32_bf16 v[92:95], v[236:239], a[88:91], v[92:95]
  ds_read_b64_tr_b16 v[226:227], v170 offset:16896
  v_cvt_pk_bf16_f32 v71, v134, v135
  v_mfma_f32_16x16x32_bf16 v[92:95], v[232:235], a[84:87], v[92:95]
  s_waitcnt lgkmcnt(4)
  ds_read_b64_tr_b16 v[228:229], v170 offset:20480
  ds_read_b64_tr_b16 v[230:231], v170 offset:20992
  v_mfma_f32_16x16x32_bf16 v[100:103], v[244:247], a[84:87], v[100:103]
  s_nop 0
  ds_read_b64_tr_b16 v[232:233], v171 offset:12288
  ds_read_b64_tr_b16 v[234:235], v171 offset:12800
  v_mfma_f32_16x16x32_bf16 v[100:103], v[248:251], a[88:91], v[100:103]
  s_add_u32 m0, s22, 122880
  ds_read_b64_tr_b16 v[236:237], v171 offset:16384
  v_mul_f32 v136, v204, v136
  v_mfma_f32_16x16x32_bf16 v[100:103], v[252:255], a[92:95], v[100:103]
  buffer_load_dwordx4 v182, s[44:47], s23 offen lds
  v_mfma_f32_16x16x32_bf16 v[96:99], v[252:255], a[20:23], v[96:99]
  s_add_u32 s23, s23, 36864
  ds_read_b64_tr_b16 v[238:239], v171 offset:16896
  v_mul_f32 v137, v205, v137
  v_mfma_f32_16x16x32_bf16 v[96:99], v[248:251], a[16:19], v[96:99]
  buffer_load_dwordx4 a[176:179], v185, s[48:51], s32 offen offset:0 sc1
  v_mfma_f32_16x16x32_bf16 v[96:99], v[244:247], a[12:15], v[96:99]
  s_waitcnt lgkmcnt(4)
  ds_read_b64_tr_b16 v[240:241], v171 offset:20480
  ds_read_b64_tr_b16 v[242:243], v171 offset:20992
  v_mfma_f32_16x16x32_bf16 v[104:107], v[220:223], a[12:15], v[104:107]
  s_nop 0
  ds_read_b64_tr_b16 v[244:245], v168 offset:24576
  ds_read_b64_tr_b16 v[246:247], v168 offset:25088
  v_mfma_f32_16x16x32_bf16 v[104:107], v[224:227], a[16:19], v[104:107]
  s_add_u32 m0, s22, 126976
  ds_read_b64_tr_b16 v[248:249], v168 offset:28672
  v_mul_f32 v138, v206, v138
  v_mfma_f32_16x16x32_bf16 v[104:107], v[228:231], a[20:23], v[104:107]
  buffer_load_dwordx4 v182, s[44:47], s23 offen lds
  v_mfma_f32_16x16x32_bf16 v[108:111], v[228:231], a[92:95], v[108:111]
  s_add_u32 s23, s23, 36864
  ds_read_b64_tr_b16 v[250:251], v168 offset:29184
  v_mul_f32 v139, v207, v139
  v_mfma_f32_16x16x32_bf16 v[108:111], v[224:227], a[88:91], v[108:111]
  buffer_load_dwordx4 a[180:183], v185, s[48:51], s32 offen offset:1024 sc1
  v_mfma_f32_16x16x32_bf16 v[108:111], v[220:223], a[84:87], v[108:111]
  s_waitcnt lgkmcnt(4)
  ds_read_b64_tr_b16 v[252:253], v168 offset:32768
  ds_read_b64_tr_b16 v[254:255], v168 offset:33280
  v_mfma_f32_16x16x32_bf16 v[116:119], v[232:235], a[84:87], v[116:119]
  ds_read_b64_tr_b16 v[220:221], v169 offset:24576
  v_add_u32 v168, 36864, v172
  v_mfma_f32_16x16x32_bf16 v[116:119], v[236:239], a[88:91], v[116:119]
  s_add_u32 m0, s22, 131072
  ds_read_b64_tr_b16 v[222:223], v169 offset:25088
  v_mul_f32 v140, v208, v140
  v_mfma_f32_16x16x32_bf16 v[116:119], v[240:243], a[92:95], v[116:119]
  buffer_load_dwordx4 v182, s[44:47], s23 offen lds
  v_mfma_f32_16x16x32_bf16 v[112:115], v[240:243], a[20:23], v[112:115]
  s_add_u32 s23, s23, 36864
  ds_read_b64_tr_b16 v[224:225], v169 offset:28672
  v_mul_f32 v141, v209, v141
  v_mfma_f32_16x16x32_bf16 v[112:115], v[236:239], a[16:19], v[112:115]
  ds_read_b64_tr_b16 v[226:227], v169 offset:29184
  v_mul_f32 v142, v210, v142
  v_mfma_f32_16x16x32_bf16 v[112:115], v[232:235], a[12:15], v[112:115]
  s_waitcnt lgkmcnt(4)
  ds_read_b64_tr_b16 v[228:229], v169 offset:32768
  ds_read_b64_tr_b16 v[230:231], v169 offset:33280
  v_mfma_f32_16x16x32_bf16 v[88:91], v[244:247], a[24:27], v[88:91]
  ds_read_b64_tr_b16 v[232:233], v170 offset:24576
  v_add_u32 v169, 36864, v173
  v_mfma_f32_16x16x32_bf16 v[88:91], v[248:251], a[28:31], v[88:91]
  ds_read_b64_tr_b16 v[234:235], v170 offset:25088
  v_mul_f32 v143, v211, v143
  v_mfma_f32_16x16x32_bf16 v[88:91], v[252:255], a[32:35], v[88:91]
  buffer_load_dwordx4 a[184:187], v185, s[48:51], s32 offen offset:2048 sc1
  v_mfma_f32_16x16x32_bf16 v[92:95], v[252:255], a[104:107], v[92:95]
  ds_read_b64_tr_b16 v[236:237], v170 offset:28672
  v_cvt_pk_bf16_f32 v72, v136, v137
  v_mfma_f32_16x16x32_bf16 v[92:95], v[248:251], a[100:103], v[92:95]
  ds_read_b64_tr_b16 v[238:239], v170 offset:29184
  v_cvt_pk_bf16_f32 v73, v138, v139
  v_mfma_f32_16x16x32_bf16 v[92:95], v[244:247], a[96:99], v[92:95]
  s_waitcnt lgkmcnt(4)
  ds_read_b64_tr_b16 v[240:241], v170 offset:32768
  ds_read_b64_tr_b16 v[242:243], v170 offset:33280
  v_mfma_f32_16x16x32_bf16 v[100:103], v[220:223], a[96:99], v[100:103]
  s_nop 0
  ds_read_b64_tr_b16 v[244:245], v171 offset:24576
  ds_read_b64_tr_b16 v[246:247], v171 offset:25088
  v_mfma_f32_16x16x32_bf16 v[100:103], v[224:227], a[100:103], v[100:103]
  s_add_u32 m0, s22, 135168
  ds_read_b64_tr_b16 v[248:249], v171 offset:28672
  v_add_u32 v170, 36864, v174
  v_mfma_f32_16x16x32_bf16 v[100:103], v[228:231], a[104:107], v[100:103]
  buffer_load_dwordx4 v182, s[44:47], s23 offen lds
  v_mfma_f32_16x16x32_bf16 v[96:99], v[228:231], a[32:35], v[96:99]
  s_add_u32 s23, s23, 36864
  ds_read_b64_tr_b16 v[250:251], v171 offset:29184
  v_cvt_pk_bf16_f32 v76, v140, v141
  v_mfma_f32_16x16x32_bf16 v[96:99], v[224:227], a[28:31], v[96:99]
  buffer_load_dwordx4 a[188:191], v185, s[48:51], s32 offen offset:3072 sc1
  v_mfma_f32_16x16x32_bf16 v[96:99], v[220:223], a[24:27], v[96:99]
  s_waitcnt lgkmcnt(4)
  ds_read_b64_tr_b16 v[252:253], v171 offset:32768
  ds_read_b64_tr_b16 v[254:255], v171 offset:33280
  v_mfma_f32_16x16x32_bf16 v[104:107], v[232:235], a[24:27], v[104:107]
  s_add_u32 s32, s32, 4096
  ds_read_b64_tr_b16 v[220:221], v168 offset:0
  v_add_u32 v171, 36864, v175
  v_mfma_f32_16x16x32_bf16 v[104:107], v[236:239], a[28:31], v[104:107]
  s_add_u32 m0, s22, 139264
  ds_read_b64_tr_b16 v[222:223], v168 offset:512
  v_cvt_pk_bf16_f32 v77, v142, v143
  v_mfma_f32_16x16x32_bf16 v[104:107], v[240:243], a[32:35], v[104:107]
  buffer_load_dwordx4 v182, s[44:47], s23 offen lds
  v_mfma_f32_16x16x32_bf16 v[108:111], v[240:243], a[104:107], v[108:111]
  s_add_u32 s23, s23, s27
  ds_read_b64_tr_b16 v[224:225], v168 offset:4096
  v_mul_f32 v144, v212, v144
  v_mfma_f32_16x16x32_bf16 v[108:111], v[236:239], a[100:103], v[108:111]
  ds_read_b64_tr_b16 v[226:227], v168 offset:4608
  v_mul_f32 v145, v213, v145
  v_mfma_f32_16x16x32_bf16 v[108:111], v[232:235], a[96:99], v[108:111]
  s_waitcnt lgkmcnt(4)
  ds_read_b64_tr_b16 v[228:229], v168 offset:8192
  ds_read_b64_tr_b16 v[230:231], v168 offset:8704
  v_mfma_f32_16x16x32_bf16 v[116:119], v[244:247], a[96:99], v[116:119]
  ds_read_b64_tr_b16 v[232:233], v169 offset:0
  v_mul_f32 v146, v214, v146
  v_mfma_f32_16x16x32_bf16 v[116:119], v[248:251], a[100:103], v[116:119]
  s_add_u32 m0, s22, 143360
  ds_read_b64_tr_b16 v[234:235], v169 offset:512
  v_mul_f32 v147, v215, v147
  v_mfma_f32_16x16x32_bf16 v[116:119], v[252:255], a[104:107], v[116:119]
  buffer_load_dwordx4 v182, s[44:47], s23 offen lds
  v_mfma_f32_16x16x32_bf16 v[112:115], v[252:255], a[32:35], v[112:115]
  ds_read_b64_tr_b16 v[236:237], v169 offset:4096
  v_mul_f32 v148, v216, v148
  v_mfma_f32_16x16x32_bf16 v[112:115], v[248:251], a[28:31], v[112:115]
  ds_read_b64_tr_b16 v[238:239], v169 offset:4608
  v_mul_f32 v149, v217, v149
  v_mfma_f32_16x16x32_bf16 v[112:115], v[244:247], a[24:27], v[112:115]
  s_waitcnt lgkmcnt(4)
  ds_read_b64_tr_b16 v[240:241], v169 offset:8192
  ds_read_b64_tr_b16 v[242:243], v169 offset:8704
  v_mfma_f32_16x16x32_bf16 v[88:91], v[220:223], a[36:39], v[88:91]
  ds_read_b64_tr_b16 v[244:245], v170 offset:0
  v_mul_f32 v150, v218, v150
  v_mfma_f32_16x16x32_bf16 v[88:91], v[224:227], a[40:43], v[88:91]
  s_waitcnt vmcnt(20)
  ds_read_b64_tr_b16 v[246:247], v170 offset:512
  v_mul_f32 v151, v219, v151
  v_mfma_f32_16x16x32_bf16 v[88:91], v[228:231], a[44:47], v[88:91]
  s_barrier
  v_mfma_f32_16x16x32_bf16 v[92:95], v[228:231], a[116:119], v[92:95]
  ds_read_b64_tr_b16 v[248:249], v170 offset:4096
  v_cvt_pk_bf16_f32 v74, v144, v145
  v_mfma_f32_16x16x32_bf16 v[92:95], v[224:227], a[112:115], v[92:95]
  ds_read_b64_tr_b16 v[250:251], v170 offset:4608
  v_cvt_pk_bf16_f32 v75, v146, v147
  v_mfma_f32_16x16x32_bf16 v[92:95], v[220:223], a[108:111], v[92:95]
  s_waitcnt lgkmcnt(4)
  ds_read_b64_tr_b16 v[252:253], v170 offset:8192
  ds_read_b64_tr_b16 v[254:255], v170 offset:8704
  v_mfma_f32_16x16x32_bf16 v[100:103], v[232:235], a[108:111], v[100:103]
  s_add_u32 s23, s26, 128
  ds_read_b64_tr_b16 v[220:221], v171 offset:0
  v_cvt_pk_bf16_f32 v78, v148, v149
  v_mfma_f32_16x16x32_bf16 v[100:103], v[236:239], a[112:115], v[100:103]
  s_add_u32 m0, s22, 0
  ds_read_b64_tr_b16 v[222:223], v171 offset:512
  v_cvt_pk_bf16_f32 v79, v150, v151
  v_mfma_f32_16x16x32_bf16 v[100:103], v[240:243], a[116:119], v[100:103]
  buffer_load_dwordx4 v182, s[44:47], s23 offen lds
  v_mfma_f32_16x16x32_bf16 v[96:99], v[240:243], a[44:47], v[96:99]
  s_add_u32 s23, s23, 36864
  ds_read_b64_tr_b16 v[224:225], v171 offset:4096
  v_mfma_f32_16x16x32_bf16 v[96:99], v[236:239], a[40:43], v[96:99]
  ds_read_b64_tr_b16 v[226:227], v171 offset:4608
  v_mfma_f32_16x16x32_bf16 v[96:99], v[232:235], a[36:39], v[96:99]
  s_waitcnt lgkmcnt(4)
  ds_read_b64_tr_b16 v[228:229], v171 offset:8192
  ds_read_b64_tr_b16 v[230:231], v171 offset:8704
  v_mfma_f32_16x16x32_bf16 v[104:107], v[244:247], a[36:39], v[104:107]
  ds_read_b64_tr_b16 v[232:233], v168 offset:12288
  v_mfma_f32_16x16x32_bf16 v[104:107], v[248:251], a[40:43], v[104:107]
  s_add_u32 m0, s22, 4096
  ds_read_b64_tr_b16 v[234:235], v168 offset:12800
  v_mfma_f32_16x16x32_bf16 v[104:107], v[252:255], a[44:47], v[104:107]
  buffer_load_dwordx4 v182, s[44:47], s23 offen lds
  v_mfma_f32_16x16x32_bf16 v[108:111], v[252:255], a[116:119], v[108:111]
  s_add_u32 s23, s23, 36864
  ds_read_b64_tr_b16 v[236:237], v168 offset:16384
  v_mfma_f32_16x16x32_bf16 v[108:111], v[248:251], a[112:115], v[108:111]
  ds_read_b64_tr_b16 v[238:239], v168 offset:16896
  v_mfma_f32_16x16x32_bf16 v[108:111], v[244:247], a[108:111], v[108:111]
  s_waitcnt lgkmcnt(4)
  ds_read_b64_tr_b16 v[240:241], v168 offset:20480
  ds_read_b64_tr_b16 v[242:243], v168 offset:20992
  v_mfma_f32_16x16x32_bf16 v[116:119], v[220:223], a[108:111], v[116:119]
  ds_read_b64_tr_b16 v[244:245], v169 offset:12288
  v_mfma_f32_16x16x32_bf16 v[116:119], v[224:227], a[112:115], v[116:119]
  s_add_u32 m0, s22, 8192
  ds_read_b64_tr_b16 v[246:247], v169 offset:12800
  v_mfma_f32_16x16x32_bf16 v[116:119], v[228:231], a[116:119], v[116:119]
  buffer_load_dwordx4 v182, s[44:47], s23 offen lds
  v_mfma_f32_16x16x32_bf16 v[112:115], v[228:231], a[44:47], v[112:115]
  s_add_u32 s23, s23, 36864
  ds_read_b64_tr_b16 v[248:249], v169 offset:16384
  v_mfma_f32_16x16x32_bf16 v[112:115], v[224:227], a[40:43], v[112:115]
  ds_read_b64_tr_b16 v[250:251], v169 offset:16896
  v_mfma_f32_16x16x32_bf16 v[112:115], v[220:223], a[36:39], v[112:115]
  s_waitcnt lgkmcnt(4)
  ds_read_b64_tr_b16 v[252:253], v169 offset:20480
  ds_read_b64_tr_b16 v[254:255], v169 offset:20992
  v_mfma_f32_16x16x32_bf16 v[88:91], v[232:235], a[48:51], v[88:91]
  ds_read_b64_tr_b16 v[220:221], v170 offset:12288
  v_mfma_f32_16x16x32_bf16 v[88:91], v[236:239], a[52:55], v[88:91]
  ds_read_b64_tr_b16 v[222:223], v170 offset:12800
  v_mfma_f32_16x16x32_bf16 v[88:91], v[240:243], a[56:59], v[88:91]
  buffer_store_dwordx4 v[64:67], v185, s[48:51], s31 offen offset:0 sc1
  v_mfma_f32_16x16x32_bf16 v[92:95], v[240:243], a[128:131], v[92:95]
  ds_read_b64_tr_b16 v[224:225], v170 offset:16384
  v_mfma_f32_16x16x32_bf16 v[92:95], v[236:239], a[124:127], v[92:95]
  ds_read_b64_tr_b16 v[226:227], v170 offset:16896
  v_mfma_f32_16x16x32_bf16 v[92:95], v[232:235], a[120:123], v[92:95]
  s_waitcnt lgkmcnt(4)
  ds_read_b64_tr_b16 v[228:229], v170 offset:20480
  ds_read_b64_tr_b16 v[230:231], v170 offset:20992
  v_mfma_f32_16x16x32_bf16 v[100:103], v[244:247], a[120:123], v[100:103]
  s_nop 0
  ds_read_b64_tr_b16 v[232:233], v171 offset:12288
  ds_read_b64_tr_b16 v[234:235], v171 offset:12800
  v_mfma_f32_16x16x32_bf16 v[100:103], v[248:251], a[124:127], v[100:103]
  s_add_u32 m0, s22, 12288
  ds_read_b64_tr_b16 v[236:237], v171 offset:16384
  v_mfma_f32_16x16x32_bf16 v[100:103], v[252:255], a[128:131], v[100:103]
  buffer_load_dwordx4 v182, s[44:47], s23 offen lds
  v_mfma_f32_16x16x32_bf16 v[96:99], v[252:255], a[56:59], v[96:99]
  s_add_u32 s23, s23, 36864
  ds_read_b64_tr_b16 v[238:239], v171 offset:16896
  v_mfma_f32_16x16x32_bf16 v[96:99], v[248:251], a[52:55], v[96:99]
  buffer_store_dwordx4 v[68:71], v185, s[48:51], s31 offen offset:1024 sc1
  v_mfma_f32_16x16x32_bf16 v[96:99], v[244:247], a[48:51], v[96:99]
  s_waitcnt lgkmcnt(4)
  ds_read_b64_tr_b16 v[240:241], v171 offset:20480
  ds_read_b64_tr_b16 v[242:243], v171 offset:20992
  v_mfma_f32_16x16x32_bf16 v[104:107], v[220:223], a[48:51], v[104:107]
  s_nop 0
  ds_read_b64_tr_b16 v[244:245], v168 offset:24576
  ds_read_b64_tr_b16 v[246:247], v168 offset:25088
  v_mfma_f32_16x16x32_bf16 v[104:107], v[224:227], a[52:55], v[104:107]
  s_add_u32 m0, s22, 16384
  ds_read_b64_tr_b16 v[248:249], v168 offset:28672
  v_mfma_f32_16x16x32_bf16 v[104:107], v[228:231], a[56:59], v[104:107]
  buffer_load_dwordx4 v182, s[44:47], s23 offen lds
  v_mfma_f32_16x16x32_bf16 v[108:111], v[228:231], a[128:131], v[108:111]
  s_add_u32 s23, s23, 36864
  ds_read_b64_tr_b16 v[250:251], v168 offset:29184
  v_mfma_f32_16x16x32_bf16 v[108:111], v[224:227], a[124:127], v[108:111]
  buffer_store_dwordx4 v[72:75], v185, s[48:51], s31 offen offset:2048 sc1
  v_mfma_f32_16x16x32_bf16 v[108:111], v[220:223], a[120:123], v[108:111]
  s_waitcnt lgkmcnt(4)
  ds_read_b64_tr_b16 v[252:253], v168 offset:32768
  ds_read_b64_tr_b16 v[254:255], v168 offset:33280
  v_mfma_f32_16x16x32_bf16 v[116:119], v[232:235], a[120:123], v[116:119]
  ds_read_b64_tr_b16 v[220:221], v169 offset:24576
  v_add_u32 v168, 73728, v172
  v_mfma_f32_16x16x32_bf16 v[116:119], v[236:239], a[124:127], v[116:119]
  s_add_u32 m0, s22, 20480
  ds_read_b64_tr_b16 v[222:223], v169 offset:25088
  v_mfma_f32_16x16x32_bf16 v[116:119], v[240:243], a[128:131], v[116:119]
  buffer_load_dwordx4 v182, s[44:47], s23 offen lds
  v_mfma_f32_16x16x32_bf16 v[112:115], v[240:243], a[56:59], v[112:115]
  s_add_u32 s23, s23, 36864
  ds_read_b64_tr_b16 v[224:225], v169 offset:28672
  v_mfma_f32_16x16x32_bf16 v[112:115], v[236:239], a[52:55], v[112:115]
  ds_read_b64_tr_b16 v[226:227], v169 offset:29184
  v_mfma_f32_16x16x32_bf16 v[112:115], v[232:235], a[48:51], v[112:115]
  s_waitcnt lgkmcnt(4)
  ds_read_b64_tr_b16 v[228:229], v169 offset:32768
  ds_read_b64_tr_b16 v[230:231], v169 offset:33280
  v_mfma_f32_16x16x32_bf16 v[88:91], v[244:247], a[60:63], v[88:91]
  ds_read_b64_tr_b16 v[232:233], v170 offset:24576
  v_add_u32 v169, 73728, v173
  v_mfma_f32_16x16x32_bf16 v[88:91], v[248:251], a[64:67], v[88:91]
  ds_read_b64_tr_b16 v[234:235], v170 offset:25088
  v_mfma_f32_16x16x32_bf16 v[88:91], v[252:255], a[68:71], v[88:91]
  buffer_store_dwordx4 v[76:79], v185, s[48:51], s31 offen offset:3072 sc1
  v_mfma_f32_16x16x32_bf16 v[92:95], v[252:255], a[140:143], v[92:95]
  s_add_u32 s31, s31, 4096
  ds_read_b64_tr_b16 v[236:237], v170 offset:28672
  v_mfma_f32_16x16x32_bf16 v[92:95], v[248:251], a[136:139], v[92:95]
  ds_read_b64_tr_b16 v[238:239], v170 offset:29184
  v_mfma_f32_16x16x32_bf16 v[92:95], v[244:247], a[132:135], v[92:95]
  s_waitcnt lgkmcnt(4)
  ds_read_b64_tr_b16 v[240:241], v170 offset:32768
  ds_read_b64_tr_b16 v[242:243], v170 offset:33280
  v_mfma_f32_16x16x32_bf16 v[100:103], v[220:223], a[132:135], v[100:103]
  ds_read_b64_tr_b16 v[244:245], v171 offset:24576
  v_add_u32 v170, 73728, v174
  v_mfma_f32_16x16x32_bf16 v[100:103], v[224:227], a[136:139], v[100:103]
  s_add_u32 m0, s22, 24576
  ds_read_b64_tr_b16 v[246:247], v171 offset:25088
  v_mfma_f32_16x16x32_bf16 v[100:103], v[228:231], a[140:143], v[100:103]
  buffer_load_dwordx4 v182, s[44:47], s23 offen lds
  v_mfma_f32_16x16x32_bf16 v[96:99], v[228:231], a[68:71], v[96:99]
  s_add_u32 s23, s23, 36864
  ds_read_b64_tr_b16 v[248:249], v171 offset:28672
  v_max_f32 v88, 0, v88
  v_mfma_f32_16x16x32_bf16 v[96:99], v[224:227], a[64:67], v[96:99]
  ds_read_b64_tr_b16 v[250:251], v171 offset:29184
  v_max_f32 v89, 0, v89
  v_mfma_f32_16x16x32_bf16 v[96:99], v[220:223], a[60:63], v[96:99]
KB_I7:
  s_cbranch_execz KB_I10
  s_waitcnt lgkmcnt(4)
  ds_read_b64_tr_b16 v[252:253], v171 offset:32768
  ds_read_b64_tr_b16 v[254:255], v171 offset:33280
  v_mfma_f32_16x16x32_bf16 v[104:107], v[232:235], a[60:63], v[104:107]
  ds_read_b64_tr_b16 v[220:221], v168 offset:0
  v_add_u32 v171, 73728, v175
  v_mfma_f32_16x16x32_bf16 v[104:107], v[236:239], a[64:67], v[104:107]
  s_add_u32 m0, s22, 28672
  ds_read_b64_tr_b16 v[222:223], v168 offset:512
  v_max_f32 v90, 0, v90
  v_mfma_f32_16x16x32_bf16 v[104:107], v[240:243], a[68:71], v[104:107]
  buffer_load_dwordx4 v182, s[44:47], s23 offen lds
  v_mfma_f32_16x16x32_bf16 v[108:111], v[240:243], a[140:143], v[108:111]
  s_add_u32 s23, s23, s27
  ds_read_b64_tr_b16 v[224:225], v168 offset:4096
  v_max_f32 v91, 0, v91
  v_mfma_f32_16x16x32_bf16 v[108:111], v[236:239], a[136:139], v[108:111]
  ds_read_b64_tr_b16 v[226:227], v168 offset:4608
  v_max_f32 v92, 0, v92
  v_mfma_f32_16x16x32_bf16 v[108:111], v[232:235], a[132:135], v[108:111]
  s_waitcnt lgkmcnt(4)
  ds_read_b64_tr_b16 v[228:229], v168 offset:8192
  ds_read_b64_tr_b16 v[230:231], v168 offset:8704
  v_mfma_f32_16x16x32_bf16 v[116:119], v[244:247], a[132:135], v[116:119]
  ds_read_b64_tr_b16 v[232:233], v169 offset:0
  v_max_f32 v93, 0, v93
  v_mfma_f32_16x16x32_bf16 v[116:119], v[248:251], a[136:139], v[116:119]
  s_add_u32 m0, s22, 32768
  ds_read_b64_tr_b16 v[234:235], v169 offset:512
  v_max_f32 v94, 0, v94
  v_mfma_f32_16x16x32_bf16 v[116:119], v[252:255], a[140:143], v[116:119]
  buffer_load_dwordx4 v182, s[44:47], s23 offen lds
  v_mfma_f32_16x16x32_bf16 v[112:115], v[252:255], a[68:71], v[112:115]
  ds_read_b64_tr_b16 v[236:237], v169 offset:4096
  v_max_f32 v95, 0, v95
  v_mfma_f32_16x16x32_bf16 v[112:115], v[248:251], a[64:67], v[112:115]
  ds_read_b64_tr_b16 v[238:239], v169 offset:4608
  v_mul_f32 v104, v88, v104
  v_mfma_f32_16x16x32_bf16 v[112:115], v[244:247], a[60:63], v[112:115]
  s_waitcnt lgkmcnt(4)
  ds_read_b64_tr_b16 v[240:241], v169 offset:8192
  ds_read_b64_tr_b16 v[242:243], v169 offset:8704
  v_mfma_f32_16x16x32_bf16 v[120:123], v[220:223], v[16:19], 0
  ds_read_b64_tr_b16 v[244:245], v170 offset:0
  v_mul_f32 v105, v89, v105
  v_mfma_f32_16x16x32_bf16 v[120:123], v[224:227], v[24:27], v[120:123]
  s_waitcnt vmcnt(23)
  ds_read_b64_tr_b16 v[246:247], v170 offset:512
  v_mul_f32 v106, v90, v106
  v_mfma_f32_16x16x32_bf16 v[120:123], v[228:231], v[32:35], v[120:123]
  s_barrier
  v_mfma_f32_16x16x32_bf16 v[124:127], v[228:231], v[36:39], 0
  ds_read_b64_tr_b16 v[248:249], v170 offset:4096
  v_mul_f32 v107, v91, v107
  v_mfma_f32_16x16x32_bf16 v[124:127], v[224:227], v[28:31], v[124:127]
  ds_read_b64_tr_b16 v[250:251], v170 offset:4608
  v_mul_f32 v108, v92, v108
  v_mfma_f32_16x16x32_bf16 v[124:127], v[220:223], v[20:23], v[124:127]
  s_waitcnt lgkmcnt(4)
  ds_read_b64_tr_b16 v[252:253], v170 offset:8192
  ds_read_b64_tr_b16 v[254:255], v170 offset:8704
  v_mfma_f32_16x16x32_bf16 v[132:135], v[232:235], v[20:23], 0
  s_add_u32 s23, s26, 256
  ds_read_b64_tr_b16 v[220:221], v171 offset:0
  v_mul_f32 v109, v93, v109
  v_mfma_f32_16x16x32_bf16 v[132:135], v[236:239], v[28:31], v[132:135]
  s_add_u32 m0, s22, 36864
  ds_read_b64_tr_b16 v[222:223], v171 offset:512
  v_mul_f32 v110, v94, v110
  v_mfma_f32_16x16x32_bf16 v[132:135], v[240:243], v[36:39], v[132:135]
  buffer_load_dwordx4 v182, s[44:47], s23 offen lds
  v_mfma_f32_16x16x32_bf16 v[128:131], v[240:243], v[32:35], 0
  s_add_u32 s23, s23, 36864
  ds_read_b64_tr_b16 v[224:225], v171 offset:4096
  v_mul_f32 v111, v95, v111
  v_mfma_f32_16x16x32_bf16 v[128:131], v[236:239], v[24:27], v[128:131]
  ds_read_b64_tr_b16 v[226:227], v171 offset:4608
  v_cvt_pk_bf16_f32 v80, v104, v105
  v_mfma_f32_16x16x32_bf16 v[128:131], v[232:235], v[16:19], v[128:131]
  s_waitcnt lgkmcnt(4)
  ds_read_b64_tr_b16 v[228:229], v171 offset:8192
  ds_read_b64_tr_b16 v[230:231], v171 offset:8704
  v_mfma_f32_16x16x32_bf16 v[136:139], v[244:247], v[16:19], 0
  ds_read_b64_tr_b16 v[232:233], v168 offset:12288
  v_cvt_pk_bf16_f32 v81, v106, v107
  v_mfma_f32_16x16x32_bf16 v[136:139], v[248:251], v[24:27], v[136:139]
  s_add_u32 m0, s22, 40960
  ds_read_b64_tr_b16 v[234:235], v168 offset:12800
  v_cvt_pk_bf16_f32 v84, v108, v109
  v_mfma_f32_16x16x32_bf16 v[136:139], v[252:255], v[32:35], v[136:139]
  buffer_load_dwordx4 v182, s[44:47], s23 offen lds
  v_mfma_f32_16x16x32_bf16 v[140:143], v[252:255], v[36:39], 0
  s_add_u32 s23, s23, 36864
  ds_read_b64_tr_b16 v[236:237], v168 offset:16384
  v_cvt_pk_bf16_f32 v85, v110, v111
  v_mfma_f32_16x16x32_bf16 v[140:143], v[248:251], v[28:31], v[140:143]
  ds_read_b64_tr_b16 v[238:239], v168 offset:16896
  v_max_f32 v96, 0, v96
  v_mfma_f32_16x16x32_bf16 v[140:143], v[244:247], v[20:23], v[140:143]
  s_waitcnt lgkmcnt(4)
  ds_read_b64_tr_b16 v[240:241], v168 offset:20480
  ds_read_b64_tr_b16 v[242:243], v168 offset:20992
  v_mfma_f32_16x16x32_bf16 v[148:151], v[220:223], v[20:23], 0
  ds_read_b64_tr_b16 v[244:245], v169 offset:12288
  v_max_f32 v97, 0, v97
  v_mfma_f32_16x16x32_bf16 v[148:151], v[224:227], v[28:31], v[148:151]
  s_add_u32 m0, s22, 45056
  ds_read_b64_tr_b16 v[246:247], v169 offset:12800
  v_max_f32 v98, 0, v98
  v_mfma_f32_16x16x32_bf16 v[148:151], v[228:231], v[36:39], v[148:151]
  buffer_load_dwordx4 v182, s[44:47], s23 offen lds
  v_mfma_f32_16x16x32_bf16 v[144:147], v[228:231], v[32:35], 0
  s_add_u32 s23, s23, 36864
  ds_read_b64_tr_b16 v[248:249], v169 offset:16384
  v_max_f32 v99, 0, v99
  v_mfma_f32_16x16x32_bf16 v[144:147], v[224:227], v[24:27], v[144:147]
  ds_read_b64_tr_b16 v[250:251], v169 offset:16896
  v_max_f32 v100, 0, v100
  v_mfma_f32_16x16x32_bf16 v[144:147], v[220:223], v[16:19], v[144:147]
  s_waitcnt lgkmcnt(4)
  ds_read_b64_tr_b16 v[252:253], v169 offset:20480
  ds_read_b64_tr_b16 v[254:255], v169 offset:20992
  v_mfma_f32_16x16x32_bf16 v[120:123], v[232:235], v[40:43], v[120:123]
  ds_read_b64_tr_b16 v[220:221], v170 offset:12288
  v_max_f32 v101, 0, v101
  v_mfma_f32_16x16x32_bf16 v[120:123], v[236:239], v[48:51], v[120:123]
  ds_read_b64_tr_b16 v[222:223], v170 offset:12800
  v_max_f32 v102, 0, v102
  v_mfma_f32_16x16x32_bf16 v[120:123], v[240:243], v[56:59], v[120:123]
  v_mfma_f32_16x16x32_bf16 v[124:127], v[240:243], v[60:63], v[124:127]
  ds_read_b64_tr_b16 v[224:225], v170 offset:16384
  v_max_f32 v103, 0, v103
  v_mfma_f32_16x16x32_bf16 v[124:127], v[236:239], v[52:55], v[124:127]
  ds_read_b64_tr_b16 v[226:227], v170 offset:16896
  v_mul_f32 v112, v96, v112
  v_mfma_f32_16x16x32_bf16 v[124:127], v[232:235], v[44:47], v[124:127]
  s_waitcnt lgkmcnt(4)
  ds_read_b64_tr_b16 v[228:229], v170 offset:20480
  ds_read_b64_tr_b16 v[230:231], v170 offset:20992
  v_mfma_f32_16x16x32_bf16 v[132:135], v[244:247], v[44:47], v[132:135]
  ds_read_b64_tr_b16 v[232:233], v171 offset:12288
  v_mul_f32 v113, v97, v113
  v_mfma_f32_16x16x32_bf16 v[132:135], v[248:251], v[52:55], v[132:135]
  s_add_u32 m0, s22, 49152
  ds_read_b64_tr_b16 v[234:235], v171 offset:12800
  v_mul_f32 v114, v98, v114
  v_mfma_f32_16x16x32_bf16 v[132:135], v[252:255], v[60:63], v[132:135]
  buffer_load_dwordx4 v182, s[44:47], s23 offen lds
  v_mfma_f32_16x16x32_bf16 v[128:131], v[252:255], v[56:59], v[128:131]
  s_add_u32 s23, s23, 36864
  ds_read_b64_tr_b16 v[236:237], v171 offset:16384
  v_mul_f32 v115, v99, v115
  v_mfma_f32_16x16x32_bf16 v[128:131], v[248:251], v[48:51], v[128:131]
  ds_read_b64_tr_b16 v[238:239], v171 offset:16896
  v_mul_f32 v116, v100, v116
  v_mfma_f32_16x16x32_bf16 v[128:131], v[244:247], v[40:43], v[128:131]
  s_waitcnt lgkmcnt(4)
  ds_read_b64_tr_b16 v[240:241], v171 offset:20480
  ds_read_b64_tr_b16 v[242:243], v171 offset:20992
  v_mfma_f32_16x16x32_bf16 v[136:139], v[220:223], v[40:43], v[136:139]
  ds_read_b64_tr_b16 v[244:245], v168 offset:24576
  v_mul_f32 v117, v101, v117
  v_mfma_f32_16x16x32_bf16 v[136:139], v[224:227], v[48:51], v[136:139]
  s_add_u32 m0, s22, 53248
  ds_read_b64_tr_b16 v[246:247], v168 offset:25088
  v_mul_f32 v118, v102, v118
  v_mfma_f32_16x16x32_bf16 v[136:139], v[228:231], v[56:59], v[136:139]
  buffer_load_dwordx4 v182, s[44:47], s23 offen lds
  v_mfma_f32_16x16x32_bf16 v[140:143], v[228:231], v[60:63], v[140:143]
  s_add_u32 s23, s23, 36864
  ds_read_b64_tr_b16 v[248:249], v168 offset:28672
  v_mul_f32 v119, v103, v119
  v_mfma_f32_16x16x32_bf16 v[140:143], v[224:227], v[52:55], v[140:143]
  ds_read_b64_tr_b16 v[250:251], v168 offset:29184
  v_cvt_pk_bf16_f32 v82, v112, v113
  v_mfma_f32_16x16x32_bf16 v[140:143], v[220:223], v[44:47], v[140:143]
  s_waitcnt lgkmcnt(4)
  ds_read_b64_tr_b16 v[252:253], v168 offset:32768
  ds_read_b64_tr_b16 v[254:255], v168 offset:33280
  v_mfma_f32_16x16x32_bf16 v[148:151], v[232:235], v[44:47], v[148:151]
  ds_read_b64_tr_b16 v[220:221], v169 offset:24576
  v_cvt_pk_bf16_f32 v83, v114, v115
  v_mfma_f32_16x16x32_bf16 v[148:151], v[236:239], v[52:55], v[148:151]
  s_add_u32 m0, s22, 57344
  ds_read_b64_tr_b16 v[222:223], v169 offset:25088
  v_cvt_pk_bf16_f32 v86, v116, v117
  v_mfma_f32_16x16x32_bf16 v[148:151], v[240:243], v[60:63], v[148:151]
  buffer_load_dwordx4 v182, s[44:47], s23 offen lds
  v_mfma_f32_16x16x32_bf16 v[144:147], v[240:243], v[56:59], v[144:147]
  s_add_u32 s23, s23, 36864
  ds_read_b64_tr_b16 v[224:225], v169 offset:28672
  v_cvt_pk_bf16_f32 v87, v118, v119
  v_mfma_f32_16x16x32_bf16 v[144:147], v[236:239], v[48:51], v[144:147]
  ds_read_b64_tr_b16 v[226:227], v169 offset:29184
  v_add_u32 v168, 110592, v172
  v_mfma_f32_16x16x32_bf16 v[144:147], v[232:235], v[40:43], v[144:147]
  s_waitcnt lgkmcnt(4)
  ds_read_b64_tr_b16 v[228:229], v169 offset:32768
  ds_read_b64_tr_b16 v[230:231], v169 offset:33280
  v_mfma_f32_16x16x32_bf16 v[120:123], v[244:247], v[64:67], v[120:123]
  s_nop 0
  ds_read_b64_tr_b16 v[232:233], v170 offset:24576
  ds_read_b64_tr_b16 v[234:235], v170 offset:25088
  v_mfma_f32_16x16x32_bf16 v[120:123], v[248:251], v[72:75], v[120:123]
  ds_read_b64_tr_b16 v[236:237], v170 offset:28672
  v_add_u32 v169, 110592, v173
  v_mfma_f32_16x16x32_bf16 v[120:123], v[252:255], v[80:83], v[120:123]
  buffer_store_dwordx4 v[80:83], v185, s[48:51], s31 offen offset:0 sc1
  v_mfma_f32_16x16x32_bf16 v[124:127], v[252:255], v[84:87], v[124:127]
  ds_read_b64_tr_b16 v[238:239], v170 offset:29184
  v_mfma_f32_16x16x32_bf16 v[124:127], v[248:251], v[76:79], v[124:127]
  buffer_store_dwordx4 v[84:87], v185, s[48:51], s31 offen offset:1024 sc1
  v_mfma_f32_16x16x32_bf16 v[124:127], v[244:247], v[68:71], v[124:127]
  s_waitcnt lgkmcnt(4)
  ds_read_b64_tr_b16 v[240:241], v170 offset:32768
  ds_read_b64_tr_b16 v[242:243], v170 offset:33280
  v_mfma_f32_16x16x32_bf16 v[132:135], v[220:223], v[68:71], v[132:135]
  ds_read_b64_tr_b16 v[244:245], v171 offset:24576
  v_add_u32 v170, 110592, v174
  v_mfma_f32_16x16x32_bf16 v[132:135], v[224:227], v[76:79], v[132:135]
  s_add_u32 m0, s22, 61440
  ds_read_b64_tr_b16 v[246:247], v171 offset:25088
  v_mfma_f32_16x16x32_bf16 v[132:135], v[228:231], v[84:87], v[132:135]
  buffer_load_dwordx4 v182, s[44:47], s23 offen lds
  v_mfma_f32_16x16x32_bf16 v[128:131], v[228:231], v[80:83], v[128:131]
  s_add_u32 s23, s23, 36864
  ds_read_b64_tr_b16 v[248:249], v171 offset:28672
  v_cvt_pk_bf16_f32 v152, v120, v121
  v_mfma_f32_16x16x32_bf16 v[128:131], v[224:227], v[72:75], v[128:131]
  ds_read_b64_tr_b16 v[250:251], v171 offset:29184
  v_cvt_pk_bf16_f32 v153, v122, v123
  v_mfma_f32_16x16x32_bf16 v[128:131], v[220:223], v[64:67], v[128:131]
  s_waitcnt lgkmcnt(4)
  ds_read_b64_tr_b16 v[252:253], v171 offset:32768
  ds_read_b64_tr_b16 v[254:255], v171 offset:33280
  v_mfma_f32_16x16x32_bf16 v[136:139], v[232:235], v[64:67], v[136:139]
  ds_read_b64_tr_b16 v[220:221], v168 offset:0
  v_add_u32 v171, 110592, v175
  v_mfma_f32_16x16x32_bf16 v[136:139], v[236:239], v[72:75], v[136:139]
  s_add_u32 m0, s22, 65536
  ds_read_b64_tr_b16 v[222:223], v168 offset:512
  v_cvt_pk_bf16_f32 v156, v124, v125
  v_mfma_f32_16x16x32_bf16 v[136:139], v[240:243], v[80:83], v[136:139]
  buffer_load_dwordx4 v182, s[44:47], s23 offen lds
  v_mfma_f32_16x16x32_bf16 v[140:143], v[240:243], v[84:87], v[140:143]
  s_add_u32 s23, s23, s27
  ds_read_b64_tr_b16 v[224:225], v168 offset:4096
  v_cvt_pk_bf16_f32 v154, v128, v129
  v_mfma_f32_16x16x32_bf16 v[140:143], v[236:239], v[76:79], v[140:143]
  ds_read_b64_tr_b16 v[226:227], v168 offset:4608
  v_cvt_pk_bf16_f32 v155, v130, v131
  v_mfma_f32_16x16x32_bf16 v[140:143], v[232:235], v[68:71], v[140:143]
  s_waitcnt lgkmcnt(4)
  ds_read_b64_tr_b16 v[228:229], v168 offset:8192
  ds_read_b64_tr_b16 v[230:231], v168 offset:8704
  v_mfma_f32_16x16x32_bf16 v[148:151], v[244:247], v[68:71], v[148:151]
  ds_read_b64_tr_b16 v[232:233], v169 offset:0
  v_cvt_pk_bf16_f32 v157, v126, v127
  v_mfma_f32_16x16x32_bf16 v[148:151], v[248:251], v[76:79], v[148:151]
  s_add_u32 m0, s22, 69632
  ds_read_b64_tr_b16 v[234:235], v169 offset:512
  v_cvt_pk_bf16_f32 v158, v132, v133
  v_mfma_f32_16x16x32_bf16 v[148:151], v[252:255], v[84:87], v[148:151]
  buffer_load_dwordx4 v182, s[44:47], s23 offen lds
  v_mfma_f32_16x16x32_bf16 v[144:147], v[252:255], v[80:83], v[144:147]
  ds_read_b64_tr_b16 v[236:237], v169 offset:4096
  v_cvt_pk_bf16_f32 v159, v134, v135
  v_mfma_f32_16x16x32_bf16 v[144:147], v[248:251], v[72:75], v[144:147]
  ds_read_b64_tr_b16 v[238:239], v169 offset:4608
  v_cvt_pk_bf16_f32 v160, v136, v137
  v_mfma_f32_16x16x32_bf16 v[144:147], v[244:247], v[64:67], v[144:147]
  s_waitcnt lgkmcnt(4)
  ds_read_b64_tr_b16 v[240:241], v169 offset:8192
  ds_read_b64_tr_b16 v[242:243], v169 offset:8704
  v_mfma_f32_16x16x32_bf16 v[188:191], v[220:223], v[16:19], 0
  s_nop 0
  ds_read_b64_tr_b16 v[244:245], v170 offset:0
  ds_read_b64_tr_b16 v[246:247], v170 offset:512
  v_mfma_f32_16x16x32_bf16 v[188:191], v[224:227], v[24:27], v[188:191]
  s_waitcnt vmcnt(21)
  ds_read_b64_tr_b16 v[248:249], v170 offset:4096
  v_cvt_pk_bf16_f32 v161, v138, v139
  v_mfma_f32_16x16x32_bf16 v[188:191], v[228:231], v[32:35], v[188:191]
  s_barrier
  v_mfma_f32_16x16x32_bf16 v[192:195], v[228:231], v[36:39], 0
  ds_read_b64_tr_b16 v[250:251], v170 offset:4608
  v_cvt_pk_bf16_f32 v162, v144, v145
  v_mfma_f32_16x16x32_bf16 v[192:195], v[224:227], v[28:31], v[192:195]
  buffer_store_dwordx4 v[152:155], v183, s[48:51], s28 offen offset:0 sc1
  v_mfma_f32_16x16x32_bf16 v[192:195], v[220:223], v[20:23], v[192:195]
  s_waitcnt lgkmcnt(4)
  ds_read_b64_tr_b16 v[252:253], v170 offset:8192
  ds_read_b64_tr_b16 v[254:255], v170 offset:8704
  v_mfma_f32_16x16x32_bf16 v[200:203], v[232:235], v[20:23], 0
  s_add_u32 s23, s29, 0
  ds_read_b64_tr_b16 v[220:221], v171 offset:0
  v_cvt_pk_bf16_f32 v163, v146, v147
  v_mfma_f32_16x16x32_bf16 v[200:203], v[236:239], v[28:31], v[200:203]
  s_add_u32 m0, s22, 73728
  ds_read_b64_tr_b16 v[222:223], v171 offset:512
  v_cvt_pk_bf16_f32 v164, v140, v141
  v_mfma_f32_16x16x32_bf16 v[200:203], v[240:243], v[36:39], v[200:203]
  buffer_load_dwordx4 v182, s[44:47], s23 offen lds
  v_mfma_f32_16x16x32_bf16 v[196:199], v[240:243], v[32:35], 0
  s_add_u32 s23, s23, 36864
  ds_read_b64_tr_b16 v[224:225], v171 offset:4096
  v_cvt_pk_bf16_f32 v165, v142, v143
  v_mfma_f32_16x16x32_bf16 v[196:199], v[236:239], v[24:27], v[196:199]
  ds_read_b64_tr_b16 v[226:227], v171 offset:4608
  v_cvt_pk_bf16_f32 v166, v148, v149
  v_mfma_f32_16x16x32_bf16 v[196:199], v[232:235], v[16:19], v[196:199]
  s_waitcnt lgkmcnt(4)
  ds_read_b64_tr_b16 v[228:229], v171 offset:8192
  ds_read_b64_tr_b16 v[230:231], v171 offset:8704
  v_mfma_f32_16x16x32_bf16 v[204:207], v[244:247], v[16:19], 0
  s_nop 0
  ds_read_b64_tr_b16 v[232:233], v168 offset:12288
  ds_read_b64_tr_b16 v[234:235], v168 offset:12800
  v_mfma_f32_16x16x32_bf16 v[204:207], v[248:251], v[24:27], v[204:207]
  s_add_u32 m0, s22, 77824
  ds_read_b64_tr_b16 v[236:237], v168 offset:16384
  v_cvt_pk_bf16_f32 v167, v150, v151
  v_mfma_f32_16x16x32_bf16 v[204:207], v[252:255], v[32:35], v[204:207]
  buffer_load_dwordx4 v182, s[44:47], s23 offen lds
  v_mfma_f32_16x16x32_bf16 v[208:211], v[252:255], v[36:39], 0
  s_add_u32 s23, s23, 36864
  ds_read_b64_tr_b16 v[238:239], v168 offset:16896
  v_mfma_f32_16x16x32_bf16 v[208:211], v[248:251], v[28:31], v[208:211]
  buffer_store_dwordx4 v[156:159], v183, s[48:51], s28 offen offset:2048 sc1
  v_mfma_f32_16x16x32_bf16 v[208:211], v[244:247], v[20:23], v[208:211]
  s_waitcnt lgkmcnt(4)
  ds_read_b64_tr_b16 v[240:241], v168 offset:20480
  ds_read_b64_tr_b16 v[242:243], v168 offset:20992
  v_mfma_f32_16x16x32_bf16 v[216:219], v[220:223], v[20:23], 0
  s_nop 0
  ds_read_b64_tr_b16 v[244:245], v169 offset:12288
  ds_read_b64_tr_b16 v[246:247], v169 offset:12800
  v_mfma_f32_16x16x32_bf16 v[216:219], v[224:227], v[28:31], v[216:219]
  s_add_u32 m0, s22, 81920
  ds_read_b64_tr_b16 v[248:249], v169 offset:16384
  v_mfma_f32_16x16x32_bf16 v[216:219], v[228:231], v[36:39], v[216:219]
  buffer_load_dwordx4 v182, s[44:47], s23 offen lds
  v_mfma_f32_16x16x32_bf16 v[212:215], v[228:231], v[32:35], 0
  s_add_u32 s23, s23, 36864
  ds_read_b64_tr_b16 v[250:251], v169 offset:16896
  v_mfma_f32_16x16x32_bf16 v[212:215], v[224:227], v[24:27], v[212:215]
  buffer_store_dwordx4 v[160:163], v183, s[48:51], s28 offen offset:1024 sc1
  v_mfma_f32_16x16x32_bf16 v[212:215], v[220:223], v[16:19], v[212:215]
  s_waitcnt lgkmcnt(4)
  ds_read_b64_tr_b16 v[252:253], v169 offset:20480
  ds_read_b64_tr_b16 v[254:255], v169 offset:20992
  v_mfma_f32_16x16x32_bf16 v[188:191], v[232:235], v[40:43], v[188:191]
  s_nop 0
  ds_read_b64_tr_b16 v[220:221], v170 offset:12288
  ds_read_b64_tr_b16 v[222:223], v170 offset:12800
  v_mfma_f32_16x16x32_bf16 v[188:191], v[236:239], v[48:51], v[188:191]
  ds_read_b64_tr_b16 v[224:225], v170 offset:16384
  v_mfma_f32_16x16x32_bf16 v[188:191], v[240:243], v[56:59], v[188:191]
  v_mfma_f32_16x16x32_bf16 v[192:195], v[240:243], v[60:63], v[192:195]
  ds_read_b64_tr_b16 v[226:227], v170 offset:16896
  v_mfma_f32_16x16x32_bf16 v[192:195], v[236:239], v[52:55], v[192:195]
  buffer_store_dwordx4 v[164:167], v183, s[48:51], s28 offen offset:3072 sc1
  v_mfma_f32_16x16x32_bf16 v[192:195], v[232:235], v[44:47], v[192:195]
  s_waitcnt lgkmcnt(4)
  ds_read_b64_tr_b16 v[228:229], v170 offset:20480
  ds_read_b64_tr_b16 v[230:231], v170 offset:20992
  v_mfma_f32_16x16x32_bf16 v[200:203], v[244:247], v[44:47], v[200:203]
  s_add_u32 s28, s28, 16384
  ds_read_b64_tr_b16 v[232:233], v171 offset:12288
  v_mfma_f32_16x16x32_bf16 v[200:203], v[248:251], v[52:55], v[200:203]
  s_add_u32 m0, s22, 86016
  ds_read_b64_tr_b16 v[234:235], v171 offset:12800
  v_mfma_f32_16x16x32_bf16 v[200:203], v[252:255], v[60:63], v[200:203]
  buffer_load_dwordx4 v182, s[44:47], s23 offen lds
  v_mfma_f32_16x16x32_bf16 v[196:199], v[252:255], v[56:59], v[196:199]
  s_add_u32 s23, s23, 36864
  ds_read_b64_tr_b16 v[236:237], v171 offset:16384
  v_mfma_f32_16x16x32_bf16 v[196:199], v[248:251], v[48:51], v[196:199]
  ds_read_b64_tr_b16 v[238:239], v171 offset:16896
  v_mfma_f32_16x16x32_bf16 v[196:199], v[244:247], v[40:43], v[196:199]
  s_waitcnt lgkmcnt(4)
  ds_read_b64_tr_b16 v[240:241], v171 offset:20480
  ds_read_b64_tr_b16 v[242:243], v171 offset:20992
  v_mfma_f32_16x16x32_bf16 v[204:207], v[220:223], v[40:43], v[204:207]
  ds_read_b64_tr_b16 v[244:245], v168 offset:24576
  v_mfma_f32_16x16x32_bf16 v[204:207], v[224:227], v[48:51], v[204:207]
  s_add_u32 m0, s22, 90112
  ds_read_b64_tr_b16 v[246:247], v168 offset:25088
  v_mfma_f32_16x16x32_bf16 v[204:207], v[228:231], v[56:59], v[204:207]
  buffer_load_dwordx4 v182, s[44:47], s23 offen lds
  v_mfma_f32_16x16x32_bf16 v[208:211], v[228:231], v[60:63], v[208:211]
  s_add_u32 s23, s23, 36864
  ds_read_b64_tr_b16 v[248:249], v168 offset:28672
  v_mfma_f32_16x16x32_bf16 v[208:211], v[224:227], v[52:55], v[208:211]
  ds_read_b64_tr_b16 v[250:251], v168 offset:29184
  v_mfma_f32_16x16x32_bf16 v[208:211], v[220:223], v[44:47], v[208:211]
  s_waitcnt lgkmcnt(4)
  ds_read_b64_tr_b16 v[252:253], v168 offset:32768
  ds_read_b64_tr_b16 v[254:255], v168 offset:33280
  v_mfma_f32_16x16x32_bf16 v[216:219], v[232:235], v[44:47], v[216:219]
  ds_read_b64_tr_b16 v[220:221], v169 offset:24576
  v_add_u32 v168, 0, v172
  v_mfma_f32_16x16x32_bf16 v[216:219], v[236:239], v[52:55], v[216:219]
  s_add_u32 m0, s22, 94208
  ds_read_b64_tr_b16 v[222:223], v169 offset:25088
  v_mfma_f32_16x16x32_bf16 v[216:219], v[240:243], v[60:63], v[216:219]
  buffer_load_dwordx4 v182, s[44:47], s23 offen lds
  v_mfma_f32_16x16x32_bf16 v[212:215], v[240:243], v[56:59], v[212:215]
  s_add_u32 s23, s23, 36864
  ds_read_b64_tr_b16 v[224:225], v169 offset:28672
  v_mfma_f32_16x16x32_bf16 v[212:215], v[236:239], v[48:51], v[212:215]
  ds_read_b64_tr_b16 v[226:227], v169 offset:29184
  v_mfma_f32_16x16x32_bf16 v[212:215], v[232:235], v[40:43], v[212:215]
  s_waitcnt lgkmcnt(4)
  ds_read_b64_tr_b16 v[228:229], v169 offset:32768
  ds_read_b64_tr_b16 v[230:231], v169 offset:33280
  v_mfma_f32_16x16x32_bf16 v[188:191], v[244:247], v[64:67], v[188:191]
  ds_read_b64_tr_b16 v[232:233], v170 offset:24576
  v_add_u32 v169, 0, v173
  v_mfma_f32_16x16x32_bf16 v[188:191], v[248:251], v[72:75], v[188:191]
  s_waitcnt vmcnt(13)
  ds_read_b64_tr_b16 v[234:235], v170 offset:25088
  v_mfma_f32_16x16x32_bf16 v[188:191], v[252:255], v[80:83], v[188:191]
  buffer_store_dword v14, v186, s[48:51], s34 offen offset:192 sc1
  v_mfma_f32_16x16x32_bf16 v[192:195], v[252:255], v[84:87], v[192:195]
  ds_read_b64_tr_b16 v[236:237], v170 offset:28672
  v_mfma_f32_16x16x32_bf16 v[192:195], v[248:251], v[76:79], v[192:195]
  ds_read_b64_tr_b16 v[238:239], v170 offset:29184
  v_mfma_f32_16x16x32_bf16 v[192:195], v[244:247], v[68:71], v[192:195]
  s_waitcnt lgkmcnt(4)
  ds_read_b64_tr_b16 v[240:241], v170 offset:32768
  ds_read_b64_tr_b16 v[242:243], v170 offset:33280
  v_mfma_f32_16x16x32_bf16 v[200:203], v[220:223], v[68:71], v[200:203]
  ds_read_b64_tr_b16 v[244:245], v171 offset:24576
  v_add_u32 v170, 0, v174
  v_mfma_f32_16x16x32_bf16 v[200:203], v[224:227], v[76:79], v[200:203]
  s_add_u32 m0, s22, 98304
  ds_read_b64_tr_b16 v[246:247], v171 offset:25088
  v_mfma_f32_16x16x32_bf16 v[200:203], v[228:231], v[84:87], v[200:203]
  buffer_load_dwordx4 v182, s[44:47], s23 offen lds
  v_mfma_f32_16x16x32_bf16 v[196:199], v[228:231], v[80:83], v[196:199]
  s_add_u32 s23, s23, 36864
  ds_read_b64_tr_b16 v[248:249], v171 offset:28672
  v_mfma_f32_16x16x32_bf16 v[196:199], v[224:227], v[72:75], v[196:199]
  ds_read_b64_tr_b16 v[250:251], v171 offset:29184
  v_mfma_f32_16x16x32_bf16 v[196:199], v[220:223], v[64:67], v[196:199]
  s_waitcnt lgkmcnt(4)
  ds_read_b64_tr_b16 v[252:253], v171 offset:32768
  ds_read_b64_tr_b16 v[254:255], v171 offset:33280
  v_mfma_f32_16x16x32_bf16 v[204:207], v[232:235], v[64:67], v[204:207]
  ds_read_b64_tr_b16 v[220:221], v168 offset:0
  v_add_u32 v171, 0, v175
  v_mfma_f32_16x16x32_bf16 v[204:207], v[236:239], v[72:75], v[204:207]
  s_add_u32 m0, s22, 102400
  ds_read_b64_tr_b16 v[222:223], v168 offset:512
  v_mfma_f32_16x16x32_bf16 v[204:207], v[240:243], v[80:83], v[204:207]
  buffer_load_dwordx4 v182, s[44:47], s23 offen lds
  v_mfma_f32_16x16x32_bf16 v[208:211], v[240:243], v[84:87], v[208:211]
  s_add_u32 s23, s23, s30
  ds_read_b64_tr_b16 v[224:225], v168 offset:4096
  v_mfma_f32_16x16x32_bf16 v[208:211], v[236:239], v[76:79], v[208:211]
  ds_read_b64_tr_b16 v[226:227], v168 offset:4608
  v_mfma_f32_16x16x32_bf16 v[208:211], v[232:235], v[68:71], v[208:211]
  s_waitcnt lgkmcnt(4)
  ds_read_b64_tr_b16 v[228:229], v168 offset:8192
  ds_read_b64_tr_b16 v[230:231], v168 offset:8704
  v_mfma_f32_16x16x32_bf16 v[216:219], v[244:247], v[68:71], v[216:219]
  ds_read_b64_tr_b16 v[232:233], v169 offset:0
  v_mfma_f32_16x16x32_bf16 v[216:219], v[248:251], v[76:79], v[216:219]
  s_add_u32 m0, s22, 106496
  ds_read_b64_tr_b16 v[234:235], v169 offset:512
  v_mfma_f32_16x16x32_bf16 v[216:219], v[252:255], v[84:87], v[216:219]
  buffer_load_dwordx4 v182, s[44:47], s23 offen lds
  v_mfma_f32_16x16x32_bf16 v[212:215], v[252:255], v[80:83], v[212:215]
  ds_read_b64_tr_b16 v[236:237], v169 offset:4096
  v_mfma_f32_16x16x32_bf16 v[212:215], v[248:251], v[72:75], v[212:215]
  ds_read_b64_tr_b16 v[238:239], v169 offset:4608
  v_mfma_f32_16x16x32_bf16 v[212:215], v[244:247], v[64:67], v[212:215]
  s_waitcnt lgkmcnt(4)
  ds_read_b64_tr_b16 v[240:241], v169 offset:8192
  ds_read_b64_tr_b16 v[242:243], v169 offset:8704
  v_mfma_f32_16x16x32_bf16 v[88:91], v[220:223], v[16:19], 0
  ds_read_b64_tr_b16 v[244:245], v170 offset:0
  v_mfma_f32_16x16x32_bf16 v[88:91], v[224:227], v[24:27], v[88:91]
  s_waitcnt vmcnt(22)
  ds_read_b64_tr_b16 v[246:247], v170 offset:512
  v_mfma_f32_16x16x32_bf16 v[88:91], v[228:231], v[32:35], v[88:91]
  s_barrier
  v_mfma_f32_16x16x32_bf16 v[92:95], v[228:231], v[36:39], 0
  ds_read_b64_tr_b16 v[248:249], v170 offset:4096
  v_mfma_f32_16x16x32_bf16 v[92:95], v[224:227], v[28:31], v[92:95]
  ds_read_b64_tr_b16 v[250:251], v170 offset:4608
  v_mfma_f32_16x16x32_bf16 v[92:95], v[220:223], v[20:23], v[92:95]
  s_waitcnt lgkmcnt(4)
  ds_read_b64_tr_b16 v[252:253], v170 offset:8192
  ds_read_b64_tr_b16 v[254:255], v170 offset:8704
  v_mfma_f32_16x16x32_bf16 v[100:103], v[232:235], v[20:23], 0
  s_add_u32 s23, s29, 128
  ds_read_b64_tr_b16 v[220:221], v171 offset:0
  v_mfma_f32_16x16x32_bf16 v[100:103], v[236:239], v[28:31], v[100:103]
  s_add_u32 m0, s22, 110592
  ds_read_b64_tr_b16 v[222:223], v171 offset:512
  v_mfma_f32_16x16x32_bf16 v[100:103], v[240:243], v[36:39], v[100:103]
  buffer_load_dwordx4 v182, s[44:47], s23 offen lds
  v_mfma_f32_16x16x32_bf16 v[96:99], v[240:243], v[32:35], 0
  s_add_u32 s23, s23, 36864
  ds_read_b64_tr_b16 v[224:225], v171 offset:4096
  v_mfma_f32_16x16x32_bf16 v[96:99], v[236:239], v[24:27], v[96:99]
  ds_read_b64_tr_b16 v[226:227], v171 offset:4608
  v_mfma_f32_16x16x32_bf16 v[96:99], v[232:235], v[16:19], v[96:99]
  s_waitcnt lgkmcnt(4)
  ds_read_b64_tr_b16 v[228:229], v171 offset:8192
  ds_read_b64_tr_b16 v[230:231], v171 offset:8704
  v_mfma_f32_16x16x32_bf16 v[104:107], v[244:247], v[16:19], 0
  ds_read_b64_tr_b16 v[232:233], v168 offset:12288
  v_mfma_f32_16x16x32_bf16 v[104:107], v[248:251], v[24:27], v[104:107]
  s_add_u32 m0, s22, 114688
  ds_read_b64_tr_b16 v[234:235], v168 offset:12800
  v_mfma_f32_16x16x32_bf16 v[104:107], v[252:255], v[32:35], v[104:107]
  buffer_load_dwordx4 v182, s[44:47], s23 offen lds
  v_mfma_f32_16x16x32_bf16 v[108:111], v[252:255], v[36:39], 0
  s_add_u32 s23, s23, 36864
  ds_read_b64_tr_b16 v[236:237], v168 offset:16384
  v_mfma_f32_16x16x32_bf16 v[108:111], v[248:251], v[28:31], v[108:111]
  ds_read_b64_tr_b16 v[238:239], v168 offset:16896
  v_mfma_f32_16x16x32_bf16 v[108:111], v[244:247], v[20:23], v[108:111]
  s_waitcnt lgkmcnt(4)
  ds_read_b64_tr_b16 v[240:241], v168 offset:20480
  ds_read_b64_tr_b16 v[242:243], v168 offset:20992
  v_mfma_f32_16x16x32_bf16 v[116:119], v[220:223], v[20:23], 0
  ds_read_b64_tr_b16 v[244:245], v169 offset:12288
  v_mfma_f32_16x16x32_bf16 v[116:119], v[224:227], v[28:31], v[116:119]
  s_add_u32 m0, s22, 118784
  ds_read_b64_tr_b16 v[246:247], v169 offset:12800
  v_mfma_f32_16x16x32_bf16 v[116:119], v[228:231], v[36:39], v[116:119]
  buffer_load_dwordx4 v182, s[44:47], s23 offen lds
  v_mfma_f32_16x16x32_bf16 v[112:115], v[228:231], v[32:35], 0
  s_add_u32 s23, s23, 36864
  ds_read_b64_tr_b16 v[248:249], v169 offset:16384
  v_mfma_f32_16x16x32_bf16 v[112:115], v[224:227], v[24:27], v[112:115]
  ds_read_b64_tr_b16 v[250:251], v169 offset:16896
  v_mfma_f32_16x16x32_bf16 v[112:115], v[220:223], v[16:19], v[112:115]
  s_waitcnt lgkmcnt(4)
  ds_read_b64_tr_b16 v[252:253], v169 offset:20480
  ds_read_b64_tr_b16 v[254:255], v169 offset:20992
  v_mfma_f32_16x16x32_bf16 v[88:91], v[232:235], v[40:43], v[88:91]
  ds_read_b64_tr_b16 v[220:221], v170 offset:12288
  v_mfma_f32_16x16x32_bf16 v[88:91], v[236:239], v[48:51], v[88:91]
  s_waitcnt vmcnt(10)
  ds_read_b64_tr_b16 v[222:223], v170 offset:12800
  v_mfma_f32_16x16x32_bf16 v[88:91], v[240:243], v[56:59], v[88:91]
  s_barrier
  v_mfma_f32_16x16x32_bf16 v[92:95], v[240:243], v[60:63], v[92:95]
KB_I8:
  s_cbranch_execz KB_I11
  ds_read_b64_tr_b16 v[224:225], v170 offset:16384
  v_mfma_f32_16x16x32_bf16 v[92:95], v[236:239], v[52:55], v[92:95]
  ds_read_b64_tr_b16 v[226:227], v170 offset:16896
  v_mfma_f32_16x16x32_bf16 v[92:95], v[232:235], v[44:47], v[92:95]
  s_waitcnt lgkmcnt(4)
  ds_read_b64_tr_b16 v[228:229], v170 offset:20480
  ds_read_b64_tr_b16 v[230:231], v170 offset:20992
  v_mfma_f32_16x16x32_bf16 v[100:103], v[244:247], v[44:47], v[100:103]
  s_nop 0
  ds_read_b64_tr_b16 v[232:233], v171 offset:12288
  ds_read_b64_tr_b16 v[234:235], v171 offset:12800
  v_mfma_f32_16x16x32_bf16 v[100:103], v[248:251], v[52:55], v[100:103]
  s_add_u32 m0, s22, 122880
  ds_read_b64_tr_b16 v[236:237], v171 offset:16384
  v_mfma_f32_16x16x32_bf16 v[100:103], v[252:255], v[60:63], v[100:103]
  buffer_load_dwordx4 v182, s[44:47], s23 offen lds
  v_mfma_f32_16x16x32_bf16 v[96:99], v[252:255], v[56:59], v[96:99]
  s_add_u32 s23, s23, 36864
  ds_read_b64_tr_b16 v[238:239], v171 offset:16896
  v_mfma_f32_16x16x32_bf16 v[96:99], v[248:251], v[48:51], v[96:99]
  buffer_atomic_add v14, v12, s[48:51], s74 offen offset:0 sc1
  v_mfma_f32_16x16x32_bf16 v[96:99], v[244:247], v[40:43], v[96:99]
  s_waitcnt lgkmcnt(4)
  ds_read_b64_tr_b16 v[240:241], v171 offset:20480
  ds_read_b64_tr_b16 v[242:243], v171 offset:20992
  v_mfma_f32_16x16x32_bf16 v[104:107], v[220:223], v[40:43], v[104:107]
  ds_read_b64_tr_b16 v[244:245], v168 offset:24576
  v_mfma_f32_16x16x32_bf16 v[104:107], v[224:227], v[48:51], v[104:107]
  s_add_u32 m0, s22, 126976
  ds_read_b64_tr_b16 v[246:247], v168 offset:25088
  v_mfma_f32_16x16x32_bf16 v[104:107], v[228:231], v[56:59], v[104:107]
  buffer_load_dwordx4 v182, s[44:47], s23 offen lds
  v_mfma_f32_16x16x32_bf16 v[108:111], v[228:231], v[60:63], v[108:111]
  s_add_u32 s23, s23, 36864
  ds_read_b64_tr_b16 v[248:249], v168 offset:28672
  v_mfma_f32_16x16x32_bf16 v[108:111], v[224:227], v[52:55], v[108:111]
  ds_read_b64_tr_b16 v[250:251], v168 offset:29184
  v_mfma_f32_16x16x32_bf16 v[108:111], v[220:223], v[44:47], v[108:111]
  s_waitcnt lgkmcnt(4)
  ds_read_b64_tr_b16 v[252:253], v168 offset:32768
  ds_read_b64_tr_b16 v[254:255], v168 offset:33280
  v_mfma_f32_16x16x32_bf16 v[116:119], v[232:235], v[44:47], v[116:119]
  ds_read_b64_tr_b16 v[220:221], v169 offset:24576
  v_add_u32 v168, 36864, v172
  v_mfma_f32_16x16x32_bf16 v[116:119], v[236:239], v[52:55], v[116:119]
  s_add_u32 m0, s22, 131072
  ds_read_b64_tr_b16 v[222:223], v169 offset:25088
  v_mfma_f32_16x16x32_bf16 v[116:119], v[240:243], v[60:63], v[116:119]
  buffer_load_dwordx4 v182, s[44:47], s23 offen lds
  v_mfma_f32_16x16x32_bf16 v[112:115], v[240:243], v[56:59], v[112:115]
  s_add_u32 s23, s23, 36864
  ds_read_b64_tr_b16 v[224:225], v169 offset:28672
  v_mfma_f32_16x16x32_bf16 v[112:115], v[236:239], v[48:51], v[112:115]
  ds_read_b64_tr_b16 v[226:227], v169 offset:29184
  v_mfma_f32_16x16x32_bf16 v[112:115], v[232:235], v[40:43], v[112:115]
  s_waitcnt lgkmcnt(4)
  ds_read_b64_tr_b16 v[228:229], v169 offset:32768
  ds_read_b64_tr_b16 v[230:231], v169 offset:33280
  v_mfma_f32_16x16x32_bf16 v[88:91], v[244:247], v[64:67], v[88:91]
  ds_read_b64_tr_b16 v[232:233], v170 offset:24576
  v_add_u32 v169, 36864, v173
  v_mfma_f32_16x16x32_bf16 v[88:91], v[248:251], v[72:75], v[88:91]
  ds_read_b64_tr_b16 v[234:235], v170 offset:25088
  v_mfma_f32_16x16x32_bf16 v[88:91], v[252:255], v[80:83], v[88:91]
  v_mfma_f32_16x16x32_bf16 v[92:95], v[252:255], v[84:87], v[92:95]
  ds_read_b64_tr_b16 v[236:237], v170 offset:28672
  v_mfma_f32_16x16x32_bf16 v[92:95], v[248:251], v[76:79], v[92:95]
  ds_read_b64_tr_b16 v[238:239], v170 offset:29184
  v_mfma_f32_16x16x32_bf16 v[92:95], v[244:247], v[68:71], v[92:95]
  s_waitcnt lgkmcnt(4)
  ds_read_b64_tr_b16 v[240:241], v170 offset:32768
  ds_read_b64_tr_b16 v[242:243], v170 offset:33280
  v_mfma_f32_16x16x32_bf16 v[100:103], v[220:223], v[68:71], v[100:103]
  ds_read_b64_tr_b16 v[244:245], v171 offset:24576
  v_add_u32 v170, 36864, v174
  v_mfma_f32_16x16x32_bf16 v[100:103], v[224:227], v[76:79], v[100:103]
  s_add_u32 m0, s22, 135168
  ds_read_b64_tr_b16 v[246:247], v171 offset:25088
  v_mfma_f32_16x16x32_bf16 v[100:103], v[228:231], v[84:87], v[100:103]
  buffer_load_dwordx4 v182, s[44:47], s23 offen lds
  v_mfma_f32_16x16x32_bf16 v[96:99], v[228:231], v[80:83], v[96:99]
  s_add_u32 s23, s23, 36864
  ds_read_b64_tr_b16 v[248:249], v171 offset:28672
  v_mfma_f32_16x16x32_bf16 v[96:99], v[224:227], v[72:75], v[96:99]
  ds_read_b64_tr_b16 v[250:251], v171 offset:29184
  v_mfma_f32_16x16x32_bf16 v[96:99], v[220:223], v[64:67], v[96:99]
  s_waitcnt lgkmcnt(4)
  ds_read_b64_tr_b16 v[252:253], v171 offset:32768
  ds_read_b64_tr_b16 v[254:255], v171 offset:33280
  v_mfma_f32_16x16x32_bf16 v[104:107], v[232:235], v[64:67], v[104:107]
  s_nop 0
  ds_read_b64_tr_b16 v[220:221], v168 offset:0
  ds_read_b64_tr_b16 v[222:223], v168 offset:512
  v_mfma_f32_16x16x32_bf16 v[104:107], v[236:239], v[72:75], v[104:107]
  s_add_u32 m0, s22, 139264
  ds_read_b64_tr_b16 v[224:225], v168 offset:4096
  v_add_u32 v171, 36864, v175
  v_mfma_f32_16x16x32_bf16 v[104:107], v[240:243], v[80:83], v[104:107]
  buffer_load_dwordx4 v182, s[44:47], s23 offen lds
  v_mfma_f32_16x16x32_bf16 v[108:111], v[240:243], v[84:87], v[108:111]
  s_add_u32 s23, s23, s30
  ds_read_b64_tr_b16 v[226:227], v168 offset:4608
  v_mfma_f32_16x16x32_bf16 v[108:111], v[236:239], v[76:79], v[108:111]
  buffer_load_dword v15, v186, s[48:51], s35 offen offset:192 sc1
  v_mfma_f32_16x16x32_bf16 v[108:111], v[232:235], v[68:71], v[108:111]
  s_waitcnt lgkmcnt(4)
  ds_read_b64_tr_b16 v[228:229], v168 offset:8192
  ds_read_b64_tr_b16 v[230:231], v168 offset:8704
  v_mfma_f32_16x16x32_bf16 v[116:119], v[244:247], v[68:71], v[116:119]
  ds_read_b64_tr_b16 v[232:233], v169 offset:0
  v_mfma_f32_16x16x32_bf16 v[116:119], v[248:251], v[76:79], v[116:119]
  s_add_u32 m0, s22, 143360
  ds_read_b64_tr_b16 v[234:235], v169 offset:512
  v_mfma_f32_16x16x32_bf16 v[116:119], v[252:255], v[84:87], v[116:119]
  buffer_load_dwordx4 v182, s[44:47], s23 offen lds
  v_mfma_f32_16x16x32_bf16 v[112:115], v[252:255], v[80:83], v[112:115]
  ds_read_b64_tr_b16 v[236:237], v169 offset:4096
  v_mfma_f32_16x16x32_bf16 v[112:115], v[248:251], v[72:75], v[112:115]
  ds_read_b64_tr_b16 v[238:239], v169 offset:4608
  v_mfma_f32_16x16x32_bf16 v[112:115], v[244:247], v[64:67], v[112:115]
  s_waitcnt lgkmcnt(4)
  ds_read_b64_tr_b16 v[240:241], v169 offset:8192
  ds_read_b64_tr_b16 v[242:243], v169 offset:8704
  v_mfma_f32_16x16x32_bf16 v[120:123], v[220:223], v[16:19], 0
  ds_read_b64_tr_b16 v[244:245], v170 offset:0
  v_mfma_f32_16x16x32_bf16 v[120:123], v[224:227], v[24:27], v[120:123]
  s_waitcnt vmcnt(20)
  ds_read_b64_tr_b16 v[246:247], v170 offset:512
  v_mfma_f32_16x16x32_bf16 v[120:123], v[228:231], v[32:35], v[120:123]
  s_barrier
  v_mfma_f32_16x16x32_bf16 v[124:127], v[228:231], v[36:39], 0
  ds_read_b64_tr_b16 v[248:249], v170 offset:4096
  v_mfma_f32_16x16x32_bf16 v[124:127], v[224:227], v[28:31], v[124:127]
  ds_read_b64_tr_b16 v[250:251], v170 offset:4608
  v_mfma_f32_16x16x32_bf16 v[124:127], v[220:223], v[20:23], v[124:127]
  s_waitcnt lgkmcnt(4)
  ds_read_b64_tr_b16 v[252:253], v170 offset:8192
  ds_read_b64_tr_b16 v[254:255], v170 offset:8704
  v_mfma_f32_16x16x32_bf16 v[132:135], v[232:235], v[20:23], 0
  s_add_u32 s23, s29, 256
  ds_read_b64_tr_b16 v[220:221], v171 offset:0
  v_mfma_f32_16x16x32_bf16 v[132:135], v[236:239], v[28:31], v[132:135]
  s_add_u32 m0, s22, 0
  ds_read_b64_tr_b16 v[222:223], v171 offset:512
  v_mfma_f32_16x16x32_bf16 v[132:135], v[240:243], v[36:39], v[132:135]
  buffer_load_dwordx4 v182, s[44:47], s23 offen lds
  v_mfma_f32_16x16x32_bf16 v[128:131], v[240:243], v[32:35], 0
  s_add_u32 s23, s23, 36864
  ds_read_b64_tr_b16 v[224:225], v171 offset:4096
  v_mfma_f32_16x16x32_bf16 v[128:131], v[236:239], v[24:27], v[128:131]
  ds_read_b64_tr_b16 v[226:227], v171 offset:4608
  v_mfma_f32_16x16x32_bf16 v[128:131], v[232:235], v[16:19], v[128:131]
  s_waitcnt lgkmcnt(4)
  ds_read_b64_tr_b16 v[228:229], v171 offset:8192
  ds_read_b64_tr_b16 v[230:231], v171 offset:8704
  v_mfma_f32_16x16x32_bf16 v[136:139], v[244:247], v[16:19], 0
  ds_read_b64_tr_b16 v[232:233], v168 offset:12288
  v_mfma_f32_16x16x32_bf16 v[136:139], v[248:251], v[24:27], v[136:139]
  s_add_u32 m0, s22, 4096
  ds_read_b64_tr_b16 v[234:235], v168 offset:12800
  v_mfma_f32_16x16x32_bf16 v[136:139], v[252:255], v[32:35], v[136:139]
  buffer_load_dwordx4 v182, s[44:47], s23 offen lds
  v_mfma_f32_16x16x32_bf16 v[140:143], v[252:255], v[36:39], 0
  s_add_u32 s23, s23, 36864
  ds_read_b64_tr_b16 v[236:237], v168 offset:16384
  v_mfma_f32_16x16x32_bf16 v[140:143], v[248:251], v[28:31], v[140:143]
  ds_read_b64_tr_b16 v[238:239], v168 offset:16896
  v_mfma_f32_16x16x32_bf16 v[140:143], v[244:247], v[20:23], v[140:143]
  s_waitcnt lgkmcnt(4)
  ds_read_b64_tr_b16 v[240:241], v168 offset:20480
  ds_read_b64_tr_b16 v[242:243], v168 offset:20992
  v_mfma_f32_16x16x32_bf16 v[148:151], v[220:223], v[20:23], 0
  ds_read_b64_tr_b16 v[244:245], v169 offset:12288
  v_mfma_f32_16x16x32_bf16 v[148:151], v[224:227], v[28:31], v[148:151]
  s_add_u32 m0, s22, 8192
  ds_read_b64_tr_b16 v[246:247], v169 offset:12800
  v_mfma_f32_16x16x32_bf16 v[148:151], v[228:231], v[36:39], v[148:151]
  buffer_load_dwordx4 v182, s[44:47], s23 offen lds
  v_mfma_f32_16x16x32_bf16 v[144:147], v[228:231], v[32:35], 0
  s_add_u32 s23, s23, 36864
  ds_read_b64_tr_b16 v[248:249], v169 offset:16384
  v_mfma_f32_16x16x32_bf16 v[144:147], v[224:227], v[24:27], v[144:147]
  ds_read_b64_tr_b16 v[250:251], v169 offset:16896
  v_mfma_f32_16x16x32_bf16 v[144:147], v[220:223], v[16:19], v[144:147]
  s_waitcnt lgkmcnt(4)
  ds_read_b64_tr_b16 v[252:253], v169 offset:20480
  ds_read_b64_tr_b16 v[254:255], v169 offset:20992
  v_mfma_f32_16x16x32_bf16 v[120:123], v[232:235], v[40:43], v[120:123]
  ds_read_b64_tr_b16 v[220:221], v170 offset:12288
  v_mfma_f32_16x16x32_bf16 v[120:123], v[236:239], v[48:51], v[120:123]
  ds_read_b64_tr_b16 v[222:223], v170 offset:12800
  v_mfma_f32_16x16x32_bf16 v[120:123], v[240:243], v[56:59], v[120:123]
  v_mfma_f32_16x16x32_bf16 v[124:127], v[240:243], v[60:63], v[124:127]
  ds_read_b64_tr_b16 v[224:225], v170 offset:16384
  v_mfma_f32_16x16x32_bf16 v[124:127], v[236:239], v[52:55], v[124:127]
  ds_read_b64_tr_b16 v[226:227], v170 offset:16896
  v_mfma_f32_16x16x32_bf16 v[124:127], v[232:235], v[44:47], v[124:127]
  s_waitcnt lgkmcnt(4)
  ds_read_b64_tr_b16 v[228:229], v170 offset:20480
  ds_read_b64_tr_b16 v[230:231], v170 offset:20992
  v_mfma_f32_16x16x32_bf16 v[132:135], v[244:247], v[44:47], v[132:135]
  ds_read_b64_tr_b16 v[232:233], v171 offset:12288
  v_mfma_f32_16x16x32_bf16 v[132:135], v[248:251], v[52:55], v[132:135]
  s_add_u32 m0, s22, 12288
  ds_read_b64_tr_b16 v[234:235], v171 offset:12800
  v_mfma_f32_16x16x32_bf16 v[132:135], v[252:255], v[60:63], v[132:135]
  buffer_load_dwordx4 v182, s[44:47], s23 offen lds
  v_mfma_f32_16x16x32_bf16 v[128:131], v[252:255], v[56:59], v[128:131]
  s_add_u32 s23, s23, 36864
  ds_read_b64_tr_b16 v[236:237], v171 offset:16384
  v_mfma_f32_16x16x32_bf16 v[128:131], v[248:251], v[48:51], v[128:131]
  ds_read_b64_tr_b16 v[238:239], v171 offset:16896
  v_mfma_f32_16x16x32_bf16 v[128:131], v[244:247], v[40:43], v[128:131]
  s_waitcnt lgkmcnt(4)
  ds_read_b64_tr_b16 v[240:241], v171 offset:20480
  ds_read_b64_tr_b16 v[242:243], v171 offset:20992
  v_mfma_f32_16x16x32_bf16 v[136:139], v[220:223], v[40:43], v[136:139]
  s_waitcnt vmcnt(5)
  ds_read_b64_tr_b16 v[244:245], v168 offset:24576
  v_mfma_f32_16x16x32_bf16 v[136:139], v[224:227], v[48:51], v[136:139]
  s_add_u32 m0, s22, 16384
  ds_read_b64_tr_b16 v[246:247], v168 offset:25088
  v_readfirstlane_b32 s53, v15
  v_mfma_f32_16x16x32_bf16 v[136:139], v[228:231], v[56:59], v[136:139]
  buffer_load_dwordx4 v182, s[44:47], s23 offen lds
  v_mfma_f32_16x16x32_bf16 v[140:143], v[228:231], v[60:63], v[140:143]
  s_add_u32 s23, s23, 36864
  ds_read_b64_tr_b16 v[248:249], v168 offset:28672
  v_mfma_f32_16x16x32_bf16 v[140:143], v[224:227], v[52:55], v[140:143]
  s_cmp_eq_u32 s53, 1
  s_cbranch_scc0 KB_SLOW3
KB_RES3:
  ds_read_b64_tr_b16 v[250:251], v168 offset:29184
  v_mfma_f32_16x16x32_bf16 v[140:143], v[220:223], v[44:47], v[140:143]
  s_waitcnt lgkmcnt(4)
  ds_read_b64_tr_b16 v[252:253], v168 offset:32768
  ds_read_b64_tr_b16 v[254:255], v168 offset:33280
  v_mfma_f32_16x16x32_bf16 v[148:151], v[232:235], v[44:47], v[148:151]
  s_nop 0
  ds_read_b64_tr_b16 v[220:221], v169 offset:24576
  ds_read_b64_tr_b16 v[222:223], v169 offset:25088
  v_mfma_f32_16x16x32_bf16 v[148:151], v[236:239], v[52:55], v[148:151]
  s_add_u32 m0, s22, 20480
  ds_read_b64_tr_b16 v[224:225], v169 offset:28672
  v_add_u32 v168, 73728, v172
  v_mfma_f32_16x16x32_bf16 v[148:151], v[240:243], v[60:63], v[148:151]
  buffer_load_dwordx4 v182, s[44:47], s23 offen lds
  v_mfma_f32_16x16x32_bf16 v[144:147], v[240:243], v[56:59], v[144:147]
  s_add_u32 s23, s23, 36864
  ds_read_b64_tr_b16 v[226:227], v169 offset:29184
  v_mfma_f32_16x16x32_bf16 v[144:147], v[236:239], v[48:51], v[144:147]
  buffer_load_dwordx4 a[192:195], v185, s[48:51], s32 offen offset:0 sc1
  v_mfma_f32_16x16x32_bf16 v[144:147], v[232:235], v[40:43], v[144:147]
  s_waitcnt lgkmcnt(4)
  ds_read_b64_tr_b16 v[228:229], v169 offset:32768
  ds_read_b64_tr_b16 v[230:231], v169 offset:33280
  v_mfma_f32_16x16x32_bf16 v[120:123], v[244:247], v[64:67], v[120:123]
  s_nop 0
  ds_read_b64_tr_b16 v[232:233], v170 offset:24576
  ds_read_b64_tr_b16 v[234:235], v170 offset:25088
  v_mfma_f32_16x16x32_bf16 v[120:123], v[248:251], v[72:75], v[120:123]
  ds_read_b64_tr_b16 v[236:237], v170 offset:28672
  v_add_u32 v169, 73728, v173
  v_mfma_f32_16x16x32_bf16 v[120:123], v[252:255], v[80:83], v[120:123]
  buffer_load_dwordx4 a[196:199], v185, s[48:51], s32 offen offset:1024 sc1
  v_mfma_f32_16x16x32_bf16 v[124:127], v[252:255], v[84:87], v[124:127]
  ds_read_b64_tr_b16 v[238:239], v170 offset:29184
  v_mfma_f32_16x16x32_bf16 v[124:127], v[248:251], v[76:79], v[124:127]
  buffer_load_dwordx4 a[200:203], v185, s[48:51], s32 offen offset:2048 sc1
  v_mfma_f32_16x16x32_bf16 v[124:127], v[244:247], v[68:71], v[124:127]
  s_waitcnt lgkmcnt(4)
  ds_read_b64_tr_b16 v[240:241], v170 offset:32768
  ds_read_b64_tr_b16 v[242:243], v170 offset:33280
  v_mfma_f32_16x16x32_bf16 v[132:135], v[220:223], v[68:71], v[132:135]
  s_nop 0
  ds_read_b64_tr_b16 v[244:245], v171 offset:24576
  ds_read_b64_tr_b16 v[246:247], v171 offset:25088
  v_mfma_f32_16x16x32_bf16 v[132:135], v[224:227], v[76:79], v[132:135]
  s_add_u32 m0, s22, 24576
  ds_read_b64_tr_b16 v[248:249], v171 offset:28672
  v_add_u32 v170, 73728, v174
  v_mfma_f32_16x16x32_bf16 v[132:135], v[228:231], v[84:87], v[132:135]
  buffer_load_dwordx4 v182, s[44:47], s23 offen lds
  v_mfma_f32_16x16x32_bf16 v[128:131], v[228:231], v[80:83], v[128:131]
  s_add_u32 s23, s23, 36864
  ds_read_b64_tr_b16 v[250:251], v171 offset:29184
  v_mfma_f32_16x16x32_bf16 v[128:131], v[224:227], v[72:75], v[128:131]
  buffer_load_dwordx4 a[204:207], v185, s[48:51], s32 offen offset:3072 sc1
  v_mfma_f32_16x16x32_bf16 v[128:131], v[220:223], v[64:67], v[128:131]
  s_waitcnt lgkmcnt(4)
  ds_read_b64_tr_b16 v[252:253], v171 offset:32768
  ds_read_b64_tr_b16 v[254:255], v171 offset:33280
  v_mfma_f32_16x16x32_bf16 v[136:139], v[232:235], v[64:67], v[136:139]
  s_add_u32 s32, s32, 4096
  ds_read_b64_tr_b16 v[220:221], v168 offset:0
  ds_read_b64_tr_b16 v[222:223], v168 offset:512
  v_mfma_f32_16x16x32_bf16 v[136:139], v[236:239], v[72:75], v[136:139]
  s_add_u32 m0, s22, 28672
  ds_read_b64_tr_b16 v[224:225], v168 offset:4096
  v_add_u32 v171, 73728, v175
  v_mfma_f32_16x16x32_bf16 v[136:139], v[240:243], v[80:83], v[136:139]
  buffer_load_dwordx4 v182, s[44:47], s23 offen lds
  v_mfma_f32_16x16x32_bf16 v[140:143], v[240:243], v[84:87], v[140:143]
  s_add_u32 s23, s23, s30
  ds_read_b64_tr_b16 v[226:227], v168 offset:4608
  v_mfma_f32_16x16x32_bf16 v[140:143], v[236:239], v[76:79], v[140:143]
  buffer_load_dwordx4 a[208:211], v185, s[48:51], s32 offen offset:0 sc1
  v_mfma_f32_16x16x32_bf16 v[140:143], v[232:235], v[68:71], v[140:143]
  s_waitcnt lgkmcnt(4)
  ds_read_b64_tr_b16 v[228:229], v168 offset:8192
  ds_read_b64_tr_b16 v[230:231], v168 offset:8704
  v_mfma_f32_16x16x32_bf16 v[148:151], v[244:247], v[68:71], v[148:151]
  s_waitcnt vmcnt(63)
  ds_read_b64_tr_b16 v[232:233], v169 offset:0
  ds_read_b64_tr_b16 v[234:235], v169 offset:512
  v_mfma_f32_16x16x32_bf16 v[148:151], v[248:251], v[76:79], v[148:151]
  s_add_u32 m0, s22, 32768
  ds_read_b64_tr_b16 v[236:237], v169 offset:4096
  v_mfma_f32_16x16x32_bf16 v[148:151], v[252:255], v[84:87], v[148:151]
  buffer_load_dwordx4 v182, s[44:47], s23 offen lds
  v_mfma_f32_16x16x32_bf16 v[144:147], v[252:255], v[80:83], v[144:147]
  ds_read_b64_tr_b16 v[238:239], v169 offset:4608
  v_mfma_f32_16x16x32_bf16 v[144:147], v[248:251], v[72:75], v[144:147]
  buffer_load_dwordx4 a[212:215], v185, s[48:51], s32 offen offset:1024 sc1
  v_mfma_f32_16x16x32_bf16 v[144:147], v[244:247], v[64:67], v[144:147]
  s_waitcnt lgkmcnt(4)
  ds_read_b64_tr_b16 v[240:241], v169 offset:8192
  ds_read_b64_tr_b16 v[242:243], v169 offset:8704
  v_mfma_f32_16x16x32_bf16 v[188:191], v[220:223], a[144:147], v[188:191]
  ds_read_b64_tr_b16 v[244:245], v170 offset:0
  v_mfma_f32_16x16x32_bf16 v[188:191], v[224:227], a[152:155], v[188:191]
  s_waitcnt vmcnt(23)
  ds_read_b64_tr_b16 v[246:247], v170 offset:512
  v_mfma_f32_16x16x32_bf16 v[188:191], v[228:231], a[160:163], v[188:191]
  s_barrier
  v_mfma_f32_16x16x32_bf16 v[192:195], v[228:231], a[164:167], v[192:195]
  ds_read_b64_tr_b16 v[248:249], v170 offset:4096
  v_mfma_f32_16x16x32_bf16 v[192:195], v[224:227], a[156:159], v[192:195]
  ds_read_b64_tr_b16 v[250:251], v170 offset:4608
  v_mfma_f32_16x16x32_bf16 v[192:195], v[220:223], a[148:151], v[192:195]
  s_waitcnt lgkmcnt(4)
  ds_read_b64_tr_b16 v[252:253], v170 offset:8192
  ds_read_b64_tr_b16 v[254:255], v170 offset:8704
  v_mfma_f32_16x16x32_bf16 v[200:203], v[232:235], a[148:151], v[200:203]
  s_add_u32 s23, s26, 384
  ds_read_b64_tr_b16 v[220:221], v171 offset:0
  v_mfma_f32_16x16x32_bf16 v[200:203], v[236:239], a[156:159], v[200:203]
  s_add_u32 m0, s22, 36864
  ds_read_b64_tr_b16 v[222:223], v171 offset:512
  v_mfma_f32_16x16x32_bf16 v[200:203], v[240:243], a[164:167], v[200:203]
  buffer_load_dwordx4 v182, s[44:47], s23 offen lds
  v_mfma_f32_16x16x32_bf16 v[196:199], v[240:243], a[160:163], v[196:199]
  s_add_u32 s23, s23, 36864
  ds_read_b64_tr_b16 v[224:225], v171 offset:4096
  v_mfma_f32_16x16x32_bf16 v[196:199], v[236:239], a[152:155], v[196:199]
  ds_read_b64_tr_b16 v[226:227], v171 offset:4608
  v_mfma_f32_16x16x32_bf16 v[196:199], v[232:235], a[144:147], v[196:199]
  s_waitcnt lgkmcnt(4)
  ds_read_b64_tr_b16 v[228:229], v171 offset:8192
  ds_read_b64_tr_b16 v[230:231], v171 offset:8704
  v_mfma_f32_16x16x32_bf16 v[204:207], v[244:247], a[144:147], v[204:207]
  ds_read_b64_tr_b16 v[232:233], v168 offset:12288
  v_mfma_f32_16x16x32_bf16 v[204:207], v[248:251], a[152:155], v[204:207]
  s_add_u32 m0, s22, 40960
  ds_read_b64_tr_b16 v[234:235], v168 offset:12800
  v_mfma_f32_16x16x32_bf16 v[204:207], v[252:255], a[160:163], v[204:207]
  buffer_load_dwordx4 v182, s[44:47], s23 offen lds
  v_mfma_f32_16x16x32_bf16 v[208:211], v[252:255], a[164:167], v[208:211]
  s_add_u32 s23, s23, 36864
  ds_read_b64_tr_b16 v[236:237], v168 offset:16384
  v_mfma_f32_16x16x32_bf16 v[208:211], v[248:251], a[156:159], v[208:211]
  ds_read_b64_tr_b16 v[238:239], v168 offset:16896
  v_mfma_f32_16x16x32_bf16 v[208:211], v[244:247], a[148:151], v[208:211]
  s_waitcnt lgkmcnt(4)
  ds_read_b64_tr_b16 v[240:241], v168 offset:20480
  ds_read_b64_tr_b16 v[242:243], v168 offset:20992
  v_mfma_f32_16x16x32_bf16 v[216:219], v[220:223], a[148:151], v[216:219]
  ds_read_b64_tr_b16 v[244:245], v169 offset:12288
  v_mfma_f32_16x16x32_bf16 v[216:219], v[224:227], a[156:159], v[216:219]
  s_add_u32 m0, s22, 45056
  ds_read_b64_tr_b16 v[246:247], v169 offset:12800
  v_mfma_f32_16x16x32_bf16 v[216:219], v[228:231], a[164:167], v[216:219]
  buffer_load_dwordx4 v182, s[44:47], s23 offen lds
  v_mfma_f32_16x16x32_bf16 v[212:215], v[228:231], a[160:163], v[212:215]
  s_add_u32 s23, s23, 36864
  ds_read_b64_tr_b16 v[248:249], v169 offset:16384
  v_mfma_f32_16x16x32_bf16 v[212:215], v[224:227], a[152:155], v[212:215]
  ds_read_b64_tr_b16 v[250:251], v169 offset:16896
  v_mfma_f32_16x16x32_bf16 v[212:215], v[220:223], a[144:147], v[212:215]
  s_waitcnt lgkmcnt(4)
  ds_read_b64_tr_b16 v[252:253], v169 offset:20480
  ds_read_b64_tr_b16 v[254:255], v169 offset:20992
  v_mfma_f32_16x16x32_bf16 v[188:191], v[232:235], a[168:171], v[188:191]
  ds_read_b64_tr_b16 v[220:221], v170 offset:12288
  v_mfma_f32_16x16x32_bf16 v[188:191], v[236:239], a[176:179], v[188:191]
  ds_read_b64_tr_b16 v[222:223], v170 offset:12800
  v_mfma_f32_16x16x32_bf16 v[188:191], v[240:243], a[184:187], v[188:191]
  buffer_load_dword v13, v186, s[48:51], s74 offen offset:0 sc1
  v_mfma_f32_16x16x32_bf16 v[192:195], v[240:243], a[188:191], v[192:195]
  ds_read_b64_tr_b16 v[224:225], v170 offset:16384
  v_mfma_f32_16x16x32_bf16 v[192:195], v[236:239], a[180:183], v[192:195]
  ds_read_b64_tr_b16 v[226:227], v170 offset:16896
  v_mfma_f32_16x16x32_bf16 v[192:195], v[232:235], a[172:175], v[192:195]
  s_waitcnt lgkmcnt(4)
  ds_read_b64_tr_b16 v[228:229], v170 offset:20480
  ds_read_b64_tr_b16 v[230:231], v170 offset:20992
  v_mfma_f32_16x16x32_bf16 v[200:203], v[244:247], a[172:175], v[200:203]
  ds_read_b64_tr_b16 v[232:233], v171 offset:12288
  v_mfma_f32_16x16x32_bf16 v[200:203], v[248:251], a[180:183], v[200:203]
  s_add_u32 m0, s22, 49152
  ds_read_b64_tr_b16 v[234:235], v171 offset:12800
  v_mfma_f32_16x16x32_bf16 v[200:203], v[252:255], a[188:191], v[200:203]
  buffer_load_dwordx4 v182, s[44:47], s23 offen lds
  v_mfma_f32_16x16x32_bf16 v[196:199], v[252:255], a[184:187], v[196:199]
  s_add_u32 s23, s23, 36864
  ds_read_b64_tr_b16 v[236:237], v171 offset:16384
  v_mfma_f32_16x16x32_bf16 v[196:199], v[248:251], a[176:179], v[196:199]
  ds_read_b64_tr_b16 v[238:239], v171 offset:16896
  v_mfma_f32_16x16x32_bf16 v[196:199], v[244:247], a[168:171], v[196:199]
  s_waitcnt lgkmcnt(4)
  ds_read_b64_tr_b16 v[240:241], v171 offset:20480
  ds_read_b64_tr_b16 v[242:243], v171 offset:20992
  v_mfma_f32_16x16x32_bf16 v[204:207], v[220:223], a[168:171], v[204:207]
  ds_read_b64_tr_b16 v[244:245], v168 offset:24576
  v_mfma_f32_16x16x32_bf16 v[204:207], v[224:227], a[176:179], v[204:207]
  s_add_u32 m0, s22, 53248
  ds_read_b64_tr_b16 v[246:247], v168 offset:25088
  v_mfma_f32_16x16x32_bf16 v[204:207], v[228:231], a[184:187], v[204:207]
  buffer_load_dwordx4 v182, s[44:47], s23 offen lds
  v_mfma_f32_16x16x32_bf16 v[208:211], v[228:231], a[188:191], v[208:211]
  s_add_u32 s23, s23, 36864
  ds_read_b64_tr_b16 v[248:249], v168 offset:28672
  v_mfma_f32_16x16x32_bf16 v[208:211], v[224:227], a[180:183], v[208:211]
  ds_read_b64_tr_b16 v[250:251], v168 offset:29184
  v_mfma_f32_16x16x32_bf16 v[208:211], v[220:223], a[172:175], v[208:211]
  s_waitcnt lgkmcnt(4)
  ds_read_b64_tr_b16 v[252:253], v168 offset:32768
  ds_read_b64_tr_b16 v[254:255], v168 offset:33280
  v_mfma_f32_16x16x32_bf16 v[216:219], v[232:235], a[172:175], v[216:219]
  ds_read_b64_tr_b16 v[220:221], v169 offset:24576
  v_add_u32 v168, 110592, v172
  v_mfma_f32_16x16x32_bf16 v[216:219], v[236:239], a[180:183], v[216:219]
  s_add_u32 m0, s22, 57344
  ds_read_b64_tr_b16 v[222:223], v169 offset:25088
  v_mfma_f32_16x16x32_bf16 v[216:219], v[240:243], a[188:191], v[216:219]
  buffer_load_dwordx4 v182, s[44:47], s23 offen lds
  v_mfma_f32_16x16x32_bf16 v[212:215], v[240:243], a[184:187], v[212:215]
  s_add_u32 s23, s23, 36864
  ds_read_b64_tr_b16 v[224:225], v169 offset:28672
  v_mfma_f32_16x16x32_bf16 v[212:215], v[236:239], a[176:179], v[212:215]
  s_waitcnt vmcnt(7)
  ds_read_b64_tr_b16 v[226:227], v169 offset:29184
  v_mfma_f32_16x16x32_bf16 v[212:215], v[232:235], a[168:171], v[212:215]
  s_waitcnt lgkmcnt(4)
  ds_read_b64_tr_b16 v[228:229], v169 offset:32768
  ds_read_b64_tr_b16 v[230:231], v169 offset:33280
  v_mfma_f32_16x16x32_bf16 v[188:191], v[244:247], a[192:195], v[188:191]
  ds_read_b64_tr_b16 v[232:233], v170 offset:24576
  v_add_u32 v169, 110592, v173
  v_mfma_f32_16x16x32_bf16 v[188:191], v[248:251], a[200:203], v[188:191]
  ds_read_b64_tr_b16 v[234:235], v170 offset:25088
  v_mfma_f32_16x16x32_bf16 v[188:191], v[252:255], a[208:211], v[188:191]
  v_mfma_f32_16x16x32_bf16 v[192:195], v[252:255], a[212:215], v[192:195]
  ds_read_b64_tr_b16 v[236:237], v170 offset:28672
  v_mfma_f32_16x16x32_bf16 v[192:195], v[248:251], a[204:207], v[192:195]
  ds_read_b64_tr_b16 v[238:239], v170 offset:29184
  v_mfma_f32_16x16x32_bf16 v[192:195], v[244:247], a[196:199], v[192:195]
  s_waitcnt lgkmcnt(4)
  ds_read_b64_tr_b16 v[240:241], v170 offset:32768
  ds_read_b64_tr_b16 v[242:243], v170 offset:33280
  v_mfma_f32_16x16x32_bf16 v[200:203], v[220:223], a[196:199], v[200:203]
  ds_read_b64_tr_b16 v[244:245], v171 offset:24576
  v_add_u32 v170, 110592, v174
  v_mfma_f32_16x16x32_bf16 v[200:203], v[224:227], a[204:207], v[200:203]
  s_add_u32 m0, s22, 61440
  ds_read_b64_tr_b16 v[246:247], v171 offset:25088
  v_mfma_f32_16x16x32_bf16 v[200:203], v[228:231], a[212:215], v[200:203]
  buffer_load_dwordx4 v182, s[44:47], s23 offen lds
  v_mfma_f32_16x16x32_bf16 v[196:199], v[228:231], a[208:211], v[196:199]
  s_add_u32 s23, s23, 36864
  ds_read_b64_tr_b16 v[248:249], v171 offset:28672
  v_cvt_pk_bf16_f32 v152, v188, v189
  v_mfma_f32_16x16x32_bf16 v[196:199], v[224:227], a[200:203], v[196:199]
  ds_read_b64_tr_b16 v[250:251], v171 offset:29184
  v_cvt_pk_bf16_f32 v153, v190, v191
  v_mfma_f32_16x16x32_bf16 v[196:199], v[220:223], a[192:195], v[196:199]
  s_waitcnt lgkmcnt(4)
  ds_read_b64_tr_b16 v[252:253], v171 offset:32768
  ds_read_b64_tr_b16 v[254:255], v171 offset:33280
  v_mfma_f32_16x16x32_bf16 v[204:207], v[232:235], a[192:195], v[204:207]
  ds_read_b64_tr_b16 v[220:221], v168 offset:0
  v_add_u32 v171, 110592, v175
  v_mfma_f32_16x16x32_bf16 v[204:207], v[236:239], a[200:203], v[204:207]
  s_add_u32 m0, s22, 65536
  ds_read_b64_tr_b16 v[222:223], v168 offset:512
  v_cvt_pk_bf16_f32 v156, v192, v193
  v_mfma_f32_16x16x32_bf16 v[204:207], v[240:243], a[208:211], v[204:207]
  buffer_load_dwordx4 v182, s[44:47], s23 offen lds
  v_mfma_f32_16x16x32_bf16 v[208:211], v[240:243], a[212:215], v[208:211]
  s_add_u32 s23, s23, s27
  ds_read_b64_tr_b16 v[224:225], v168 offset:4096
  v_cvt_pk_bf16_f32 v154, v196, v197
  v_mfma_f32_16x16x32_bf16 v[208:211], v[236:239], a[204:207], v[208:211]
  ds_read_b64_tr_b16 v[226:227], v168 offset:4608
  v_cvt_pk_bf16_f32 v155, v198, v199
  v_mfma_f32_16x16x32_bf16 v[208:211], v[232:235], a[196:199], v[208:211]
  s_waitcnt lgkmcnt(4)
  ds_read_b64_tr_b16 v[228:229], v168 offset:8192
  ds_read_b64_tr_b16 v[230:231], v168 offset:8704
  v_mfma_f32_16x16x32_bf16 v[216:219], v[244:247], a[196:199], v[216:219]
  ds_read_b64_tr_b16 v[232:233], v169 offset:0
  v_cvt_pk_bf16_f32 v157, v194, v195
  v_mfma_f32_16x16x32_bf16 v[216:219], v[248:251], a[204:207], v[216:219]
  s_add_u32 m0, s22, 69632
  ds_read_b64_tr_b16 v[234:235], v169 offset:512
  v_cvt_pk_bf16_f32 v158, v200, v201
  v_mfma_f32_16x16x32_bf16 v[216:219], v[252:255], a[212:215], v[216:219]
  buffer_load_dwordx4 v182, s[44:47], s23 offen lds
  v_mfma_f32_16x16x32_bf16 v[212:215], v[252:255], a[208:211], v[212:215]
  ds_read_b64_tr_b16 v[236:237], v169 offset:4096
  v_cvt_pk_bf16_f32 v159, v202, v203
  v_mfma_f32_16x16x32_bf16 v[212:215], v[248:251], a[200:203], v[212:215]
  ds_read_b64_tr_b16 v[238:239], v169 offset:4608
  v_cvt_pk_bf16_f32 v160, v204, v205
  v_mfma_f32_16x16x32_bf16 v[212:215], v[244:247], a[192:195], v[212:215]
  s_waitcnt lgkmcnt(4)
  ds_read_b64_tr_b16 v[240:241], v169 offset:8192
  ds_read_b64_tr_b16 v[242:243], v169 offset:8704
  v_mfma_f32_16x16x32_bf16 v[88:91], v[220:223], a[144:147], v[88:91]
  s_nop 0
  ds_read_b64_tr_b16 v[244:245], v170 offset:0
  ds_read_b64_tr_b16 v[246:247], v170 offset:512
  v_mfma_f32_16x16x32_bf16 v[88:91], v[224:227], a[152:155], v[88:91]
  s_waitcnt vmcnt(22)
  ds_read_b64_tr_b16 v[248:249], v170 offset:4096
  v_cvt_pk_bf16_f32 v161, v206, v207
  v_mfma_f32_16x16x32_bf16 v[88:91], v[228:231], a[160:163], v[88:91]
  s_barrier
  v_mfma_f32_16x16x32_bf16 v[92:95], v[228:231], a[164:167], v[92:95]
KB_I9:
  s_cbranch_execz KB_I12
  ds_read_b64_tr_b16 v[250:251], v170 offset:4608
  v_cvt_pk_bf16_f32 v162, v212, v213
  v_mfma_f32_16x16x32_bf16 v[92:95], v[224:227], a[156:159], v[92:95]
  buffer_store_dwordx4 v[152:155], v183, s[48:51], s28 offen offset:0 sc1
  v_mfma_f32_16x16x32_bf16 v[92:95], v[220:223], a[148:151], v[92:95]
  s_waitcnt lgkmcnt(4)
  ds_read_b64_tr_b16 v[252:253], v170 offset:8192
  ds_read_b64_tr_b16 v[254:255], v170 offset:8704
  v_mfma_f32_16x16x32_bf16 v[100:103], v[232:235], a[148:151], v[100:103]
  s_add_u32 s23, s29, 384
  ds_read_b64_tr_b16 v[220:221], v171 offset:0
  v_cvt_pk_bf16_f32 v163, v214, v215
  v_mfma_f32_16x16x32_bf16 v[100:103], v[236:239], a[156:159], v[100:103]
  s_add_u32 m0, s22, 73728
  ds_read_b64_tr_b16 v[222:223], v171 offset:512
  v_cvt_pk_bf16_f32 v164, v208, v209
  v_mfma_f32_16x16x32_bf16 v[100:103], v[240:243], a[164:167], v[100:103]
  buffer_load_dwordx4 v182, s[44:47], s23 offen lds
  v_mfma_f32_16x16x32_bf16 v[96:99], v[240:243], a[160:163], v[96:99]
  s_add_u32 s23, s23, 36864
  ds_read_b64_tr_b16 v[224:225], v171 offset:4096
  v_cvt_pk_bf16_f32 v165, v210, v211
  v_mfma_f32_16x16x32_bf16 v[96:99], v[236:239], a[152:155], v[96:99]
  ds_read_b64_tr_b16 v[226:227], v171 offset:4608
  v_cvt_pk_bf16_f32 v166, v216, v217
  v_mfma_f32_16x16x32_bf16 v[96:99], v[232:235], a[144:147], v[96:99]
  s_waitcnt lgkmcnt(4)
  ds_read_b64_tr_b16 v[228:229], v171 offset:8192
  ds_read_b64_tr_b16 v[230:231], v171 offset:8704
  v_mfma_f32_16x16x32_bf16 v[104:107], v[244:247], a[144:147], v[104:107]
  s_nop 0
  ds_read_b64_tr_b16 v[232:233], v168 offset:12288
  ds_read_b64_tr_b16 v[234:235], v168 offset:12800
  v_mfma_f32_16x16x32_bf16 v[104:107], v[248:251], a[152:155], v[104:107]
  s_add_u32 m0, s22, 77824
  ds_read_b64_tr_b16 v[236:237], v168 offset:16384
  v_cvt_pk_bf16_f32 v167, v218, v219
  v_mfma_f32_16x16x32_bf16 v[104:107], v[252:255], a[160:163], v[104:107]
  buffer_load_dwordx4 v182, s[44:47], s23 offen lds
  v_mfma_f32_16x16x32_bf16 v[108:111], v[252:255], a[164:167], v[108:111]
  s_add_u32 s23, s23, 36864
  ds_read_b64_tr_b16 v[238:239], v168 offset:16896
  v_mfma_f32_16x16x32_bf16 v[108:111], v[248:251], a[156:159], v[108:111]
  buffer_store_dwordx4 v[156:159], v183, s[48:51], s28 offen offset:2048 sc1
  v_mfma_f32_16x16x32_bf16 v[108:111], v[244:247], a[148:151], v[108:111]
  s_waitcnt lgkmcnt(4)
  ds_read_b64_tr_b16 v[240:241], v168 offset:20480
  ds_read_b64_tr_b16 v[242:243], v168 offset:20992
  v_mfma_f32_16x16x32_bf16 v[116:119], v[220:223], a[148:151], v[116:119]
  s_nop 0
  ds_read_b64_tr_b16 v[244:245], v169 offset:12288
  ds_read_b64_tr_b16 v[246:247], v169 offset:12800
  v_mfma_f32_16x16x32_bf16 v[116:119], v[224:227], a[156:159], v[116:119]
  s_add_u32 m0, s22, 81920
  ds_read_b64_tr_b16 v[248:249], v169 offset:16384
  v_mfma_f32_16x16x32_bf16 v[116:119], v[228:231], a[164:167], v[116:119]
  buffer_load_dwordx4 v182, s[44:47], s23 offen lds
  v_mfma_f32_16x16x32_bf16 v[112:115], v[228:231], a[160:163], v[112:115]
  s_add_u32 s23, s23, 36864
  ds_read_b64_tr_b16 v[250:251], v169 offset:16896
  v_mfma_f32_16x16x32_bf16 v[112:115], v[224:227], a[152:155], v[112:115]
  buffer_store_dwordx4 v[160:163], v183, s[48:51], s28 offen offset:1024 sc1
  v_mfma_f32_16x16x32_bf16 v[112:115], v[220:223], a[144:147], v[112:115]
  s_waitcnt lgkmcnt(4)
  ds_read_b64_tr_b16 v[252:253], v169 offset:20480
  ds_read_b64_tr_b16 v[254:255], v169 offset:20992
  v_mfma_f32_16x16x32_bf16 v[88:91], v[232:235], a[168:171], v[88:91]
  s_nop 0
  ds_read_b64_tr_b16 v[220:221], v170 offset:12288
  ds_read_b64_tr_b16 v[222:223], v170 offset:12800
  v_mfma_f32_16x16x32_bf16 v[88:91], v[236:239], a[176:179], v[88:91]
  ds_read_b64_tr_b16 v[224:225], v170 offset:16384
  v_mfma_f32_16x16x32_bf16 v[88:91], v[240:243], a[184:187], v[88:91]
  v_mfma_f32_16x16x32_bf16 v[92:95], v[240:243], a[188:191], v[92:95]
  ds_read_b64_tr_b16 v[226:227], v170 offset:16896
  v_mfma_f32_16x16x32_bf16 v[92:95], v[236:239], a[180:183], v[92:95]
  buffer_store_dwordx4 v[164:167], v183, s[48:51], s28 offen offset:3072 sc1
  v_mfma_f32_16x16x32_bf16 v[92:95], v[232:235], a[172:175], v[92:95]
  s_waitcnt lgkmcnt(4)
  ds_read_b64_tr_b16 v[228:229], v170 offset:20480
  ds_read_b64_tr_b16 v[230:231], v170 offset:20992
  v_mfma_f32_16x16x32_bf16 v[100:103], v[244:247], a[172:175], v[100:103]
  s_add_u32 s28, s28, 16384
  s_waitcnt vmcnt(13)
  ds_read_b64_tr_b16 v[232:233], v171 offset:12288
  v_mfma_f32_16x16x32_bf16 v[100:103], v[248:251], a[180:183], v[100:103]
  s_add_u32 m0, s22, 86016
  ds_read_b64_tr_b16 v[234:235], v171 offset:12800
  v_readfirstlane_b32 s53, v13
  v_mfma_f32_16x16x32_bf16 v[100:103], v[252:255], a[188:191], v[100:103]
  buffer_load_dwordx4 v182, s[44:47], s23 offen lds
  v_mfma_f32_16x16x32_bf16 v[96:99], v[252:255], a[184:187], v[96:99]
  s_add_u32 s23, s23, 36864
  ds_read_b64_tr_b16 v[236:237], v171 offset:16384
  v_mfma_f32_16x16x32_bf16 v[96:99], v[248:251], a[176:179], v[96:99]
  s_cmp_eq_u32 s53, 16
  s_cselect_b32 s36, s72, 1073741824
  ds_read_b64_tr_b16 v[238:239], v171 offset:16896
  v_mfma_f32_16x16x32_bf16 v[96:99], v[244:247], a[168:171], v[96:99]
  s_waitcnt lgkmcnt(4)
  ds_read_b64_tr_b16 v[240:241], v171 offset:20480
  ds_read_b64_tr_b16 v[242:243], v171 offset:20992
  v_mfma_f32_16x16x32_bf16 v[104:107], v[220:223], a[168:171], v[104:107]
  s_nop 0
  ds_read_b64_tr_b16 v[244:245], v168 offset:24576
  ds_read_b64_tr_b16 v[246:247], v168 offset:25088
  v_mfma_f32_16x16x32_bf16 v[104:107], v[224:227], a[176:179], v[104:107]
  s_add_u32 m0, s22, 90112
  ds_read_b64_tr_b16 v[248:249], v168 offset:28672
  v_mfma_f32_16x16x32_bf16 v[104:107], v[228:231], a[184:187], v[104:107]
  buffer_load_dwordx4 v182, s[44:47], s23 offen lds
  v_mfma_f32_16x16x32_bf16 v[108:111], v[228:231], a[188:191], v[108:111]
  s_add_u32 s23, s23, 36864
  s_add_u32 s73, s36, 0
  ds_read_b64_tr_b16 v[250:251], v168 offset:29184
  v_mfma_f32_16x16x32_bf16 v[108:111], v[224:227], a[180:183], v[108:111]
  buffer_load_dwordx4 a[0:3], v180, s[48:51], s73 offen sc1
  v_mfma_f32_16x16x32_bf16 v[108:111], v[220:223], a[172:175], v[108:111]
  s_waitcnt lgkmcnt(4)
  ds_read_b64_tr_b16 v[252:253], v168 offset:32768
  ds_read_b64_tr_b16 v[254:255], v168 offset:33280
  v_mfma_f32_16x16x32_bf16 v[116:119], v[232:235], a[172:175], v[116:119]
  s_nop 0
  ds_read_b64_tr_b16 v[220:221], v169 offset:24576
  ds_read_b64_tr_b16 v[222:223], v169 offset:25088
  v_mfma_f32_16x16x32_bf16 v[116:119], v[236:239], a[180:183], v[116:119]
  s_add_u32 m0, s22, 94208
  ds_read_b64_tr_b16 v[224:225], v169 offset:28672
  v_add_u32 v168, 0, v172
  v_mfma_f32_16x16x32_bf16 v[116:119], v[240:243], a[188:191], v[116:119]
  buffer_load_dwordx4 v182, s[44:47], s23 offen lds
  v_mfma_f32_16x16x32_bf16 v[112:115], v[240:243], a[184:187], v[112:115]
  s_add_u32 s23, s23, 36864
  s_add_u32 s73, s36, 327680
  ds_read_b64_tr_b16 v[226:227], v169 offset:29184
  v_mfma_f32_16x16x32_bf16 v[112:115], v[236:239], a[176:179], v[112:115]
  buffer_load_dwordx4 a[4:7], v180, s[48:51], s73 offen sc1
  v_mfma_f32_16x16x32_bf16 v[112:115], v[232:235], a[168:171], v[112:115]
  s_waitcnt lgkmcnt(4)
  ds_read_b64_tr_b16 v[228:229], v169 offset:32768
  ds_read_b64_tr_b16 v[230:231], v169 offset:33280
  v_mfma_f32_16x16x32_bf16 v[88:91], v[244:247], a[192:195], v[88:91]
  s_nop 0
  ds_read_b64_tr_b16 v[232:233], v170 offset:24576
  ds_read_b64_tr_b16 v[234:235], v170 offset:25088
  v_mfma_f32_16x16x32_bf16 v[88:91], v[248:251], a[200:203], v[88:91]
  s_add_u32 s73, s36, 655360
  ds_read_b64_tr_b16 v[236:237], v170 offset:28672
  v_add_u32 v169, 0, v173
  v_mfma_f32_16x16x32_bf16 v[88:91], v[252:255], a[208:211], v[88:91]
  buffer_load_dwordx4 a[8:11], v180, s[48:51], s73 offen sc1
  v_mfma_f32_16x16x32_bf16 v[92:95], v[252:255], a[212:215], v[92:95]
  s_add_u32 s73, s36, 983040
  ds_read_b64_tr_b16 v[238:239], v170 offset:29184
  v_mfma_f32_16x16x32_bf16 v[92:95], v[248:251], a[204:207], v[92:95]
  buffer_load_dwordx4 a[12:15], v180, s[48:51], s73 offen sc1
  v_mfma_f32_16x16x32_bf16 v[92:95], v[244:247], a[196:199], v[92:95]
  s_waitcnt lgkmcnt(4)
  ds_read_b64_tr_b16 v[240:241], v170 offset:32768
  ds_read_b64_tr_b16 v[242:243], v170 offset:33280
  v_mfma_f32_16x16x32_bf16 v[100:103], v[220:223], a[196:199], v[100:103]
  ds_read_b64_tr_b16 v[244:245], v171 offset:24576
  v_add_u32 v170, 0, v174
  v_mfma_f32_16x16x32_bf16 v[100:103], v[224:227], a[204:207], v[100:103]
  s_add_u32 m0, s22, 98304
  ds_read_b64_tr_b16 v[246:247], v171 offset:25088
  v_mfma_f32_16x16x32_bf16 v[100:103], v[228:231], a[212:215], v[100:103]
  buffer_load_dwordx4 v182, s[44:47], s23 offen lds
  v_mfma_f32_16x16x32_bf16 v[96:99], v[228:231], a[208:211], v[96:99]
  s_add_u32 s23, s23, 36864
  ds_read_b64_tr_b16 v[248:249], v171 offset:28672
  v_cvt_pk_bf16_f32 v152, v88, v89
  v_mfma_f32_16x16x32_bf16 v[96:99], v[224:227], a[200:203], v[96:99]
  ds_read_b64_tr_b16 v[250:251], v171 offset:29184
  v_cvt_pk_bf16_f32 v153, v90, v91
  v_mfma_f32_16x16x32_bf16 v[96:99], v[220:223], a[192:195], v[96:99]
  s_waitcnt lgkmcnt(4)
  ds_read_b64_tr_b16 v[252:253], v171 offset:32768
  ds_read_b64_tr_b16 v[254:255], v171 offset:33280
  v_mfma_f32_16x16x32_bf16 v[104:107], v[232:235], a[192:195], v[104:107]
  ds_read_b64_tr_b16 v[220:221], v168 offset:0
  v_add_u32 v171, 0, v175
  v_mfma_f32_16x16x32_bf16 v[104:107], v[236:239], a[200:203], v[104:107]
  s_add_u32 m0, s22, 102400
  ds_read_b64_tr_b16 v[222:223], v168 offset:512
  v_cvt_pk_bf16_f32 v156, v92, v93
  v_mfma_f32_16x16x32_bf16 v[104:107], v[240:243], a[208:211], v[104:107]
  buffer_load_dwordx4 v182, s[44:47], s23 offen lds
  v_mfma_f32_16x16x32_bf16 v[108:111], v[240:243], a[212:215], v[108:111]
  s_add_u32 s23, s23, s30
  ds_read_b64_tr_b16 v[224:225], v168 offset:4096
  v_cvt_pk_bf16_f32 v154, v96, v97
  v_mfma_f32_16x16x32_bf16 v[108:111], v[236:239], a[204:207], v[108:111]
  ds_read_b64_tr_b16 v[226:227], v168 offset:4608
  v_cvt_pk_bf16_f32 v155, v98, v99
  v_mfma_f32_16x16x32_bf16 v[108:111], v[232:235], a[196:199], v[108:111]
  s_waitcnt lgkmcnt(4)
  ds_read_b64_tr_b16 v[228:229], v168 offset:8192
  ds_read_b64_tr_b16 v[230:231], v168 offset:8704
  v_mfma_f32_16x16x32_bf16 v[116:119], v[244:247], a[196:199], v[116:119]
  ds_read_b64_tr_b16 v[232:233], v169 offset:0
  v_cvt_pk_bf16_f32 v157, v94, v95
  v_mfma_f32_16x16x32_bf16 v[116:119], v[248:251], a[204:207], v[116:119]
  s_add_u32 m0, s22, 106496
  ds_read_b64_tr_b16 v[234:235], v169 offset:512
  v_cvt_pk_bf16_f32 v158, v100, v101
  v_mfma_f32_16x16x32_bf16 v[116:119], v[252:255], a[212:215], v[116:119]
  buffer_load_dwordx4 v182, s[44:47], s23 offen lds
  v_mfma_f32_16x16x32_bf16 v[112:115], v[252:255], a[208:211], v[112:115]
  ds_read_b64_tr_b16 v[236:237], v169 offset:4096
  v_cvt_pk_bf16_f32 v159, v102, v103
  v_mfma_f32_16x16x32_bf16 v[112:115], v[248:251], a[200:203], v[112:115]
  ds_read_b64_tr_b16 v[238:239], v169 offset:4608
  v_cvt_pk_bf16_f32 v160, v104, v105
  v_mfma_f32_16x16x32_bf16 v[112:115], v[244:247], a[192:195], v[112:115]
  s_waitcnt lgkmcnt(4)
  ds_read_b64_tr_b16 v[240:241], v169 offset:8192
  ds_read_b64_tr_b16 v[242:243], v169 offset:8704
  v_mfma_f32_16x16x32_bf16 v[120:123], v[220:223], a[144:147], v[120:123]
  s_nop 0
  ds_read_b64_tr_b16 v[244:245], v170 offset:0
  ds_read_b64_tr_b16 v[246:247], v170 offset:512
  v_mfma_f32_16x16x32_bf16 v[120:123], v[224:227], a[152:155], v[120:123]
  s_waitcnt vmcnt(24)
  ds_read_b64_tr_b16 v[248:249], v170 offset:4096
  v_cvt_pk_bf16_f32 v161, v106, v107
  v_mfma_f32_16x16x32_bf16 v[120:123], v[228:231], a[160:163], v[120:123]
  s_barrier
  v_mfma_f32_16x16x32_bf16 v[124:127], v[228:231], a[164:167], v[124:127]
  ds_read_b64_tr_b16 v[250:251], v170 offset:4608
  v_cvt_pk_bf16_f32 v162, v112, v113
  v_mfma_f32_16x16x32_bf16 v[124:127], v[224:227], a[156:159], v[124:127]
  buffer_store_dwordx4 v[152:155], v183, s[48:51], s28 offen offset:0 sc1
  v_mfma_f32_16x16x32_bf16 v[124:127], v[220:223], a[148:151], v[124:127]
  s_waitcnt lgkmcnt(4)
  ds_read_b64_tr_b16 v[252:253], v170 offset:8192
  ds_read_b64_tr_b16 v[254:255], v170 offset:8704
  v_mfma_f32_16x16x32_bf16 v[132:135], v[232:235], a[148:151], v[132:135]
  ds_read_b64_tr_b16 v[220:221], v171 offset:0
  v_cvt_pk_bf16_f32 v163, v114, v115
  v_mfma_f32_16x16x32_bf16 v[132:135], v[236:239], a[156:159], v[132:135]
  ds_read_b64_tr_b16 v[222:223], v171 offset:512
  v_cvt_pk_bf16_f32 v164, v108, v109
  v_mfma_f32_16x16x32_bf16 v[132:135], v[240:243], a[164:167], v[132:135]
  v_mfma_f32_16x16x32_bf16 v[128:131], v[240:243], a[160:163], v[128:131]
  ds_read_b64_tr_b16 v[224:225], v171 offset:4096
  v_cvt_pk_bf16_f32 v165, v110, v111
  v_mfma_f32_16x16x32_bf16 v[128:131], v[236:239], a[152:155], v[128:131]
  ds_read_b64_tr_b16 v[226:227], v171 offset:4608
  v_cvt_pk_bf16_f32 v166, v116, v117
  v_mfma_f32_16x16x32_bf16 v[128:131], v[232:235], a[144:147], v[128:131]
  s_waitcnt lgkmcnt(4)
  ds_read_b64_tr_b16 v[228:229], v171 offset:8192
  ds_read_b64_tr_b16 v[230:231], v171 offset:8704
  v_mfma_f32_16x16x32_bf16 v[136:139], v[244:247], a[144:147], v[136:139]
  s_nop 0
  ds_read_b64_tr_b16 v[232:233], v168 offset:12288
  ds_read_b64_tr_b16 v[234:235], v168 offset:12800
  v_mfma_f32_16x16x32_bf16 v[136:139], v[248:251], a[152:155], v[136:139]
  ds_read_b64_tr_b16 v[236:237], v168 offset:16384
  v_cvt_pk_bf16_f32 v167, v118, v119
  v_mfma_f32_16x16x32_bf16 v[136:139], v[252:255], a[160:163], v[136:139]
  v_mfma_f32_16x16x32_bf16 v[140:143], v[252:255], a[164:167], v[140:143]
  ds_read_b64_tr_b16 v[238:239], v168 offset:16896
  v_accvgpr_read_b32 v180, a243
  v_mfma_f32_16x16x32_bf16 v[140:143], v[248:251], a[156:159], v[140:143]
  buffer_store_dwordx4 v[156:159], v183, s[48:51], s28 offen offset:2048 sc1
  v_mfma_f32_16x16x32_bf16 v[140:143], v[244:247], a[148:151], v[140:143]
  s_waitcnt lgkmcnt(4)
  ds_read_b64_tr_b16 v[240:241], v168 offset:20480
  ds_read_b64_tr_b16 v[242:243], v168 offset:20992
  v_mfma_f32_16x16x32_bf16 v[148:151], v[220:223], a[148:151], v[148:151]
  s_nop 0
  ds_read_b64_tr_b16 v[244:245], v169 offset:12288
  ds_read_b64_tr_b16 v[246:247], v169 offset:12800
  v_mfma_f32_16x16x32_bf16 v[148:151], v[224:227], a[156:159], v[148:151]
  ds_read_b64_tr_b16 v[248:249], v169 offset:16384
  v_mfma_f32_16x16x32_bf16 v[148:151], v[228:231], a[164:167], v[148:151]
  v_mfma_f32_16x16x32_bf16 v[144:147], v[228:231], a[160:163], v[144:147]
  ds_read_b64_tr_b16 v[250:251], v169 offset:16896
  v_mfma_f32_16x16x32_bf16 v[144:147], v[224:227], a[152:155], v[144:147]
  buffer_store_dwordx4 v[160:163], v183, s[48:51], s28 offen offset:1024 sc1
  v_mfma_f32_16x16x32_bf16 v[144:147], v[220:223], a[144:147], v[144:147]
  s_waitcnt lgkmcnt(4)
  ds_read_b64_tr_b16 v[252:253], v169 offset:20480
  ds_read_b64_tr_b16 v[254:255], v169 offset:20992
  v_mfma_f32_16x16x32_bf16 v[120:123], v[232:235], a[168:171], v[120:123]
  s_nop 0
  ds_read_b64_tr_b16 v[220:221], v170 offset:12288
  ds_read_b64_tr_b16 v[222:223], v170 offset:12800
  v_mfma_f32_16x16x32_bf16 v[120:123], v[236:239], a[176:179], v[120:123]
  s_waitcnt vmcnt(13)
  ds_read_b64_tr_b16 v[224:225], v170 offset:16384
  v_mfma_f32_16x16x32_bf16 v[120:123], v[240:243], a[184:187], v[120:123]
  s_barrier
  v_mfma_f32_16x16x32_bf16 v[124:127], v[240:243], a[188:191], v[124:127]
  ds_read_b64_tr_b16 v[226:227], v170 offset:16896
  v_mfma_f32_16x16x32_bf16 v[124:127], v[236:239], a[180:183], v[124:127]
  buffer_store_dwordx4 v[164:167], v183, s[48:51], s28 offen offset:3072 sc1
  v_mfma_f32_16x16x32_bf16 v[124:127], v[232:235], a[172:175], v[124:127]
  s_waitcnt lgkmcnt(4)
  ds_read_b64_tr_b16 v[228:229], v170 offset:20480
  ds_read_b64_tr_b16 v[230:231], v170 offset:20992
  v_mfma_f32_16x16x32_bf16 v[132:135], v[244:247], a[172:175], v[132:135]
  s_add_u32 s28, s28, 16384
  ds_read_b64_tr_b16 v[232:233], v171 offset:12288
  ds_read_b64_tr_b16 v[234:235], v171 offset:12800
  v_mfma_f32_16x16x32_bf16 v[132:135], v[248:251], a[180:183], v[132:135]
  ds_read_b64_tr_b16 v[236:237], v171 offset:16384
  v_mfma_f32_16x16x32_bf16 v[132:135], v[252:255], a[188:191], v[132:135]
  v_mfma_f32_16x16x32_bf16 v[128:131], v[252:255], a[184:187], v[128:131]
  ds_read_b64_tr_b16 v[238:239], v171 offset:16896
  v_mfma_f32_16x16x32_bf16 v[128:131], v[248:251], a[176:179], v[128:131]
  buffer_atomic_add v14, v12, s[48:51], s74 offen offset:128 sc1
  v_mfma_f32_16x16x32_bf16 v[128:131], v[244:247], a[168:171], v[128:131]
  s_waitcnt lgkmcnt(4)
  ds_read_b64_tr_b16 v[240:241], v171 offset:20480
  ds_read_b64_tr_b16 v[242:243], v171 offset:20992
  v_mfma_f32_16x16x32_bf16 v[136:139], v[220:223], a[168:171], v[136:139]
  ds_read_b64_tr_b16 v[244:245], v168 offset:24576
  v_mfma_f32_16x16x32_bf16 v[136:139], v[224:227], a[176:179], v[136:139]
  ds_read_b64_tr_b16 v[246:247], v168 offset:25088
  v_mfma_f32_16x16x32_bf16 v[136:139], v[228:231], a[184:187], v[136:139]
  v_mfma_f32_16x16x32_bf16 v[140:143], v[228:231], a[188:191], v[140:143]
  ds_read_b64_tr_b16 v[248:249], v168 offset:28672
  v_mfma_f32_16x16x32_bf16 v[140:143], v[224:227], a[180:183], v[140:143]
  ds_read_b64_tr_b16 v[250:251], v168 offset:29184
  v_mfma_f32_16x16x32_bf16 v[140:143], v[220:223], a[172:175], v[140:143]
  s_waitcnt lgkmcnt(4)
  ds_read_b64_tr_b16 v[252:253], v168 offset:32768
  ds_read_b64_tr_b16 v[254:255], v168 offset:33280
  v_mfma_f32_16x16x32_bf16 v[148:151], v[232:235], a[172:175], v[148:151]
  ds_read_b64_tr_b16 v[220:221], v169 offset:24576
  v_add_u32 v168, 36864, v172
  v_mfma_f32_16x16x32_bf16 v[148:151], v[236:239], a[180:183], v[148:151]
  ds_read_b64_tr_b16 v[222:223], v169 offset:25088
  v_mfma_f32_16x16x32_bf16 v[148:151], v[240:243], a[188:191], v[148:151]
  v_mfma_f32_16x16x32_bf16 v[144:147], v[240:243], a[184:187], v[144:147]
  ds_read_b64_tr_b16 v[224:225], v169 offset:28672
  v_mfma_f32_16x16x32_bf16 v[144:147], v[236:239], a[176:179], v[144:147]
  ds_read_b64_tr_b16 v[226:227], v169 offset:29184
  v_mfma_f32_16x16x32_bf16 v[144:147], v[232:235], a[168:171], v[144:147]
  s_waitcnt lgkmcnt(4)
  ds_read_b64_tr_b16 v[228:229], v169 offset:32768
  ds_read_b64_tr_b16 v[230:231], v169 offset:33280
  v_mfma_f32_16x16x32_bf16 v[120:123], v[244:247], a[192:195], v[120:123]
  ds_read_b64_tr_b16 v[232:233], v170 offset:24576
  v_add_u32 v169, 36864, v173
  v_mfma_f32_16x16x32_bf16 v[120:123], v[248:251], a[200:203], v[120:123]
  ds_read_b64_tr_b16 v[234:235], v170 offset:25088
  v_mfma_f32_16x16x32_bf16 v[120:123], v[252:255], a[208:211], v[120:123]
  v_mfma_f32_16x16x32_bf16 v[124:127], v[252:255], a[212:215], v[124:127]
  ds_read_b64_tr_b16 v[236:237], v170 offset:28672
  v_mfma_f32_16x16x32_bf16 v[124:127], v[248:251], a[204:207], v[124:127]
  ds_read_b64_tr_b16 v[238:239], v170 offset:29184
  v_mfma_f32_16x16x32_bf16 v[124:127], v[244:247], a[196:199], v[124:127]
  s_waitcnt lgkmcnt(4)
  ds_read_b64_tr_b16 v[240:241], v170 offset:32768
  ds_read_b64_tr_b16 v[242:243], v170 offset:33280
  v_mfma_f32_16x16x32_bf16 v[132:135], v[220:223], a[196:199], v[132:135]
  ds_read_b64_tr_b16 v[244:245], v171 offset:24576
  v_add_u32 v170, 36864, v174
  v_mfma_f32_16x16x32_bf16 v[132:135], v[224:227], a[204:207], v[132:135]
  ds_read_b64_tr_b16 v[246:247], v171 offset:25088
  v_mfma_f32_16x16x32_bf16 v[132:135], v[228:231], a[212:215], v[132:135]
  v_mfma_f32_16x16x32_bf16 v[128:131], v[228:231], a[208:211], v[128:131]
  ds_read_b64_tr_b16 v[248:249], v171 offset:28672
  v_cvt_pk_bf16_f32 v152, v120, v121
  v_mfma_f32_16x16x32_bf16 v[128:131], v[224:227], a[200:203], v[128:131]
  ds_read_b64_tr_b16 v[250:251], v171 offset:29184
  v_cvt_pk_bf16_f32 v153, v122, v123
  v_mfma_f32_16x16x32_bf16 v[128:131], v[220:223], a[192:195], v[128:131]
  s_waitcnt lgkmcnt(4)
  ds_read_b64_tr_b16 v[252:253], v171 offset:32768
  ds_read_b64_tr_b16 v[254:255], v171 offset:33280
  v_mfma_f32_16x16x32_bf16 v[136:139], v[232:235], a[192:195], v[136:139]
  ds_read_b64_tr_b16 v[220:221], v168 offset:0
  v_add_u32 v171, 36864, v175
  v_mfma_f32_16x16x32_bf16 v[136:139], v[236:239], a[200:203], v[136:139]
  ds_read_b64_tr_b16 v[222:223], v168 offset:512
  v_cvt_pk_bf16_f32 v156, v124, v125
  v_mfma_f32_16x16x32_bf16 v[136:139], v[240:243], a[208:211], v[136:139]
  v_mfma_f32_16x16x32_bf16 v[140:143], v[240:243], a[212:215], v[140:143]
  ds_read_b64_tr_b16 v[224:225], v168 offset:4096
  v_cvt_pk_bf16_f32 v154, v128, v129
  v_mfma_f32_16x16x32_bf16 v[140:143], v[236:239], a[204:207], v[140:143]
  ds_read_b64_tr_b16 v[226:227], v168 offset:4608
  v_cvt_pk_bf16_f32 v155, v130, v131
  v_mfma_f32_16x16x32_bf16 v[140:143], v[232:235], a[196:199], v[140:143]
  s_waitcnt lgkmcnt(4)
  ds_read_b64_tr_b16 v[228:229], v168 offset:8192
  ds_read_b64_tr_b16 v[230:231], v168 offset:8704
  v_mfma_f32_16x16x32_bf16 v[148:151], v[244:247], a[196:199], v[148:151]
  ds_read_b64_tr_b16 v[232:233], v169 offset:0
  v_cvt_pk_bf16_f32 v157, v126, v127
  v_mfma_f32_16x16x32_bf16 v[148:151], v[248:251], a[204:207], v[148:151]
  ds_read_b64_tr_b16 v[234:235], v169 offset:512
  v_cvt_pk_bf16_f32 v158, v132, v133
  v_mfma_f32_16x16x32_bf16 v[148:151], v[252:255], a[212:215], v[148:151]
  v_mfma_f32_16x16x32_bf16 v[144:147], v[252:255], a[208:211], v[144:147]
  ds_read_b64_tr_b16 v[236:237], v169 offset:4096
  v_cvt_pk_bf16_f32 v159, v134, v135
  v_mfma_f32_16x16x32_bf16 v[144:147], v[248:251], a[200:203], v[144:147]
  ds_read_b64_tr_b16 v[238:239], v169 offset:4608
  v_cvt_pk_bf16_f32 v160, v136, v137
  v_mfma_f32_16x16x32_bf16 v[144:147], v[244:247], a[192:195], v[144:147]
  s_waitcnt lgkmcnt(4)
  ds_read_b64_tr_b16 v[240:241], v169 offset:8192
  ds_read_b64_tr_b16 v[242:243], v169 offset:8704
  v_mfma_f32_16x16x32_bf16 v[188:191], v[220:223], v[16:19], 0
  s_nop 0
  ds_read_b64_tr_b16 v[244:245], v170 offset:0
  ds_read_b64_tr_b16 v[246:247], v170 offset:512
  v_mfma_f32_16x16x32_bf16 v[188:191], v[224:227], v[24:27], v[188:191]
  s_waitcnt vmcnt(17)
  ds_read_b64_tr_b16 v[248:249], v170 offset:4096
  v_cvt_pk_bf16_f32 v161, v138, v139
  v_mfma_f32_16x16x32_bf16 v[188:191], v[228:231], v[32:35], v[188:191]
  s_barrier
  v_mfma_f32_16x16x32_bf16 v[192:195], v[228:231], v[36:39], 0
  ds_read_b64_tr_b16 v[250:251], v170 offset:4608
  v_cvt_pk_bf16_f32 v162, v144, v145
  v_mfma_f32_16x16x32_bf16 v[192:195], v[224:227], v[28:31], v[192:195]
  buffer_store_dwordx4 v[152:155], v183, s[48:51], s28 offen offset:0 sc1
  v_mfma_f32_16x16x32_bf16 v[192:195], v[220:223], v[20:23], v[192:195]
  s_waitcnt lgkmcnt(4)
  ds_read_b64_tr_b16 v[252:253], v170 offset:8192
  ds_read_b64_tr_b16 v[254:255], v170 offset:8704
  v_mfma_f32_16x16x32_bf16 v[200:203], v[232:235], v[20:23], 0
  ds_read_b64_tr_b16 v[220:221], v171 offset:0
  v_cvt_pk_bf16_f32 v163, v146, v147
  v_mfma_f32_16x16x32_bf16 v[200:203], v[236:239], v[28:31], v[200:203]
  ds_read_b64_tr_b16 v[222:223], v171 offset:512
  v_cvt_pk_bf16_f32 v164, v140, v141
  v_mfma_f32_16x16x32_bf16 v[200:203], v[240:243], v[36:39], v[200:203]
  v_mfma_f32_16x16x32_bf16 v[196:199], v[240:243], v[32:35], 0
  ds_read_b64_tr_b16 v[224:225], v171 offset:4096
  v_cvt_pk_bf16_f32 v165, v142, v143
  v_mfma_f32_16x16x32_bf16 v[196:199], v[236:239], v[24:27], v[196:199]
  ds_read_b64_tr_b16 v[226:227], v171 offset:4608
  v_cvt_pk_bf16_f32 v166, v148, v149
  v_mfma_f32_16x16x32_bf16 v[196:199], v[232:235], v[16:19], v[196:199]
  s_waitcnt lgkmcnt(4)
  ds_read_b64_tr_b16 v[228:229], v171 offset:8192
  ds_read_b64_tr_b16 v[230:231], v171 offset:8704
  v_mfma_f32_16x16x32_bf16 v[204:207], v[244:247], v[16:19], 0
  s_nop 0
  ds_read_b64_tr_b16 v[232:233], v168 offset:12288
  ds_read_b64_tr_b16 v[234:235], v168 offset:12800
  v_mfma_f32_16x16x32_bf16 v[204:207], v[248:251], v[24:27], v[204:207]
  ds_read_b64_tr_b16 v[236:237], v168 offset:16384
  v_cvt_pk_bf16_f32 v167, v150, v151
  v_mfma_f32_16x16x32_bf16 v[204:207], v[252:255], v[32:35], v[204:207]
  v_mfma_f32_16x16x32_bf16 v[208:211], v[252:255], v[36:39], 0
  ds_read_b64_tr_b16 v[238:239], v168 offset:16896
  v_mfma_f32_16x16x32_bf16 v[208:211], v[248:251], v[28:31], v[208:211]
  buffer_store_dwordx4 v[156:159], v183, s[48:51], s28 offen offset:2048 sc1
  v_mfma_f32_16x16x32_bf16 v[208:211], v[244:247], v[20:23], v[208:211]
  s_waitcnt lgkmcnt(4)
  ds_read_b64_tr_b16 v[240:241], v168 offset:20480
  ds_read_b64_tr_b16 v[242:243], v168 offset:20992
  v_mfma_f32_16x16x32_bf16 v[216:219], v[220:223], v[20:23], 0
  s_nop 0
  ds_read_b64_tr_b16 v[244:245], v169 offset:12288
  ds_read_b64_tr_b16 v[246:247], v169 offset:12800
  v_mfma_f32_16x16x32_bf16 v[216:219], v[224:227], v[28:31], v[216:219]
  ds_read_b64_tr_b16 v[248:249], v169 offset:16384
  v_mfma_f32_16x16x32_bf16 v[216:219], v[228:231], v[36:39], v[216:219]
  v_mfma_f32_16x16x32_bf16 v[212:215], v[228:231], v[32:35], 0
  ds_read_b64_tr_b16 v[250:251], v169 offset:16896
  v_mfma_f32_16x16x32_bf16 v[212:215], v[224:227], v[24:27], v[212:215]
  buffer_store_dwordx4 v[160:163], v183, s[48:51], s28 offen offset:1024 sc1
  v_mfma_f32_16x16x32_bf16 v[212:215], v[220:223], v[16:19], v[212:215]
  s_waitcnt lgkmcnt(4)
  ds_read_b64_tr_b16 v[252:253], v169 offset:20480
  ds_read_b64_tr_b16 v[254:255], v169 offset:20992
  v_mfma_f32_16x16x32_bf16 v[188:191], v[232:235], v[40:43], v[188:191]
  s_nop 0
  ds_read_b64_tr_b16 v[220:221], v170 offset:12288
  ds_read_b64_tr_b16 v[222:223], v170 offset:12800
  v_mfma_f32_16x16x32_bf16 v[188:191], v[236:239], v[48:51], v[188:191]
  s_waitcnt vmcnt(4)
  ds_read_b64_tr_b16 v[224:225], v170 offset:16384
  v_mfma_f32_16x16x32_bf16 v[188:191], v[240:243], v[56:59], v[188:191]
  s_barrier
  v_mfma_f32_16x16x32_bf16 v[192:195], v[240:243], v[60:63], v[192:195]
  ds_read_b64_tr_b16 v[226:227], v170 offset:16896
  v_mfma_f32_16x16x32_bf16 v[192:195], v[236:239], v[52:55], v[192:195]
  buffer_store_dwordx4 v[164:167], v183, s[48:51], s28 offen offset:3072 sc1
  v_mfma_f32_16x16x32_bf16 v[192:195], v[232:235], v[44:47], v[192:195]
  s_waitcnt lgkmcnt(4)
  ds_read_b64_tr_b16 v[228:229], v170 offset:20480
  ds_read_b64_tr_b16 v[230:231], v170 offset:20992
  v_mfma_f32_16x16x32_bf16 v[200:203], v[244:247], v[44:47], v[200:203]
  s_add_u32 s28, s28, 16384
  ds_read_b64_tr_b16 v[232:233], v171 offset:12288
  ds_read_b64_tr_b16 v[234:235], v171 offset:12800
  v_mfma_f32_16x16x32_bf16 v[200:203], v[248:251], v[52:55], v[200:203]
  ds_read_b64_tr_b16 v[236:237], v171 offset:16384
  v_mfma_f32_16x16x32_bf16 v[200:203], v[252:255], v[60:63], v[200:203]
  v_mfma_f32_16x16x32_bf16 v[196:199], v[252:255], v[56:59], v[196:199]
  ds_read_b64_tr_b16 v[238:239], v171 offset:16896
  v_mfma_f32_16x16x32_bf16 v[196:199], v[248:251], v[48:51], v[196:199]
  buffer_atomic_add v14, v12, s[48:51], s74 offen offset:256 sc1
  v_mfma_f32_16x16x32_bf16 v[196:199], v[244:247], v[40:43], v[196:199]
  s_waitcnt lgkmcnt(4)
  ds_read_b64_tr_b16 v[240:241], v171 offset:20480
  ds_read_b64_tr_b16 v[242:243], v171 offset:20992
  v_mfma_f32_16x16x32_bf16 v[204:207], v[220:223], v[40:43], v[204:207]
  ds_read_b64_tr_b16 v[244:245], v168 offset:24576
  v_mfma_f32_16x16x32_bf16 v[204:207], v[224:227], v[48:51], v[204:207]
  ds_read_b64_tr_b16 v[246:247], v168 offset:25088
  v_mfma_f32_16x16x32_bf16 v[204:207], v[228:231], v[56:59], v[204:207]
  v_mfma_f32_16x16x32_bf16 v[208:211], v[228:231], v[60:63], v[208:211]
  ds_read_b64_tr_b16 v[248:249], v168 offset:28672
  v_mfma_f32_16x16x32_bf16 v[208:211], v[224:227], v[52:55], v[208:211]
  ds_read_b64_tr_b16 v[250:251], v168 offset:29184
  v_mfma_f32_16x16x32_bf16 v[208:211], v[220:223], v[44:47], v[208:211]
  s_waitcnt lgkmcnt(4)
  ds_read_b64_tr_b16 v[252:253], v168 offset:32768
  ds_read_b64_tr_b16 v[254:255], v168 offset:33280
  v_mfma_f32_16x16x32_bf16 v[216:219], v[232:235], v[44:47], v[216:219]
  ds_read_b64_tr_b16 v[220:221], v169 offset:24576
  v_add_u32 v168, 73728, v172
  v_mfma_f32_16x16x32_bf16 v[216:219], v[236:239], v[52:55], v[216:219]
  ds_read_b64_tr_b16 v[222:223], v169 offset:25088
  v_mfma_f32_16x16x32_bf16 v[216:219], v[240:243], v[60:63], v[216:219]
  v_mfma_f32_16x16x32_bf16 v[212:215], v[240:243], v[56:59], v[212:215]
  ds_read_b64_tr_b16 v[224:225], v169 offset:28672
  v_mfma_f32_16x16x32_bf16 v[212:215], v[236:239], v[48:51], v[212:215]
  ds_read_b64_tr_b16 v[226:227], v169 offset:29184
  v_mfma_f32_16x16x32_bf16 v[212:215], v[232:235], v[40:43], v[212:215]
  s_waitcnt lgkmcnt(4)
  ds_read_b64_tr_b16 v[228:229], v169 offset:32768
  ds_read_b64_tr_b16 v[230:231], v169 offset:33280
  v_mfma_f32_16x16x32_bf16 v[188:191], v[244:247], v[64:67], v[188:191]
  ds_read_b64_tr_b16 v[232:233], v170 offset:24576
  v_add_u32 v169, 73728, v173
  v_mfma_f32_16x16x32_bf16 v[188:191], v[248:251], v[72:75], v[188:191]
  ds_read_b64_tr_b16 v[234:235], v170 offset:25088
  v_mfma_f32_16x16x32_bf16 v[188:191], v[252:255], v[80:83], v[188:191]
  buffer_load_dword v13, v186, s[48:51], s74 offen offset:128 sc1
  v_mfma_f32_16x16x32_bf16 v[192:195], v[252:255], v[84:87], v[192:195]
KB_I10:
  s_cbranch_execz KB_I13
  ds_read_b64_tr_b16 v[236:237], v170 offset:28672
  v_mfma_f32_16x16x32_bf16 v[192:195], v[248:251], v[76:79], v[192:195]
  ds_read_b64_tr_b16 v[238:239], v170 offset:29184
  v_mfma_f32_16x16x32_bf16 v[192:195], v[244:247], v[68:71], v[192:195]
  s_waitcnt lgkmcnt(4)
  ds_read_b64_tr_b16 v[240:241], v170 offset:32768
  ds_read_b64_tr_b16 v[242:243], v170 offset:33280
  v_mfma_f32_16x16x32_bf16 v[200:203], v[220:223], v[68:71], v[200:203]
  ds_read_b64_tr_b16 v[244:245], v171 offset:24576
  v_add_u32 v170, 73728, v174
  v_mfma_f32_16x16x32_bf16 v[200:203], v[224:227], v[76:79], v[200:203]
  ds_read_b64_tr_b16 v[246:247], v171 offset:25088
  v_mfma_f32_16x16x32_bf16 v[200:203], v[228:231], v[84:87], v[200:203]
  v_mfma_f32_16x16x32_bf16 v[196:199], v[228:231], v[80:83], v[196:199]
  ds_read_b64_tr_b16 v[248:249], v171 offset:28672
  v_mfma_f32_16x16x32_bf16 v[196:199], v[224:227], v[72:75], v[196:199]
  ds_read_b64_tr_b16 v[250:251], v171 offset:29184
  v_mfma_f32_16x16x32_bf16 v[196:199], v[220:223], v[64:67], v[196:199]
  s_waitcnt lgkmcnt(4)
  ds_read_b64_tr_b16 v[252:253], v171 offset:32768
  ds_read_b64_tr_b16 v[254:255], v171 offset:33280
  v_mfma_f32_16x16x32_bf16 v[204:207], v[232:235], v[64:67], v[204:207]
  ds_read_b64_tr_b16 v[220:221], v168 offset:0
  v_add_u32 v171, 73728, v175
  v_mfma_f32_16x16x32_bf16 v[204:207], v[236:239], v[72:75], v[204:207]
  ds_read_b64_tr_b16 v[222:223], v168 offset:512
  v_mfma_f32_16x16x32_bf16 v[204:207], v[240:243], v[80:83], v[204:207]
  v_mfma_f32_16x16x32_bf16 v[208:211], v[240:243], v[84:87], v[208:211]
  ds_read_b64_tr_b16 v[224:225], v168 offset:4096
  v_mfma_f32_16x16x32_bf16 v[208:211], v[236:239], v[76:79], v[208:211]
  ds_read_b64_tr_b16 v[226:227], v168 offset:4608
  v_mfma_f32_16x16x32_bf16 v[208:211], v[232:235], v[68:71], v[208:211]
  s_waitcnt lgkmcnt(4)
  ds_read_b64_tr_b16 v[228:229], v168 offset:8192
  ds_read_b64_tr_b16 v[230:231], v168 offset:8704
  v_mfma_f32_16x16x32_bf16 v[216:219], v[244:247], v[68:71], v[216:219]
  ds_read_b64_tr_b16 v[232:233], v169 offset:0
  v_mfma_f32_16x16x32_bf16 v[216:219], v[248:251], v[76:79], v[216:219]
  ds_read_b64_tr_b16 v[234:235], v169 offset:512
  v_mfma_f32_16x16x32_bf16 v[216:219], v[252:255], v[84:87], v[216:219]
  v_mfma_f32_16x16x32_bf16 v[212:215], v[252:255], v[80:83], v[212:215]
  ds_read_b64_tr_b16 v[236:237], v169 offset:4096
  v_mfma_f32_16x16x32_bf16 v[212:215], v[248:251], v[72:75], v[212:215]
  ds_read_b64_tr_b16 v[238:239], v169 offset:4608
  v_mfma_f32_16x16x32_bf16 v[212:215], v[244:247], v[64:67], v[212:215]
  s_waitcnt lgkmcnt(4)
  ds_read_b64_tr_b16 v[240:241], v169 offset:8192
  ds_read_b64_tr_b16 v[242:243], v169 offset:8704
  v_mfma_f32_16x16x32_bf16 v[188:191], v[220:223], a[144:147], v[188:191]
  ds_read_b64_tr_b16 v[244:245], v170 offset:0
  v_mfma_f32_16x16x32_bf16 v[188:191], v[224:227], a[152:155], v[188:191]
  s_waitcnt vmcnt(2)
  ds_read_b64_tr_b16 v[246:247], v170 offset:512
  v_mfma_f32_16x16x32_bf16 v[188:191], v[228:231], a[160:163], v[188:191]
  s_barrier
  v_mfma_f32_16x16x32_bf16 v[192:195], v[228:231], a[164:167], v[192:195]
  ds_read_b64_tr_b16 v[248:249], v170 offset:4096
  v_mfma_f32_16x16x32_bf16 v[192:195], v[224:227], a[156:159], v[192:195]
  ds_read_b64_tr_b16 v[250:251], v170 offset:4608
  v_mfma_f32_16x16x32_bf16 v[192:195], v[220:223], a[148:151], v[192:195]
  s_waitcnt lgkmcnt(4)
  ds_read_b64_tr_b16 v[252:253], v170 offset:8192
  ds_read_b64_tr_b16 v[254:255], v170 offset:8704
  v_mfma_f32_16x16x32_bf16 v[200:203], v[232:235], a[148:151], v[200:203]
  s_nop 0
  ds_read_b64_tr_b16 v[220:221], v171 offset:0
  ds_read_b64_tr_b16 v[222:223], v171 offset:512
  v_mfma_f32_16x16x32_bf16 v[200:203], v[236:239], a[156:159], v[200:203]
  ds_read_b64_tr_b16 v[224:225], v171 offset:4096
  v_mfma_f32_16x16x32_bf16 v[200:203], v[240:243], a[164:167], v[200:203]
  v_mfma_f32_16x16x32_bf16 v[196:199], v[240:243], a[160:163], v[196:199]
  ds_read_b64_tr_b16 v[226:227], v171 offset:4608
  v_mfma_f32_16x16x32_bf16 v[196:199], v[236:239], a[152:155], v[196:199]
  buffer_atomic_add v14, v12, s[48:51], s74 offen offset:384 sc1
  v_mfma_f32_16x16x32_bf16 v[196:199], v[232:235], a[144:147], v[196:199]
  s_waitcnt lgkmcnt(4)
  ds_read_b64_tr_b16 v[228:229], v171 offset:8192
  ds_read_b64_tr_b16 v[230:231], v171 offset:8704
  v_mfma_f32_16x16x32_bf16 v[204:207], v[244:247], a[144:147], v[204:207]
  ds_read_b64_tr_b16 v[232:233], v168 offset:12288
  v_mfma_f32_16x16x32_bf16 v[204:207], v[248:251], a[152:155], v[204:207]
  ds_read_b64_tr_b16 v[234:235], v168 offset:12800
  v_mfma_f32_16x16x32_bf16 v[204:207], v[252:255], a[160:163], v[204:207]
  v_mfma_f32_16x16x32_bf16 v[208:211], v[252:255], a[164:167], v[208:211]
  ds_read_b64_tr_b16 v[236:237], v168 offset:16384
  v_mfma_f32_16x16x32_bf16 v[208:211], v[248:251], a[156:159], v[208:211]
  ds_read_b64_tr_b16 v[238:239], v168 offset:16896
  v_mfma_f32_16x16x32_bf16 v[208:211], v[244:247], a[148:151], v[208:211]
  s_waitcnt lgkmcnt(4)
  ds_read_b64_tr_b16 v[240:241], v168 offset:20480
  ds_read_b64_tr_b16 v[242:243], v168 offset:20992
  v_mfma_f32_16x16x32_bf16 v[216:219], v[220:223], a[148:151], v[216:219]
  ds_read_b64_tr_b16 v[244:245], v169 offset:12288
  v_mfma_f32_16x16x32_bf16 v[216:219], v[224:227], a[156:159], v[216:219]
  ds_read_b64_tr_b16 v[246:247], v169 offset:12800
  v_mfma_f32_16x16x32_bf16 v[216:219], v[228:231], a[164:167], v[216:219]
  v_mfma_f32_16x16x32_bf16 v[212:215], v[228:231], a[160:163], v[212:215]
  ds_read_b64_tr_b16 v[248:249], v169 offset:16384
  v_mfma_f32_16x16x32_bf16 v[212:215], v[224:227], a[152:155], v[212:215]
  ds_read_b64_tr_b16 v[250:251], v169 offset:16896
  v_mfma_f32_16x16x32_bf16 v[212:215], v[220:223], a[144:147], v[212:215]
  s_waitcnt lgkmcnt(4)
  ds_read_b64_tr_b16 v[252:253], v169 offset:20480
  ds_read_b64_tr_b16 v[254:255], v169 offset:20992
  v_mfma_f32_16x16x32_bf16 v[188:191], v[232:235], a[168:171], v[188:191]
  ds_read_b64_tr_b16 v[220:221], v170 offset:12288
  v_mfma_f32_16x16x32_bf16 v[188:191], v[236:239], a[176:179], v[188:191]
  ds_read_b64_tr_b16 v[222:223], v170 offset:12800
  v_mfma_f32_16x16x32_bf16 v[188:191], v[240:243], a[184:187], v[188:191]
  v_mfma_f32_16x16x32_bf16 v[192:195], v[240:243], a[188:191], v[192:195]
  ds_read_b64_tr_b16 v[224:225], v170 offset:16384
  v_mfma_f32_16x16x32_bf16 v[192:195], v[236:239], a[180:183], v[192:195]
  ds_read_b64_tr_b16 v[226:227], v170 offset:16896
  v_mfma_f32_16x16x32_bf16 v[192:195], v[232:235], a[172:175], v[192:195]
  s_waitcnt lgkmcnt(4)
  ds_read_b64_tr_b16 v[228:229], v170 offset:20480
  ds_read_b64_tr_b16 v[230:231], v170 offset:20992
  v_mfma_f32_16x16x32_bf16 v[200:203], v[244:247], a[172:175], v[200:203]
  ds_read_b64_tr_b16 v[232:233], v171 offset:12288
  v_mfma_f32_16x16x32_bf16 v[200:203], v[248:251], a[180:183], v[200:203]
  ds_read_b64_tr_b16 v[234:235], v171 offset:12800
  v_mfma_f32_16x16x32_bf16 v[200:203], v[252:255], a[188:191], v[200:203]
  v_mfma_f32_16x16x32_bf16 v[196:199], v[252:255], a[184:187], v[196:199]
  ds_read_b64_tr_b16 v[236:237], v171 offset:16384
  v_mfma_f32_16x16x32_bf16 v[196:199], v[248:251], a[176:179], v[196:199]
  ds_read_b64_tr_b16 v[238:239], v171 offset:16896
  v_mfma_f32_16x16x32_bf16 v[196:199], v[244:247], a[168:171], v[196:199]
  s_waitcnt lgkmcnt(4)
  ds_read_b64_tr_b16 v[240:241], v171 offset:20480
  ds_read_b64_tr_b16 v[242:243], v171 offset:20992
  v_mfma_f32_16x16x32_bf16 v[204:207], v[220:223], a[168:171], v[204:207]
  s_waitcnt vmcnt(1)
  ds_read_b64_tr_b16 v[244:245], v168 offset:24576
  v_mfma_f32_16x16x32_bf16 v[204:207], v[224:227], a[176:179], v[204:207]
  ds_read_b64_tr_b16 v[246:247], v168 offset:25088
  v_readfirstlane_b32 s53, v13
  v_mfma_f32_16x16x32_bf16 v[204:207], v[228:231], a[184:187], v[204:207]
  v_mfma_f32_16x16x32_bf16 v[208:211], v[228:231], a[188:191], v[208:211]
  ds_read_b64_tr_b16 v[248:249], v168 offset:28672
  v_mfma_f32_16x16x32_bf16 v[208:211], v[224:227], a[180:183], v[208:211]
  s_cmp_eq_u32 s53, 16
  s_cselect_b32 s37, s72, 1073741824
  ds_read_b64_tr_b16 v[250:251], v168 offset:29184
  v_mfma_f32_16x16x32_bf16 v[208:211], v[220:223], a[172:175], v[208:211]
  s_waitcnt lgkmcnt(4)
  ds_read_b64_tr_b16 v[252:253], v168 offset:32768
  ds_read_b64_tr_b16 v[254:255], v168 offset:33280
  v_mfma_f32_16x16x32_bf16 v[216:219], v[232:235], a[172:175], v[216:219]
  s_nop 0
  ds_read_b64_tr_b16 v[220:221], v169 offset:24576
  ds_read_b64_tr_b16 v[222:223], v169 offset:25088
  v_mfma_f32_16x16x32_bf16 v[216:219], v[236:239], a[180:183], v[216:219]
  ds_read_b64_tr_b16 v[224:225], v169 offset:28672
  v_mfma_f32_16x16x32_bf16 v[216:219], v[240:243], a[188:191], v[216:219]
  v_mfma_f32_16x16x32_bf16 v[212:215], v[240:243], a[184:187], v[212:215]
  s_add_u32 s73, s37, 16384
  ds_read_b64_tr_b16 v[226:227], v169 offset:29184
  v_mfma_f32_16x16x32_bf16 v[212:215], v[236:239], a[176:179], v[212:215]
  buffer_load_dwordx4 a[16:19], v180, s[48:51], s73 offen sc1
  v_mfma_f32_16x16x32_bf16 v[212:215], v[232:235], a[168:171], v[212:215]
  s_waitcnt lgkmcnt(4)
  ds_read_b64_tr_b16 v[228:229], v169 offset:32768
  ds_read_b64_tr_b16 v[230:231], v169 offset:33280
  v_mfma_f32_16x16x32_bf16 v[188:191], v[244:247], a[192:195], v[188:191]
  s_nop 0
  ds_read_b64_tr_b16 v[232:233], v170 offset:24576
  ds_read_b64_tr_b16 v[234:235], v170 offset:25088
  v_mfma_f32_16x16x32_bf16 v[188:191], v[248:251], a[200:203], v[188:191]
  ds_read_b64_tr_b16 v[236:237], v170 offset:28672
  v_mfma_f32_16x16x32_bf16 v[188:191], v[252:255], a[208:211], v[188:191]
  buffer_load_dword v13, v186, s[48:51], s74 offen offset:256 sc1
  v_mfma_f32_16x16x32_bf16 v[192:195], v[252:255], a[212:215], v[192:195]
  s_add_u32 s73, s37, 344064
  ds_read_b64_tr_b16 v[238:239], v170 offset:29184
  v_mfma_f32_16x16x32_bf16 v[192:195], v[248:251], a[204:207], v[192:195]
  buffer_load_dwordx4 a[20:23], v180, s[48:51], s73 offen sc1
  v_mfma_f32_16x16x32_bf16 v[192:195], v[244:247], a[196:199], v[192:195]
  s_waitcnt lgkmcnt(4)
  ds_read_b64_tr_b16 v[240:241], v170 offset:32768
  ds_read_b64_tr_b16 v[242:243], v170 offset:33280
  v_mfma_f32_16x16x32_bf16 v[200:203], v[220:223], a[196:199], v[200:203]
  s_nop 0
  ds_read_b64_tr_b16 v[244:245], v171 offset:24576
  ds_read_b64_tr_b16 v[246:247], v171 offset:25088
  v_mfma_f32_16x16x32_bf16 v[200:203], v[224:227], a[204:207], v[200:203]
  ds_read_b64_tr_b16 v[248:249], v171 offset:28672
  v_mfma_f32_16x16x32_bf16 v[200:203], v[228:231], a[212:215], v[200:203]
  v_mfma_f32_16x16x32_bf16 v[196:199], v[228:231], a[208:211], v[196:199]
  s_add_u32 s73, s37, 671744
  ds_read_b64_tr_b16 v[250:251], v171 offset:29184
  v_mfma_f32_16x16x32_bf16 v[196:199], v[224:227], a[200:203], v[196:199]
  buffer_load_dwordx4 a[24:27], v180, s[48:51], s73 offen sc1
  v_mfma_f32_16x16x32_bf16 v[196:199], v[220:223], a[192:195], v[196:199]
  s_waitcnt lgkmcnt(4)
  ds_read_b64_tr_b16 v[252:253], v171 offset:32768
  ds_read_b64_tr_b16 v[254:255], v171 offset:33280
  v_mfma_f32_16x16x32_bf16 v[204:207], v[232:235], a[192:195], v[204:207]
  v_mfma_f32_16x16x32_bf16 v[204:207], v[236:239], a[200:203], v[204:207]
  v_cvt_pk_bf16_f32 v152, v188, v189
  v_mfma_f32_16x16x32_bf16 v[204:207], v[240:243], a[208:211], v[204:207]
  v_mfma_f32_16x16x32_bf16 v[208:211], v[240:243], a[212:215], v[208:211]
  s_add_u32 s73, s37, 999424
  v_mfma_f32_16x16x32_bf16 v[208:211], v[236:239], a[204:207], v[208:211]
  buffer_load_dwordx4 a[28:31], v180, s[48:51], s73 offen sc1
  v_mfma_f32_16x16x32_bf16 v[208:211], v[232:235], a[196:199], v[208:211]
  s_waitcnt lgkmcnt(0)
  v_mfma_f32_16x16x32_bf16 v[216:219], v[244:247], a[196:199], v[216:219]
  v_cvt_pk_bf16_f32 v153, v190, v191
  v_mfma_f32_16x16x32_bf16 v[216:219], v[248:251], a[204:207], v[216:219]
  v_cvt_pk_bf16_f32 v154, v196, v197
  v_mfma_f32_16x16x32_bf16 v[216:219], v[252:255], a[212:215], v[216:219]
  v_mfma_f32_16x16x32_bf16 v[212:215], v[252:255], a[208:211], v[212:215]
  v_cvt_pk_bf16_f32 v155, v198, v199
  v_mfma_f32_16x16x32_bf16 v[212:215], v[248:251], a[200:203], v[212:215]
  v_cvt_pk_bf16_f32 v156, v192, v193
  v_mfma_f32_16x16x32_bf16 v[212:215], v[244:247], a[192:195], v[212:215]
  buffer_load_dword v15, v186, s[48:51], s74 offen offset:384 sc1
  v_cvt_pk_bf16_f32 v157, v194, v195
  v_cvt_pk_bf16_f32 v158, v200, v201
  v_cvt_pk_bf16_f32 v159, v202, v203
  v_cvt_pk_bf16_f32 v160, v204, v205
  v_cvt_pk_bf16_f32 v161, v206, v207
  v_cvt_pk_bf16_f32 v164, v208, v209
  v_cvt_pk_bf16_f32 v165, v210, v211
  v_cvt_pk_bf16_f32 v162, v212, v213
  v_cvt_pk_bf16_f32 v163, v214, v215
  v_cvt_pk_bf16_f32 v166, v216, v217
  v_cvt_pk_bf16_f32 v167, v218, v219
  buffer_store_dwordx4 v[152:155], v183, s[48:51], s28 offen offset:0 sc1
  buffer_store_dwordx4 v[156:159], v183, s[48:51], s28 offen offset:2048 sc1
  buffer_store_dwordx4 v[160:163], v183, s[48:51], s28 offen offset:1024 sc1
  buffer_store_dwordx4 v[164:167], v183, s[48:51], s28 offen offset:3072 sc1
  s_add_u32 s28, s28, 16384
  s_cmp_eq_u32 s36, 1073741824
  s_cbranch_scc1 KB_E0
  ds_read_b64 v[4:5], v181 offset:0
  ds_read_b64 v[6:7], v187 offset:0
  v_mfma_f32_16x16x32_bf16 v[0:3], a[220:223], a[0:3], 0
  v_mfma_f32_16x16x32_bf16 v[0:3], a[220:223], a[4:7], v[0:3]
  v_mfma_f32_16x16x32_bf16 v[0:3], a[220:223], a[8:11], v[0:3]
  v_mfma_f32_16x16x32_bf16 v[0:3], a[220:223], a[12:15], v[0:3]
  s_waitcnt lgkmcnt(0)
  v_lshlrev_b32 v8, 16, v4
  v_and_b32 v9, 0xffff0000, v4
  v_lshlrev_b32 v10, 16, v5
  v_and_b32 v11, 0xffff0000, v5
  v_lshlrev_b32 v176, 16, v6
  v_and_b32 v177, 0xffff0000, v6
  v_lshlrev_b32 v178, 16, v7
  v_and_b32 v179, 0xffff0000, v7
  v_pk_fma_f32 v[8:9], v[176:177], v[0:1], v[8:9]
  v_pk_fma_f32 v[10:11], v[178:179], v[2:3], v[10:11]
  v_cvt_pk_bf16_f32 v4, v8, v9
  v_cvt_pk_bf16_f32 v5, v10, v11
  ds_write_b64 v181, v[4:5] offset:0
KB_E0:
  v_accvgpr_read_b32 v181, a244
  v_accvgpr_read_b32 v187, a245
  s_waitcnt vmcnt(5)
  s_cmp_eq_u32 s37, 1073741824
  s_cbranch_scc1 KB_E1
  ds_read_b64 v[4:5], v181 offset:0
  ds_read_b64 v[6:7], v187 offset:0
  v_mfma_f32_16x16x32_bf16 v[0:3], a[216:219], a[16:19], 0
  v_mfma_f32_16x16x32_bf16 v[0:3], a[216:219], a[20:23], v[0:3]
  v_mfma_f32_16x16x32_bf16 v[0:3], a[216:219], a[24:27], v[0:3]
  v_mfma_f32_16x16x32_bf16 v[0:3], a[216:219], a[28:31], v[0:3]
  s_waitcnt lgkmcnt(0)
  v_lshlrev_b32 v8, 16, v4
  v_and_b32 v9, 0xffff0000, v4
  v_lshlrev_b32 v10, 16, v5
  v_and_b32 v11, 0xffff0000, v5
  v_lshlrev_b32 v176, 16, v6
  v_and_b32 v177, 0xffff0000, v6
  v_lshlrev_b32 v178, 16, v7
  v_and_b32 v179, 0xffff0000, v7
  v_pk_fma_f32 v[8:9], v[176:177], v[0:1], v[8:9]
  v_pk_fma_f32 v[10:11], v[178:179], v[2:3], v[10:11]
  v_cvt_pk_bf16_f32 v4, v8, v9
  v_cvt_pk_bf16_f32 v5, v10, v11
  ds_write_b64 v181, v[4:5] offset:0
KB_E1:
  s_waitcnt vmcnt(0)
  s_barrier
  buffer_atomic_add v14, v12, s[48:51], s74 offen offset:512 sc1
  s_mov_b32 s54, 200000
  s_waitcnt vmcnt(9)
KB_T2:
  v_cmp_ne_u32 vcc, 16, v13
  s_nop 0
  s_and_b32 s53, vcc_lo, 1
  s_cbranch_scc0 KB_T2X
  buffer_load_dword v13, v186, s[48:51], s74 offen offset:256 sc1
  s_sub_u32 s54, s54, 1
  s_cmp_eq_u32 s54, 0
  s_cbranch_scc1 KB_T2X
  s_waitcnt vmcnt(0)
  s_branch KB_T2
KB_T2X:
  s_add_u32 s73, s72, 32768
  buffer_load_dwordx4 a[32:35], v180, s[48:51], s73 offen sc1
  s_add_u32 s73, s72, 360448
  buffer_load_dwordx4 a[36:39], v180, s[48:51], s73 offen sc1
  s_add_u32 s73, s72, 688128
  buffer_load_dwordx4 a[40:43], v180, s[48:51], s73 offen sc1
  s_add_u32 s73, s72, 1015808
  buffer_load_dwordx4 a[44:47], v180, s[48:51], s73 offen sc1
  s_cmp_lg_u32 s37, 1073741824
  s_cbranch_scc1 KB_A1
  v_accvgpr_read_b32 v180, a243
  s_add_u32 s73, s72, 16384
  buffer_load_dwordx4 a[16:19], v180, s[48:51], s73 offen sc1
  s_add_u32 s73, s72, 344064
  buffer_load_dwordx4 a[20:23], v180, s[48:51], s73 offen sc1
  s_add_u32 s73, s72, 671744
  buffer_load_dwordx4 a[24:27], v180, s[48:51], s73 offen sc1
  s_add_u32 s73, s72, 999424
  buffer_load_dwordx4 a[28:31], v180, s[48:51], s73 offen sc1
KB_A1:
  s_cmp_lg_u32 s36, 1073741824
  s_cbranch_scc1 KB_A0
  v_accvgpr_read_b32 v180, a240
  s_add_u32 s73, s72, 0
  buffer_load_dwordx4 a[0:3], v180, s[48:51], s73 offen sc1
  s_add_u32 s73, s72, 327680
  buffer_load_dwordx4 a[4:7], v180, s[48:51], s73 offen sc1
  s_add_u32 s73, s72, 655360
  buffer_load_dwordx4 a[8:11], v180, s[48:51], s73 offen sc1
  s_add_u32 s73, s72, 983040
  buffer_load_dwordx4 a[12:15], v180, s[48:51], s73 offen sc1
  v_accvgpr_read_b32 v180, a243
KB_A0:
  s_mov_b32 s54, 200000
  s_waitcnt vmcnt(9)
KB_T3:
  v_cmp_ne_u32 vcc, 16, v15
  s_nop 0
  s_and_b32 s53, vcc_lo, 1
  s_cbranch_scc0 KB_T3X
  buffer_load_dword v15, v186, s[48:51], s74 offen offset:384 sc1
  s_sub_u32 s54, s54, 1
  s_cmp_eq_u32 s54, 0
  s_cbranch_scc1 KB_T3X
  s_waitcnt vmcnt(0)
  s_branch KB_T3
KB_T3X:
  s_add_u32 s73, s72, 49152
  buffer_load_dwordx4 a[48:51], v180, s[48:51], s73 offen sc1
  s_add_u32 s73, s72, 376832
  buffer_load_dwordx4 a[52:55], v180, s[48:51], s73 offen sc1
  s_add_u32 s73, s72, 704512
  buffer_load_dwordx4 a[56:59], v180, s[48:51], s73 offen sc1
  s_add_u32 s73, s72, 1032192
  buffer_load_dwordx4 a[60:63], v180, s[48:51], s73 offen sc1
  buffer_load_dword v13, v186, s[48:51], s74 offen offset:512 sc1
  s_waitcnt vmcnt(1)
  ds_read_b64 v[4:5], v181 offset:128
  ds_read_b64 v[6:7], v187 offset:128
  v_mfma_f32_16x16x32_bf16 v[0:3], a[216:219], a[32:35], 0
  v_mfma_f32_16x16x32_bf16 v[0:3], a[216:219], a[36:39], v[0:3]
  v_mfma_f32_16x16x32_bf16 v[0:3], a[216:219], a[40:43], v[0:3]
  v_mfma_f32_16x16x32_bf16 v[0:3], a[216:219], a[44:47], v[0:3]
  s_waitcnt lgkmcnt(0)
  v_lshlrev_b32 v8, 16, v4
  v_and_b32 v9, 0xffff0000, v4
  v_lshlrev_b32 v10, 16, v5
  v_and_b32 v11, 0xffff0000, v5
  v_lshlrev_b32 v176, 16, v6
  v_and_b32 v177, 0xffff0000, v6
  v_lshlrev_b32 v178, 16, v7
  v_and_b32 v179, 0xffff0000, v7
  v_pk_fma_f32 v[8:9], v[176:177], v[0:1], v[8:9]
  v_pk_fma_f32 v[10:11], v[178:179], v[2:3], v[10:11]
  v_cvt_pk_bf16_f32 v4, v8, v9
  v_cvt_pk_bf16_f32 v5, v10, v11
  ds_write_b64 v181, v[4:5] offset:128
  ds_read_b64 v[4:5], v181 offset:256
  ds_read_b64 v[6:7], v187 offset:256
  v_mfma_f32_16x16x32_bf16 v[0:3], a[216:219], a[48:51], 0
  v_mfma_f32_16x16x32_bf16 v[0:3], a[216:219], a[52:55], v[0:3]
  v_mfma_f32_16x16x32_bf16 v[0:3], a[216:219], a[56:59], v[0:3]
  v_mfma_f32_16x16x32_bf16 v[0:3], a[216:219], a[60:63], v[0:3]
  s_waitcnt lgkmcnt(0)
  v_lshlrev_b32 v8, 16, v4
  v_and_b32 v9, 0xffff0000, v4
  v_lshlrev_b32 v10, 16, v5
  v_and_b32 v11, 0xffff0000, v5
  v_lshlrev_b32 v176, 16, v6
  v_and_b32 v177, 0xffff0000, v6
  v_lshlrev_b32 v178, 16, v7
  v_and_b32 v179, 0xffff0000, v7
  v_pk_fma_f32 v[8:9], v[176:177], v[0:1], v[8:9]
  v_pk_fma_f32 v[10:11], v[178:179], v[2:3], v[10:11]
  v_cvt_pk_bf16_f32 v4, v8, v9
  v_cvt_pk_bf16_f32 v5, v10, v11
  ds_write_b64 v181, v[4:5] offset:256
  s_cmp_lg_u32 s37, 1073741824
  s_cbranch_scc1 KB_B1
  ds_read_b64 v[4:5], v181 offset:0
  ds_read_b64 v[6:7], v187 offset:0
  v_mfma_f32_16x16x32_bf16 v[0:3], a[216:219], a[16:19], 0
  v_mfma_f32_16x16x32_bf16 v[0:3], a[216:219], a[20:23], v[0:3]
  v_mfma_f32_16x16x32_bf16 v[0:3], a[216:219], a[24:27], v[0:3]
  v_mfma_f32_16x16x32_bf16 v[0:3], a[216:219], a[28:31], v[0:3]
  s_waitcnt lgkmcnt(0)
  v_lshlrev_b32 v8, 16, v4
  v_and_b32 v9, 0xffff0000, v4
  v_lshlrev_b32 v10, 16, v5
  v_and_b32 v11, 0xffff0000, v5
  v_lshlrev_b32 v176, 16, v6
  v_and_b32 v177, 0xffff0000, v6
  v_lshlrev_b32 v178, 16, v7
  v_and_b32 v179, 0xffff0000, v7
  v_pk_fma_f32 v[8:9], v[176:177], v[0:1], v[8:9]
  v_pk_fma_f32 v[10:11], v[178:179], v[2:3], v[10:11]
  v_cvt_pk_bf16_f32 v4, v8, v9
  v_cvt_pk_bf16_f32 v5, v10, v11
  ds_write_b64 v181, v[4:5] offset:0
KB_B1:
  s_cmp_lg_u32 s36, 1073741824
  s_cbranch_scc1 KB_B0
  v_accvgpr_read_b32 v181, a241
  v_accvgpr_read_b32 v187, a242
  ds_read_b64 v[4:5], v181 offset:0
  ds_read_b64 v[6:7], v187 offset:0
  v_mfma_f32_16x16x32_bf16 v[0:3], a[220:223], a[0:3], 0
  v_mfma_f32_16x16x32_bf16 v[0:3], a[220:223], a[4:7], v[0:3]
  v_mfma_f32_16x16x32_bf16 v[0:3], a[220:223], a[8:11], v[0:3]
  v_mfma_f32_16x16x32_bf16 v[0:3], a[220:223], a[12:15], v[0:3]
  s_waitcnt lgkmcnt(0)
  v_lshlrev_b32 v8, 16, v4
  v_and_b32 v9, 0xffff0000, v4
  v_lshlrev_b32 v10, 16, v5
  v_and_b32 v11, 0xffff0000, v5
  v_lshlrev_b32 v176, 16, v6
  v_and_b32 v177, 0xffff0000, v6
  v_lshlrev_b32 v178, 16, v7
  v_and_b32 v179, 0xffff0000, v7
  v_pk_fma_f32 v[8:9], v[176:177], v[0:1], v[8:9]
  v_pk_fma_f32 v[10:11], v[178:179], v[2:3], v[10:11]
  v_cvt_pk_bf16_f32 v4, v8, v9
  v_cvt_pk_bf16_f32 v5, v10, v11
  ds_write_b64 v181, v[4:5] offset:0
  v_accvgpr_read_b32 v181, a244
  v_accvgpr_read_b32 v187, a245
KB_B0:
  s_mov_b32 s54, 200000
  s_waitcnt vmcnt(0)
KB_T4:
  v_cmp_ne_u32 vcc, 16, v13
  s_nop 0
  s_and_b32 s53, vcc_lo, 1
  s_cbranch_scc0 KB_T4X
  buffer_load_dword v13, v186, s[48:51], s74 offen offset:512 sc1
  s_sub_u32 s54, s54, 1
  s_cmp_eq_u32 s54, 0
  s_cbranch_scc1 KB_T4X
  s_waitcnt vmcnt(0)
  s_branch KB_T4
KB_T4X:
  s_add_u32 s73, s72, 65536
  buffer_load_dwordx4 a[64:67], v180, s[48:51], s73 offen sc1
  s_add_u32 s73, s72, 393216
  buffer_load_dwordx4 a[68:71], v180, s[48:51], s73 offen sc1
  s_add_u32 s73, s72, 720896
  buffer_load_dwordx4 a[72:75], v180, s[48:51], s73 offen sc1
  s_add_u32 s73, s72, 1048576
  buffer_load_dwordx4 a[76:79], v180, s[48:51], s73 offen sc1
  ds_read_b64 v[4:5], v181 offset:384
  ds_read_b64 v[6:7], v187 offset:384
  s_waitcnt vmcnt(0) lgkmcnt(0)
  v_mfma_f32_16x16x32_bf16 v[0:3], a[216:219], a[64:67], 0
  v_mfma_f32_16x16x32_bf16 v[0:3], a[216:219], a[68:71], v[0:3]
  v_mfma_f32_16x16x32_bf16 v[0:3], a[216:219], a[72:75], v[0:3]
  v_mfma_f32_16x16x32_bf16 v[0:3], a[216:219], a[76:79], v[0:3]
  v_lshlrev_b32 v8, 16, v4
  v_and_b32 v9, 0xffff0000, v4
  v_lshlrev_b32 v10, 16, v5
  v_and_b32 v11, 0xffff0000, v5
  v_lshlrev_b32 v176, 16, v6
  v_and_b32 v177, 0xffff0000, v6
  v_lshlrev_b32 v178, 16, v7
  v_and_b32 v179, 0xffff0000, v7
  v_pk_fma_f32 v[8:9], v[176:177], v[0:1], v[8:9]
  v_pk_fma_f32 v[10:11], v[178:179], v[2:3], v[10:11]
  v_cvt_pk_bf16_f32 v4, v8, v9
  v_cvt_pk_bf16_f32 v5, v10, v11
  ds_write_b64 v181, v[4:5] offset:384
  v_accvgpr_read_b32 v16, a246
  v_accvgpr_read_b32 v17, a247
  v_accvgpr_read_b32 v18, a248
  v_accvgpr_read_b32 v19, a249
  s_waitcnt lgkmcnt(0)
  s_barrier
  ds_read_b128 v[20:23], v16
  ds_read_b128 v[24:27], v16 offset:512
  ds_read_b32 v28, v17
  s_waitcnt lgkmcnt(2)
  buffer_store_dwordx4 v[20:23], v18, s[68:71], s75 offen sc1
  s_waitcnt lgkmcnt(1)
  buffer_store_dwordx4 v[24:27], v18, s[68:71], s75 offen offset:512 sc1
  s_waitcnt lgkmcnt(0)
  buffer_store_dword v28, v19, s[68:71], s75 offen sc1
  s_endpgm
KB_I11:
KB_I12:
KB_I13:
  s_branch KB_BACK
KB_TAIL:
KB_SLOW0:
  s_mov_b32 s54, 200000
KB_SP0:
  buffer_load_dword v15, v186, s[48:51], s35 offen offset:0 sc1
  s_sub_u32 s54, s54, 1
  s_cmp_eq_u32 s54, 0
  s_cbranch_scc1 KB_RES0
  s_waitcnt vmcnt(0)
  v_readfirstlane_b32 s53, v15
  s_nop 0
  s_cmp_eq_u32 s53, 1
  s_cbranch_scc0 KB_SP0
  s_branch KB_RES0
KB_SLOW1:
  s_mov_b32 s54, 200000
KB_SP1:
  buffer_load_dword v15, v186, s[48:51], s35 offen offset:64 sc1
  s_sub_u32 s54, s54, 1
  s_cmp_eq_u32 s54, 0
  s_cbranch_scc1 KB_RES1
  s_waitcnt vmcnt(0)
  v_readfirstlane_b32 s53, v15
  s_nop 0
  s_cmp_eq_u32 s53, 1
  s_cbranch_scc0 KB_SP1
  s_branch KB_RES1
KB_SLOW2:
  s_mov_b32 s54, 200000
KB_SP2:
  buffer_load_dword v15, v186, s[48:51], s35 offen offset:128 sc1
  s_sub_u32 s54, s54, 1
  s_cmp_eq_u32 s54, 0
  s_cbranch_scc1 KB_RES2
  s_waitcnt vmcnt(0)
  v_readfirstlane_b32 s53, v15
  s_nop 0
  s_cmp_eq_u32 s53, 1
  s_cbranch_scc0 KB_SP2
  s_branch KB_RES2
KB_SLOW3:
  s_mov_b32 s54, 200000
KB_SP3:
  buffer_load_dword v15, v186, s[48:51], s35 offen offset:192 sc1
  s_sub_u32 s54, s54, 1
  s_cmp_eq_u32 s54, 0
  s_cbranch_scc1 KB_RES3
  s_waitcnt vmcnt(0)
  v_readfirstlane_b32 s53, v15
  s_nop 0
  s_cmp_eq_u32 s53, 1
  s_cbranch_scc0 KB_SP3
  s_branch KB_RES3
KB_END:
  s_endpgm
CODE_END:
.p2align 8
.fill 256, 4, 0xbf800000

.section .rodata,"a"
.p2align 6
.amdhsa_kernel adaLN_cond__spectral_gfnet__glu_gated_reglu__prompt_kernel
  .amdhsa_next_free_vgpr 512
  .amdhsa_next_free_sgpr 96
  .amdhsa_accum_offset 256
  .amdhsa_group_segment_fixed_size 0
  .amdhsa_kernarg_size 96
  .amdhsa_user_sgpr_count 2
  .amdhsa_user_sgpr_kernarg_segment_ptr 1
  .amdhsa_system_sgpr_workgroup_id_x 1
  .amdhsa_float_denorm_mode_32 3
.end_amdhsa_kernel
.text
```
